```python
import torch

def _softmax(x, axis=-1):
    return torch.softmax(x, dim=axis)
def _gelu(x):
    return torch.nn.functional.gelu(x, approximate="tanh")
def _silu(x):
    return torch.nn.functional.silu(x)
def _sigmoid(x):
    return torch.sigmoid(x)
def _layernorm(x, axis=-1, eps=1e-5):
    m = x.mean(dim=axis, keepdim=True)
    v = x.var(dim=axis, keepdim=True, unbiased=False)
    return (x - m) / torch.sqrt(v + eps)
def _scatter_add(tgt, idx, src, axis=0):
    return tgt.clone().index_add_(axis, idx, src)
def _segment_sum(src, seg, n):
    out = torch.zeros((n,) + src.shape[1:], dtype=src.dtype)
    return out.index_add_(0, seg, src)
def _pad(x, pw):
    flat = tuple(v for pair in reversed(pw) for v in pair)
    return torch.nn.functional.pad(x, flat)

kernel_name = 'gated_mix__spectral_gfnet__mixer_token_mlp__prompt'

def setup_inputs():

    _w = (lambda a: (lambda t: t.to(torch.bfloat16) if t.is_floating_point() else t)(torch.as_tensor(a)))
    def _A_setup():
        B, S, D = 1, 2048, 576
        Df = D // 2 + 1
        return {
            "x": _w((lambda *s: torch.randn(*s, dtype=torch.bfloat16) * 0.05)(B, S, D)),
            "w_r": _w((lambda *s: torch.randn(*s, dtype=torch.bfloat16) * 1.6)(S, Df) * 0.02),
            "w_i": _w((lambda *s: torch.randn(*s, dtype=torch.bfloat16) * 1.6)(S, Df) * 0.02),
        }
    _A_in = _A_setup()

    def _B_setup():
        B, S, D, F = 1, 2048, 576, 4608
        return {
            "x": _w((lambda *s: torch.randn(*s, dtype=torch.bfloat16) * 0.05)(B, S, D)),
            "w1": _w((lambda *s: torch.randn(*s, dtype=torch.bfloat16) * 0.2)(S, F) * (S ** -0.5)),
            "b1": _w((lambda *s: torch.randn(*s, dtype=torch.bfloat16) * 3.2)(F) * 0.02),
            "w2": _w((lambda *s: torch.randn(*s, dtype=torch.bfloat16) * 0.05)(F, S) * (F ** -0.5)),
            "b2": _w((lambda *s: torch.randn(*s, dtype=torch.bfloat16) * 0.1)(S) * 0.02),
        }
    _B_in = _B_setup()

    return {
        "A_x": _A_in["x"],
        "A_w_r": _A_in["w_r"],
        "A_w_i": _A_in["w_i"],
        "B_x": _B_in["x"],
        "B_w1": _B_in["w1"],
        "B_b1": _B_in["b1"],
        "B_w2": _B_in["w2"],
        "B_b2": _B_in["b2"],
        "gate_w": _w((lambda *s: torch.randn(*s, dtype=torch.bfloat16) * 0.05)(576) * 16.0),
    }

def reference(A_x, A_w_r, A_w_i, B_x, B_w1, B_b1, B_w2, B_b2, gate_w):
    def _A_ref(x, w_r, w_i):
        B, S, D = x.shape
        X = (lambda x, axes=(-2,-1): torch.fft.rfft2(x.float(), dim=axes))(x, axes=(-2, -1))
        W = w_r + 1j * w_i
        X = X * W
        y = (lambda x, s, axes=(-2,-1): torch.fft.irfft2(x, s=s, dim=axes).to(torch.bfloat16))(X, (S, D), axes=(-2, -1))
        return y

    def _B_ref(x, w1, b1, w2, b2):
        B, S, D = x.shape
        h = _layernorm(x, axis=-1)
        u = torch.einsum("bsd,sf->bdf", h, w1) + b1
        u = _gelu(u)
        y = torch.einsum("bdf,fs->bds", u, w2) + b2
        return (lambda x, *d: x.permute(*d))(y, 0, 2, 1)

    x = A_x
    g = _sigmoid((x * gate_w).sum(-1, keepdims=True))
    a = _A_ref(x, A_w_r, A_w_i)
    b = _B_ref(x, B_w1, B_b1, B_w2, B_b2)
    return g * a + (1 - g) * b
```

```asm
; @launch kernel=gated_mix__spectral_gfnet__mixer_token_mlp__prompt_kernel grid=(256,1,1) block=(512,1,1) lds=163840
.amdgcn_target "amdgcn-amd-amdhsa--gfx950"
.text
.globl gated_mix__spectral_gfnet__mixer_token_mlp__prompt_kernel
.p2align 8
.type gated_mix__spectral_gfnet__mixer_token_mlp__prompt_kernel,@function
gated_mix__spectral_gfnet__mixer_token_mlp__prompt_kernel:
    s_cmp_ge_u32 s2, 256
    s_cbranch_scc1 m_end
    s_load_dwordx2 s[4:5], s[0:1], 0
    s_load_dwordx2 s[28:29], s[0:1], 88
    s_mov_b32 s97, 0x34ff00
    v_and_b32 v1, 63, v0
    v_lshrrev_b32 v5, 5, v0
    v_and_b32 v2, 31, v0
    v_lshrrev_b32 v6, 6, v0
    s_nop 0
    v_readfirstlane_b32 s24, v6
    s_nop 0
    s_cmp_ge_u32 s24, 4
    s_cbranch_scc0 m_P_main
    s_getpc_b64 s[30:31]
m_P_pc:
    s_lshr_b32 s32, s2, 3
    s_lshl2_add_u32 s32, s32, s24
    s_lshl_b32 s32, s32, 9
    s_sub_u32 s32, s32, 2048
    v_lshl_add_u32 v124, v1, 7, s32
    v_min_u32 v124, m_end-m_P_pc, v124
    v_mov_b32 v125, s31
    v_add_co_u32 v124, vcc, s30, v124
    s_nop 1
    v_addc_co_u32 v125, vcc, 0, v125, vcc
    s_mov_b64 exec, 15
    global_load_dword v127, v[124:125], off
    s_mov_b64 exec, -1
    s_branch m_P_aux
m_P_main:
    s_load_dwordx2 s[8:9], s[0:1], 64
    s_load_dwordx2 s[48:49], s[0:1], 40
    s_and_b32 s25, s2, 63
    s_lshr_b32 s26, s2, 6
    v_lshrrev_b32 v6, 2, v5
    v_and_b32 v7, 3, v5
    v_lshl_add_u32 v6, v6, 4, v7
    s_lshl_b32 s27, s26, 8
    s_add_u32 s27, s27, s25
    v_lshl_add_u32 v6, v6, 6, s27
    v_mul_u32_u24 v6, 1152, v6
    v_lshlrev_b32 v9, 4, v2
    v_lshlrev_b32 v10, 2, v2
    v_add_u32 v12, v6, v9
    v_add_u32 v13, v6, v10
    v_lshrrev_b32 v3, 4, v1
    v_and_b32 v4, 15, v1
    s_mov_b32 s30, 135168
    v_mul_u32_u24 v6, 1152, v5
    v_add3_u32 v38, v6, v9, s30
    v_add3_u32 v39, v6, v10, s30
    v_mul_u32_u24 v6, 2368, v5
    v_add3_u32 v40, v6, v9, s30
    v_add3_u32 v41, v6, v10, s30
    s_mul_i32 s30, s24, 2304
    s_add_u32 s30, s30, 135168
    v_lshrrev_b32 v6, 2, v1
    v_and_b32 v7, 3, v1
    v_lshl_add_u32 v7, v7, 3, s30
    v_lshl_add_u32 v42, v6, 6, v7
    v_and_b32 v6, 1, v6
    v_lshl_add_u32 v43, v6, 6, v7
    s_mul_i32 s30, s24, 4736
    s_add_u32 s30, s30, 145536
    v_mul_u32_u24 v6, 72, v3
    v_add_lshl_u32 v6, v6, v4, 1
    v_add_u32 v44, s30, v6
    s_add_u32 s30, s30, 468
    v_sub_u32 v45, s30, v6
    v_bfe_u32 v6, v1, 2, 2
    v_mul_u32_u24 v6, 2368, v6
    v_and_b32 v7, 3, v1
    s_lshl_b32 s30, s24, 7
    s_add_u32 s30, s30, 144384
    v_add_u32 v6, s30, v6
    v_lshl_add_u32 v47, v7, 3, v6
    v_lshl_add_u32 v47, v3, 5, v47
    v_lshl_add_u32 v46, v7, 4, v6
    v_lshrrev_b32 v7, 1, v3
    v_lshl_add_u32 v46, v7, 6, v46
    v_and_b32 v7, 1, v3
    v_lshl_add_u32 v46, v7, 3, v46
    v_lshlrev_b32 v6, 10, v3
    v_lshl_add_u32 v48, v4, 4, v6
    s_and_b32 s46, s2, 7
    s_mul_i32 s46, s46, 27
    s_lshr_b32 s47, s2, 3
    s_add_u32 s46, s46, s47
    s_mul_i32 s46, s46, 43691
    s_lshr_b32 s46, s46, 18
    s_and_b32 s47, s24, 1
    s_lshl1_add_u32 s46, s46, s47
    s_lshl_b32 s46, s46, 7
    s_min_u32 s46, s46, 9088
    v_lshlrev_b32 v56, 3, v3
    s_waitcnt lgkmcnt(0)
    s_mov_b32 s6, 0x240000
    s_mov_b32 s7, 0x20000
    buffer_load_dwordx4 v[16:19], v12, s[4:7], 0 offen nt
    buffer_load_dwordx4 v[20:23], v12, s[4:7], 0 offen offset:512 nt
    buffer_load_dword v24, v13, s[4:7], 0 offen offset:1024 nt
    s_mov_b32 s10, 0x480
    s_mov_b32 s11, 0x20000
    buffer_load_dwordx4 v[28:31], v9, s[8:11], 0 offen
    buffer_load_dwordx4 v[32:35], v9, s[8:11], 0 offen offset:512
    buffer_load_dword v36, v10, s[8:11], 0 offen offset:1024
    s_barrier
    s_load_dword s96, s[28:29], s97
    s_mov_b32 s12, s28
    s_mov_b32 s13, s29
    s_mov_b32 s14, 0x240000
    s_mov_b32 s15, 0x20000
    s_add_u32 s16, s28, 0x400000
    s_addc_u32 s17, s29, 0
    s_mov_b32 s18, 0x260000
    s_mov_b32 s19, 0x20000
    s_add_u32 s32, s28, 0x300000
    s_addc_u32 s33, s29, 0
    s_mov_b32 s34, 0x8000
    s_mov_b32 s35, 0x20000
    v_mov_b32 v53, 163824
    v_mov_b32 v54, 1
    v_lshlrev_b32 v55, 3, v5
    s_mul_i32 s36, s25, 36864
    s_lshl_b32 s37, s26, 8
    s_add_u32 s36, s36, s37
    s_add_u32 s39, s36, 32768
    s_lshl_b32 s38, s24, 12
    s_add_u32 s36, s36, s38
    s_add_u32 s38, s36, 16384
    s_lshl_b32 s40, s25, 10
    s_add_u32 s40, s40, s37
    s_lshl_b32 s43, s2, 7
    s_lshl_b32 s41, s24, 6
    s_add_u32 s42, s41, 0
    v_add_u32 v6, s42, v1
    v_cmp_le_u32 vcc, 304, v6
    v_subrev_u32 v7, 304, v6
    s_nop 0
    v_cndmask_b32 v6, v6, v7, vcc
    v_cndmask_b32 v7, 0, 8, vcc
    v_and_or_b32 v7, v6, 7, v7
    v_lshrrev_b32 v6, 3, v6
    v_lshlrev_b32 v6, 16, v6
    v_lshl_add_u32 v50, v7, 4, v6
    s_add_u32 s42, s41, 256
    v_add_u32 v6, s42, v1
    v_cmp_le_u32 vcc, 304, v6
    v_subrev_u32 v7, 304, v6
    s_nop 0
    v_cndmask_b32 v6, v6, v7, vcc
    v_cndmask_b32 v7, 0, 8, vcc
    v_and_or_b32 v7, v6, 7, v7
    v_lshrrev_b32 v6, 3, v6
    v_lshlrev_b32 v6, 16, v6
    v_lshl_add_u32 v51, v7, 4, v6
    s_add_u32 s42, s41, 448
    v_add_u32 v6, s42, v1
    v_cmp_le_u32 vcc, 304, v6
    v_subrev_u32 v7, 304, v6
    s_nop 0
    v_cndmask_b32 v6, v6, v7, vcc
    v_cndmask_b32 v7, 0, 8, vcc
    v_and_or_b32 v7, v6, 7, v7
    v_lshrrev_b32 v6, 3, v6
    v_lshlrev_b32 v6, 16, v6
    v_lshl_add_u32 v52, v7, 4, v6
    v_lshlrev_b32 v6, 2, v3
    v_cvt_f32_u32 v108, v6
    v_cvt_f32_u32 v109, v4
    v_add_f32 v110, 0x00000000, v108
    v_add_f32 v111, 0x3f800000, v108
    v_add_f32 v112, 0x40000000, v108
    v_add_f32 v113, 0x40400000, v108
    v_add_f32 v114, 0x41800000, v108
    v_add_f32 v115, 0x41880000, v108
    v_add_f32 v116, 0x41900000, v108
    v_add_f32 v117, 0x41980000, v108
    v_mul_f32 v122, 0x3d638e39, v109
    v_mul_f32 v6, v110, v122
    v_mul_f32 v7, v111, v122
    v_cos_f32 v118, v6
    v_cos_f32 v119, v7
    v_sin_f32 v120, v6
    v_sin_f32 v121, v7
    v_cvt_pk_bf16_f32 v60, v118, v119
    v_cvt_pk_bf16_f32 v64, -v120, -v121
    v_mul_f32 v6, v112, v122
    v_mul_f32 v7, v113, v122
    v_cos_f32 v118, v6
    v_cos_f32 v119, v7
    v_sin_f32 v120, v6
    v_sin_f32 v121, v7
    v_cvt_pk_bf16_f32 v61, v118, v119
    v_cvt_pk_bf16_f32 v65, -v120, -v121
    v_mul_f32 v6, v114, v122
    v_mul_f32 v7, v115, v122
    v_cos_f32 v118, v6
    v_cos_f32 v119, v7
    v_sin_f32 v120, v6
    v_sin_f32 v121, v7
    v_cvt_pk_bf16_f32 v62, v118, v119
    v_cvt_pk_bf16_f32 v66, -v120, -v121
    v_cmp_eq_u32 vcc, 0, v3
    v_mov_b32 v63, 0
    v_mov_b32 v67, 0
    v_cndmask_b32 v62, 0, v62, vcc
    v_cndmask_b32 v66, 0, v66, vcc
    v_mul_f32 v122, 0x3ae38e39, v109
    v_mul_f32 v6, v110, v122
    v_cos_f32 v92, v6
    v_sin_f32 v100, v6
    v_mul_f32 v6, v111, v122
    v_cos_f32 v93, v6
    v_sin_f32 v101, v6
    v_mul_f32 v6, v112, v122
    v_cos_f32 v94, v6
    v_sin_f32 v102, v6
    v_mul_f32 v6, v113, v122
    v_cos_f32 v95, v6
    v_sin_f32 v103, v6
    v_mul_f32 v6, v114, v122
    v_cos_f32 v96, v6
    v_sin_f32 v104, v6
    v_mul_f32 v6, v115, v122
    v_cos_f32 v97, v6
    v_sin_f32 v105, v6
    v_mul_f32 v6, v116, v122
    v_cos_f32 v98, v6
    v_sin_f32 v106, v6
    v_mul_f32 v6, v117, v122
    v_cos_f32 v99, v6
    v_sin_f32 v107, v6
    v_mul_f32 v122, 0x3d000000, v109
    v_mul_f32 v6, v110, v122
    v_mul_f32 v7, v111, v122
    v_cos_f32 v118, v6
    v_cos_f32 v119, v7
    v_sin_f32 v120, v6
    v_sin_f32 v121, v7
    v_cvt_pk_bf16_f32 v68, v118, v119
    v_cvt_pk_bf16_f32 v72, v120, v121
    v_mul_f32 v6, v112, v122
    v_mul_f32 v7, v113, v122
    v_cos_f32 v118, v6
    v_cos_f32 v119, v7
    v_sin_f32 v120, v6
    v_sin_f32 v121, v7
    v_cvt_pk_bf16_f32 v69, v118, v119
    v_cvt_pk_bf16_f32 v73, v120, v121
    v_mul_f32 v6, v114, v122
    v_mul_f32 v7, v115, v122
    v_cos_f32 v118, v6
    v_cos_f32 v119, v7
    v_sin_f32 v120, v6
    v_sin_f32 v121, v7
    v_cvt_pk_bf16_f32 v70, v118, v119
    v_cvt_pk_bf16_f32 v74, v120, v121
    v_mul_f32 v6, v116, v122
    v_mul_f32 v7, v117, v122
    v_cos_f32 v118, v6
    v_cos_f32 v119, v7
    v_sin_f32 v120, v6
    v_sin_f32 v121, v7
    v_cvt_pk_bf16_f32 v71, v118, v119
    v_cvt_pk_bf16_f32 v75, v120, v121
    v_xor_b32 v76, 0x80008000, v72
    v_xor_b32 v80, 0x80000000, v68
    v_xor_b32 v84, 0x80000000, v72
    v_xor_b32 v88, 0x8000, v68
    v_xor_b32 v77, 0x80008000, v73
    v_xor_b32 v81, 0x80000000, v69
    v_xor_b32 v85, 0x80000000, v73
    v_xor_b32 v89, 0x8000, v69
    v_xor_b32 v78, 0x80008000, v74
    v_xor_b32 v82, 0x80000000, v70
    v_xor_b32 v86, 0x80000000, v74
    v_xor_b32 v90, 0x8000, v70
    v_xor_b32 v79, 0x80008000, v75
    v_xor_b32 v83, 0x80000000, v71
    v_xor_b32 v87, 0x80000000, v75
    v_xor_b32 v91, 0x8000, v71
    s_mov_b32 s30, 0x3f803f80
    s_waitcnt lgkmcnt(0)
    s_mul_i32 s96, s96, 0x9e3779b1
    s_add_u32 s96, s96, 0x7f4a7c15
    s_add_u32 s20, s28, 0x310000
    s_addc_u32 s21, s29, 0
    s_mov_b32 s22, 0xa8000
    s_mov_b32 s23, 0x20000
    v_and_b32 v123, 63, v0
    v_lshlrev_b32 v124, 13, v123
    v_add_u32 v124, 122880, v124
    v_lshlrev_b32 v123, 15, v123
    v_min_u32 v123, v123, v124
    v_mov_b32 v124, s96
    s_and_b32 s44, s2, 63
    s_cmp_lt_u32 s44, 12
    s_cselect_b32 s45, 33, 1
    s_lshr_b32 s98, s2, 6
    s_lshl2_add_u32 s44, s44, s98
    s_add_u32 s44, s44, 2048
    s_lshl_b32 s44, s44, 7
    s_waitcnt vmcnt(3)
    ds_write_b128 v38, v[16:19] offset:0
    ds_write_b128 v38, v[20:23] offset:512
    ds_write_b32 v39, v24 offset:1024
    v_lshlrev_b32 v132, 16, v16
    v_and_b32 v133, 0xffff0000, v16
    v_lshlrev_b32 v134, 16, v17
    v_and_b32 v135, 0xffff0000, v17
    v_pk_add_f32 v[126:127], v[132:133], v[134:135]
    v_lshlrev_b32 v136, 16, v18
    v_and_b32 v137, 0xffff0000, v18
    v_pk_add_f32 v[126:127], v[126:127], v[136:137]
    v_lshlrev_b32 v138, 16, v19
    v_and_b32 v139, 0xffff0000, v19
    v_pk_add_f32 v[126:127], v[126:127], v[138:139]
    v_lshlrev_b32 v140, 16, v20
    v_and_b32 v141, 0xffff0000, v20
    v_pk_add_f32 v[126:127], v[126:127], v[140:141]
    v_lshlrev_b32 v142, 16, v21
    v_and_b32 v143, 0xffff0000, v21
    v_pk_add_f32 v[126:127], v[126:127], v[142:143]
    v_lshlrev_b32 v144, 16, v22
    v_and_b32 v145, 0xffff0000, v22
    v_pk_add_f32 v[126:127], v[126:127], v[144:145]
    v_lshlrev_b32 v146, 16, v23
    v_and_b32 v147, 0xffff0000, v23
    v_pk_add_f32 v[126:127], v[126:127], v[146:147]
    v_lshlrev_b32 v148, 16, v24
    v_and_b32 v149, 0xffff0000, v24
    v_pk_add_f32 v[126:127], v[126:127], v[148:149]
    v_add_f32 v126, v126, v127
    ds_read_b64_tr_b16 v[164:165], v42 offset:0
    ds_read_b64_tr_b16 v[166:167], v43 offset:1024
    ds_read_b64_tr_b16 v[168:169], v42 offset:32
    ds_read_b64_tr_b16 v[170:171], v43 offset:1056
    ds_read_b64_tr_b16 v[172:173], v42 offset:1152
    ds_read_b64_tr_b16 v[174:175], v43 offset:2176
    ds_read_b64_tr_b16 v[176:177], v42 offset:1184
    ds_read_b64_tr_b16 v[178:179], v43 offset:2208
    v_add_f32 v126, v126, v126 row_ror:8 row_mask:0xf bank_mask:0xf
    s_nop 1
    v_add_f32 v126, v126, v126 row_ror:4 row_mask:0xf bank_mask:0xf
    s_nop 1
    v_add_f32 v126, v126, v126 row_ror:2 row_mask:0xf bank_mask:0xf
    s_nop 1
    v_add_f32 v126, v126, v126 row_ror:1 row_mask:0xf bank_mask:0xf
    v_mov_b32 v6, v126
    s_nop 1
    v_permlane16_swap_b32 v126, v6
    v_add_f32 v126, v126, v6
    v_mul_f32 v126, 0xbae38e39, v126
    v_pk_add_f32 v[132:133], v[132:133], v[126:127] op_sel_hi:[1,0]
    v_pk_add_f32 v[134:135], v[134:135], v[126:127] op_sel_hi:[1,0]
    v_pk_add_f32 v[136:137], v[136:137], v[126:127] op_sel_hi:[1,0]
    v_pk_add_f32 v[138:139], v[138:139], v[126:127] op_sel_hi:[1,0]
    v_pk_add_f32 v[140:141], v[140:141], v[126:127] op_sel_hi:[1,0]
    v_pk_add_f32 v[142:143], v[142:143], v[126:127] op_sel_hi:[1,0]
    v_pk_add_f32 v[144:145], v[144:145], v[126:127] op_sel_hi:[1,0]
    v_pk_add_f32 v[146:147], v[146:147], v[126:127] op_sel_hi:[1,0]
    v_pk_add_f32 v[148:149], v[148:149], v[126:127] op_sel_hi:[1,0]
    v_pk_mul_f32 v[128:129], v[132:133], v[132:133]
    v_pk_fma_f32 v[128:129], v[134:135], v[134:135], v[128:129]
    v_pk_fma_f32 v[128:129], v[136:137], v[136:137], v[128:129]
    v_pk_fma_f32 v[128:129], v[138:139], v[138:139], v[128:129]
    v_pk_fma_f32 v[128:129], v[140:141], v[140:141], v[128:129]
    v_pk_fma_f32 v[128:129], v[142:143], v[142:143], v[128:129]
    v_pk_fma_f32 v[128:129], v[144:145], v[144:145], v[128:129]
    v_pk_fma_f32 v[128:129], v[146:147], v[146:147], v[128:129]
    v_pk_fma_f32 v[128:129], v[148:149], v[148:149], v[128:129]
    v_add_f32 v128, v128, v129
    s_nop 1
    v_add_f32 v128, v128, v128 row_ror:8 row_mask:0xf bank_mask:0xf
    s_nop 1
    v_add_f32 v128, v128, v128 row_ror:4 row_mask:0xf bank_mask:0xf
    s_nop 1
    v_add_f32 v128, v128, v128 row_ror:2 row_mask:0xf bank_mask:0xf
    s_nop 1
    v_add_f32 v128, v128, v128 row_ror:1 row_mask:0xf bank_mask:0xf
    v_mov_b32 v6, v128
    s_nop 1
    v_permlane16_swap_b32 v128, v6
    v_add_f32 v128, v128, v6
    v_mov_b32 v6, 0x3727c5ac
    v_fmac_f32 v6, 0x3ae38e39, v128
    v_rsq_f32 v128, v6
    s_nop 0
    v_pk_mul_f32 v[132:133], v[132:133], v[128:129] op_sel_hi:[1,0]
    v_cvt_pk_bf16_f32 v152, v132, v133
    v_pk_mul_f32 v[134:135], v[134:135], v[128:129] op_sel_hi:[1,0]
    v_cvt_pk_bf16_f32 v153, v134, v135
    v_pk_mul_f32 v[136:137], v[136:137], v[128:129] op_sel_hi:[1,0]
    v_cvt_pk_bf16_f32 v154, v136, v137
    v_pk_mul_f32 v[138:139], v[138:139], v[128:129] op_sel_hi:[1,0]
    v_cvt_pk_bf16_f32 v155, v138, v139
    ds_write_b128 v40, v[152:155] offset:9216
    v_pk_mul_f32 v[140:141], v[140:141], v[128:129] op_sel_hi:[1,0]
    v_cvt_pk_bf16_f32 v156, v140, v141
    v_pk_mul_f32 v[142:143], v[142:143], v[128:129] op_sel_hi:[1,0]
    v_cvt_pk_bf16_f32 v157, v142, v143
    v_pk_mul_f32 v[144:145], v[144:145], v[128:129] op_sel_hi:[1,0]
    v_cvt_pk_bf16_f32 v158, v144, v145
    v_pk_mul_f32 v[146:147], v[146:147], v[128:129] op_sel_hi:[1,0]
    v_cvt_pk_bf16_f32 v159, v146, v147
    ds_write_b128 v40, v[156:159] offset:9728
    v_pk_mul_f32 v[148:149], v[148:149], v[128:129] op_sel_hi:[1,0]
    v_cvt_pk_bf16_f32 v160, v148, v149
    ds_write_b32 v41, v160 offset:10240
    s_mov_b64 exec, 1
    ds_add_u32 v53, v54 offset:4
    s_mov_b64 exec, -1
    s_waitcnt lgkmcnt(4)
    v_mfma_f32_16x16x32_bf16 v[180:183], v[164:167], v[60:63], 0
    v_mfma_f32_16x16x32_bf16 v[196:199], v[164:167], v[64:67], 0
    v_mfma_f32_16x16x32_bf16 v[184:187], v[168:171], v[60:63], 0
    v_mfma_f32_16x16x32_bf16 v[200:203], v[168:171], v[64:67], 0
    v_mfma_f32_16x16x32_bf16 v[188:191], v[172:175], v[60:63], 0
    v_mfma_f32_16x16x32_bf16 v[204:207], v[172:175], v[64:67], 0
    v_mfma_f32_16x16x32_bf16 v[192:195], v[176:179], v[60:63], 0
    v_mfma_f32_16x16x32_bf16 v[208:211], v[176:179], v[64:67], 0
    s_mov_b32 s98, 0x800000
m_P_s1:
    ds_read_b32 v8, v53 offset:4
    s_sub_u32 s98, s98, 1
    s_cbranch_scc1 m_P_s1_x
    s_waitcnt lgkmcnt(0)
    v_cmp_gt_u32 vcc, 4, v8
    s_cbranch_vccnz m_P_s1
m_P_s1_x:
    ds_read_b64_tr_b16 v[212:213], v46 offset:0
    ds_read_b64_tr_b16 v[214:215], v46 offset:9472
    ds_read_b64_tr_b16 v[216:217], v46 offset:512
    ds_read_b64_tr_b16 v[218:219], v46 offset:9984
    ds_read_b64_tr_b16 v[220:221], v46 offset:640
    ds_read_b64_tr_b16 v[222:223], v46 offset:10112
    s_waitcnt vmcnt(0)
    v_dot2_f32_bf16 v130, v16, v28, 0
    v_dot2_f32_bf16 v131, v17, v29, 0
    v_dot2_f32_bf16 v130, v18, v30, v130
    v_dot2_f32_bf16 v131, v19, v31, v131
    v_dot2_f32_bf16 v130, v20, v32, v130
    v_dot2_f32_bf16 v131, v21, v33, v131
    v_dot2_f32_bf16 v130, v22, v34, v130
    v_dot2_f32_bf16 v131, v23, v35, v131
    v_dot2_f32_bf16 v130, v24, v36, v130
    s_cmp_eq_u32 s24, 3
    s_waitcnt lgkmcnt(4)
    buffer_store_dwordx4 v[212:215], v48, s[12:15], s36 offen sc1
    s_waitcnt lgkmcnt(2)
    buffer_store_dwordx4 v[216:219], v48, s[12:15], s38 offen sc1
    s_cbranch_scc0 m_P_h8
    s_waitcnt lgkmcnt(0)
    buffer_store_dwordx4 v[220:223], v48, s[12:15], s39 offen sc1
m_P_h8:
    v_add_f32 v130, v130, v131
    s_nop 1
    v_add_f32 v130, v130, v130 row_ror:8 row_mask:0xf bank_mask:0xf
    s_nop 1
    v_add_f32 v130, v130, v130 row_ror:4 row_mask:0xf bank_mask:0xf
    s_nop 1
    v_add_f32 v130, v130, v130 row_ror:2 row_mask:0xf bank_mask:0xf
    s_nop 1
    v_add_f32 v130, v130, v130 row_ror:1 row_mask:0xf bank_mask:0xf
    v_mov_b32 v6, v130
    s_nop 1
    v_permlane16_swap_b32 v130, v6
    v_add_f32 v130, v130, v6
    v_mul_f32 v130, 0xbfb8aa3b, v130
    v_exp_f32 v130, v130
    v_cmp_eq_u32 vcc, 0, v2
    v_add_f32 v130, 1.0, v130
    v_rcp_f32 v130, v130
    s_mov_b64 exec, vcc
    v_sub_f32 v28, 1.0, v130
    v_mul_f32 v29, 0x35e38e39, v130
    buffer_store_dwordx2 v[28:29], v55, s[32:35], s43 offen sc1
    s_mov_b64 exec, -1
    v_mul_f32 v240, v180, v92
    v_mul_f32 v242, v196, v92
    v_fmac_f32 v240, v196, v100
    v_fma_f32 v242, -v180, v100, v242
    v_mul_f32 v241, v181, v93
    v_mul_f32 v243, v197, v93
    v_fmac_f32 v241, v197, v101
    v_fma_f32 v243, -v181, v101, v243
    v_cvt_pk_bf16_f32 v224, v240, v241
    v_cvt_pk_bf16_f32 v232, v242, v243
    v_mul_f32 v240, v182, v94
    v_mul_f32 v242, v198, v94
    v_fmac_f32 v240, v198, v102
    v_fma_f32 v242, -v182, v102, v242
    v_mul_f32 v241, v183, v95
    v_mul_f32 v243, v199, v95
    v_fmac_f32 v241, v199, v103
    v_fma_f32 v243, -v183, v103, v243
    v_cvt_pk_bf16_f32 v225, v240, v241
    v_cvt_pk_bf16_f32 v233, v242, v243
    v_mul_f32 v240, v184, v96
    v_mul_f32 v242, v200, v96
    v_fmac_f32 v240, v200, v104
    v_fma_f32 v242, -v184, v104, v242
    v_mul_f32 v241, v185, v97
    v_mul_f32 v243, v201, v97
    v_fmac_f32 v241, v201, v105
    v_fma_f32 v243, -v185, v105, v243
    v_cvt_pk_bf16_f32 v226, v240, v241
    v_cvt_pk_bf16_f32 v234, v242, v243
    v_mul_f32 v240, v186, v98
    v_mul_f32 v242, v202, v98
    v_fmac_f32 v240, v202, v106
    v_fma_f32 v242, -v186, v106, v242
    v_mul_f32 v241, v187, v99
    v_mul_f32 v243, v203, v99
    v_fmac_f32 v241, v203, v107
    v_fma_f32 v243, -v187, v107, v243
    v_cvt_pk_bf16_f32 v227, v240, v241
    v_cvt_pk_bf16_f32 v235, v242, v243
    s_nop 0
    v_mfma_f32_16x16x32_bf16 v[180:183], v[68:71], v[224:227], 0
    v_mfma_f32_16x16x32_bf16 v[196:199], v[68:71], v[232:235], 0
    v_mfma_f32_16x16x32_bf16 v[184:187], v[80:83], v[224:227], 0
    v_mfma_f32_16x16x32_bf16 v[200:203], v[88:91], v[232:235], 0
    v_mfma_f32_16x16x32_bf16 v[180:183], v[72:75], v[232:235], v[180:183]
    v_mfma_f32_16x16x32_bf16 v[196:199], v[76:79], v[224:227], v[196:199]
    v_mfma_f32_16x16x32_bf16 v[184:187], v[84:87], v[232:235], v[184:187]
    v_mfma_f32_16x16x32_bf16 v[200:203], v[84:87], v[224:227], v[200:203]
    v_mul_f32 v240, v188, v92
    v_mul_f32 v242, v204, v92
    v_fmac_f32 v240, v204, v100
    v_fma_f32 v242, -v188, v100, v242
    v_mul_f32 v241, v189, v93
    v_mul_f32 v243, v205, v93
    v_fmac_f32 v241, v205, v101
    v_fma_f32 v243, -v189, v101, v243
    v_cvt_pk_bf16_f32 v228, v240, v241
    v_cvt_pk_bf16_f32 v236, v242, v243
    v_mul_f32 v240, v190, v94
    v_mul_f32 v242, v206, v94
    v_fmac_f32 v240, v206, v102
    v_fma_f32 v242, -v190, v102, v242
    v_mul_f32 v241, v191, v95
    v_mul_f32 v243, v207, v95
    v_fmac_f32 v241, v207, v103
    v_fma_f32 v243, -v191, v103, v243
    v_cvt_pk_bf16_f32 v229, v240, v241
    v_cvt_pk_bf16_f32 v237, v242, v243
    v_mul_f32 v240, v192, v96
    v_mul_f32 v242, v208, v96
    v_fmac_f32 v240, v208, v104
    v_fma_f32 v242, -v192, v104, v242
    v_mul_f32 v241, v193, v97
    v_mul_f32 v243, v209, v97
    v_fmac_f32 v241, v209, v105
    v_fma_f32 v243, -v193, v105, v243
    v_cvt_pk_bf16_f32 v230, v240, v241
    v_cvt_pk_bf16_f32 v238, v242, v243
    v_mul_f32 v240, v194, v98
    v_mul_f32 v242, v210, v98
    v_fmac_f32 v240, v210, v106
    v_fma_f32 v242, -v194, v106, v242
    v_mul_f32 v241, v195, v99
    v_mul_f32 v243, v211, v99
    v_fmac_f32 v241, v211, v107
    v_fma_f32 v243, -v195, v107, v243
    v_cvt_pk_bf16_f32 v231, v240, v241
    v_cvt_pk_bf16_f32 v239, v242, v243
    s_nop 0
    v_mfma_f32_16x16x32_bf16 v[188:191], v[68:71], v[228:231], 0
    v_mfma_f32_16x16x32_bf16 v[204:207], v[68:71], v[236:239], 0
    v_mfma_f32_16x16x32_bf16 v[192:195], v[80:83], v[228:231], 0
    v_mfma_f32_16x16x32_bf16 v[208:211], v[88:91], v[236:239], 0
    v_mfma_f32_16x16x32_bf16 v[188:191], v[72:75], v[236:239], v[188:191]
    v_mfma_f32_16x16x32_bf16 v[204:207], v[76:79], v[228:231], v[204:207]
    v_mfma_f32_16x16x32_bf16 v[192:195], v[84:87], v[236:239], v[192:195]
    v_mfma_f32_16x16x32_bf16 v[208:211], v[84:87], v[228:231], v[208:211]
    s_cmp_eq_u32 s24, 0
    s_waitcnt vmcnt(0)
    s_cbranch_scc1 m_P_f0
    s_mov_b64 exec, 1
    ds_add_u32 v53, v54 offset:8
    s_mov_b64 exec, -1
    s_branch m_P_f1
m_P_f0:
    s_mov_b32 s98, 0x800000
m_P_s2:
    ds_read_b32 v8, v53 offset:8
    s_sub_u32 s98, s98, 1
    s_cbranch_scc1 m_P_s2_x
    s_waitcnt lgkmcnt(0)
    v_cmp_gt_u32 vcc, 3, v8
    s_cbranch_vccnz m_P_s2
m_P_s2_x:
    s_bfm_b64 exec, s45, 4
    buffer_store_dword v124, v123, s[20:23], s44 offen sc1
    s_mov_b64 exec, -1
    s_mov_b64 exec, 1
    ds_add_u32 v53, v54 offset:8
    s_mov_b64 exec, -1
m_P_f1:
    s_mov_b32 s50, 0x2400
    s_mov_b32 s51, 0x20000
    buffer_load_dwordx2 v[248:249], v56, s[48:51], s46 offen offset:0
    buffer_load_dwordx2 v[250:251], v56, s[48:51], s46 offen offset:32
    buffer_load_dwordx2 v[252:253], v56, s[48:51], s46 offen offset:64
    buffer_load_dwordx2 v[254:255], v56, s[48:51], s46 offen offset:96
    v_cvt_pk_bf16_f32 v164, v180, v181
    v_cvt_pk_bf16_f32 v165, v182, v183
    ds_write_b16 v44, v164 offset:0
    ds_write_b16_d16_hi v44, v164 offset:36
    ds_write_b16 v44, v165 offset:72
    ds_write_b16_d16_hi v44, v165 offset:108
    v_cvt_pk_bf16_f32 v172, v184, v185
    v_cvt_pk_bf16_f32 v173, v186, v187
    ds_write_b16 v45, v172 offset:108
    ds_write_b16_d16_hi v45, v172 offset:72
    ds_write_b16 v45, v173 offset:36
    ds_write_b16_d16_hi v45, v173 offset:0
    v_cvt_pk_bf16_f32 v166, v196, v197
    v_cvt_pk_bf16_f32 v167, v198, v199
    ds_write_b16 v44, v166 offset:608
    ds_write_b16_d16_hi v44, v166 offset:644
    ds_write_b16 v44, v167 offset:680
    ds_write_b16_d16_hi v44, v167 offset:716
    v_cvt_pk_bf16_f32 v174, v200, v201
    v_cvt_pk_bf16_f32 v175, v202, v203
    ds_write_b16 v45, v174 offset:716
    ds_write_b16_d16_hi v45, v174 offset:680
    ds_write_b16 v45, v175 offset:644
    ds_write_b16_d16_hi v45, v175 offset:608
    v_cvt_pk_bf16_f32 v168, v188, v189
    v_cvt_pk_bf16_f32 v169, v190, v191
    ds_write_b16 v44, v168 offset:2368
    ds_write_b16_d16_hi v44, v168 offset:2404
    ds_write_b16 v44, v169 offset:2440
    ds_write_b16_d16_hi v44, v169 offset:2476
    v_cvt_pk_bf16_f32 v176, v192, v193
    v_cvt_pk_bf16_f32 v177, v194, v195
    ds_write_b16 v45, v176 offset:2476
    ds_write_b16_d16_hi v45, v176 offset:2440
    ds_write_b16 v45, v177 offset:2404
    ds_write_b16_d16_hi v45, v177 offset:2368
    v_cvt_pk_bf16_f32 v170, v204, v205
    v_cvt_pk_bf16_f32 v171, v206, v207
    ds_write_b16 v44, v170 offset:2976
    ds_write_b16_d16_hi v44, v170 offset:3012
    ds_write_b16 v44, v171 offset:3048
    ds_write_b16_d16_hi v44, v171 offset:3084
    v_cvt_pk_bf16_f32 v178, v208, v209
    v_cvt_pk_bf16_f32 v179, v210, v211
    ds_write_b16 v45, v178 offset:3084
    ds_write_b16_d16_hi v45, v178 offset:3048
    ds_write_b16 v45, v179 offset:3012
    ds_write_b16_d16_hi v45, v179 offset:2976
    s_mov_b64 exec, 1
    ds_add_u32 v53, v54 offset:4
    s_mov_b64 exec, -1
    s_mov_b32 s98, 0x800000
m_P_s3:
    ds_read_b32 v8, v53 offset:4
    s_sub_u32 s98, s98, 1
    s_cbranch_scc1 m_P_s3_x
    s_waitcnt lgkmcnt(0)
    v_cmp_gt_u32 vcc, 8, v8
    s_cbranch_vccnz m_P_s3
m_P_s3_x:
    ds_read_b64_tr_b16 v[212:213], v47 offset:1152
    ds_read_b64_tr_b16 v[214:215], v47 offset:10624
    ds_read_b64_tr_b16 v[216:217], v47 offset:1664
    ds_read_b64_tr_b16 v[218:219], v47 offset:11136
    ds_read_b64_tr_b16 v[220:221], v47 offset:2048
    ds_read_b64_tr_b16 v[222:223], v47 offset:11520
    s_add_u32 s30, s24, 1
    s_bitcmp1_b32 s30, 1
    s_waitcnt lgkmcnt(4)
    buffer_store_dwordx4 v[212:215], v50, s[16:19], s40 offen sc1
    s_waitcnt lgkmcnt(2)
    buffer_store_dwordx4 v[216:219], v51, s[16:19], s40 offen sc1
    s_waitcnt lgkmcnt(0)
    s_cbranch_scc0 m_A_comp
    buffer_store_dwordx4 v[220:223], v52, s[16:19], s40 offen sc1
    s_branch m_A_comp
m_P_aux:
    s_load_dwordx2 s[52:53], s[0:1], 8
    s_load_dwordx2 s[44:45], s[0:1], 16
    s_load_dwordx2 s[8:9], s[0:1], 32
    v_mov_b64 v[4:5], 0
    v_mov_b64 v[6:7], 0
    v_mov_b32 v2, 163824
    ds_write_b128 v2, v[4:7]
    s_bfe_u32 s30, s2, 0x10006
    s_lshl_b32 s30, s30, 10
    s_bfe_u32 s31, s2, 0x10005
    s_lshl_b32 s31, s31, 7
    s_add_u32 s30, s30, s31
    s_bfe_u32 s31, s2, 0x20003
    s_lshl_b32 s31, s31, 8
    s_add_u32 s30, s30, s31
    s_bfe_u32 s31, s2, 0x10007
    s_lshl_b32 s31, s31, 4
    s_add_u32 s30, s30, s31
    s_and_b32 s33, s2, 7
    s_lshl_b32 s31, s33, 1
    s_add_u32 s30, s30, s31
    s_mul_i32 s30, s30, 578
    s_lshr_b32 s34, s2, 3
    s_mul_i32 s34, s34, 589824
    s_mul_i32 s31, s33, 9
    s_lshr_b32 s31, s31, 1
    s_lshl_b32 s31, s31, 8
    s_add_u32 s34, s34, s31
    s_cmp_eq_u32 s24, 5
    s_cbranch_scc1 m_P_aux5
    s_cmp_eq_u32 s24, 6
    s_cbranch_scc1 m_P_aux6
    s_cmp_eq_u32 s24, 7
    s_cbranch_scc1 m_P_aux7
m_P_aux4:
    v_lshlrev_b32 v4, 3, v1
    s_waitcnt lgkmcnt(0)
    s_mov_b32 s10, 0x1200000
    s_mov_b32 s11, 0x20000
    s_mov_b32 s54, 0x121000
    s_mov_b32 s55, 0x20000
    s_mov_b32 s46, 0x121000
    s_mov_b32 s47, 0x20000
    s_load_dword s96, s[28:29], s97
    s_barrier
    buffer_load_dwordx2 v[16:17], v4, s[52:55], s30 offen nt
    buffer_load_dwordx2 v[24:25], v4, s[44:47], s30 offen nt
    s_add_u32 s30, s30, 18496
    buffer_load_dwordx2 v[18:19], v4, s[52:55], s30 offen nt
    buffer_load_dwordx2 v[26:27], v4, s[44:47], s30 offen nt
    s_add_u32 s30, s30, 18496
    buffer_load_dwordx2 v[20:21], v4, s[52:55], s30 offen nt
    buffer_load_dwordx2 v[28:29], v4, s[44:47], s30 offen nt
    s_add_u32 s30, s30, 18496
    buffer_load_dwordx2 v[22:23], v4, s[52:55], s30 offen nt
    buffer_load_dwordx2 v[30:31], v4, s[44:47], s30 offen nt
    s_cmp_lt_u32 s2, 216
    s_cbranch_scc1 m_A0
    s_add_u32 s56, s28, 0x1b00000
    s_addc_u32 s57, s29, 0
    s_mov_b32 s58, 0x250000
    s_mov_b32 s59, 0x20000
    s_mov_b32 s60, 0x05040100
    s_mov_b32 s61, 0x07060302
    s_lshl_b32 s62, s2, 8
    v_lshlrev_b32 v2, 6, v1
    v_add_u32 v2, 118784, v2
    v_lshlrev_b32 v3, 4, v1
    v_add_u32 v3, 118784, v3
    v_lshrrev_b32 v5, 3, v1
    v_lshlrev_b32 v5, 16, v5
    v_and_b32 v6, 7, v1
    v_xor_b32 v6, s33, v6
    v_lshl_add_u32 v8, v6, 4, v5
    v_add_u32 v9, 524288, v8
    v_add_u32 v10, 1048576, v8
    v_add_u32 v11, 1572864, v8
    s_waitcnt vmcnt(0)
    v_perm_b32 v32, v24, v16, s60
    v_perm_b32 v33, v26, v18, s60
    v_perm_b32 v34, v28, v20, s60
    v_perm_b32 v35, v30, v22, s60
    ds_write_b128 v2, v[32:35] offset:0
    v_perm_b32 v36, v24, v16, s61
    v_perm_b32 v37, v26, v18, s61
    v_perm_b32 v38, v28, v20, s61
    v_perm_b32 v39, v30, v22, s61
    ds_write_b128 v2, v[36:39] offset:16
    v_perm_b32 v40, v25, v17, s60
    v_perm_b32 v41, v27, v19, s60
    v_perm_b32 v42, v29, v21, s60
    v_perm_b32 v43, v31, v23, s60
    ds_write_b128 v2, v[40:43] offset:32
    v_perm_b32 v44, v25, v17, s61
    v_perm_b32 v45, v27, v19, s61
    v_perm_b32 v46, v29, v21, s61
    v_perm_b32 v47, v31, v23, s61
    ds_write_b128 v2, v[44:47] offset:48
    ds_read_b128 v[16:19], v3 offset:0
    ds_read_b128 v[20:23], v3 offset:1024
    ds_read_b128 v[24:27], v3 offset:2048
    ds_read_b128 v[28:31], v3 offset:3072
    s_waitcnt lgkmcnt(0)
    v_mov_b32 v12, 163824
    s_mov_b32 s98, 0x800000
m_Pf4_sg:
    ds_read_b32 v13, v12 offset:8
    s_sub_u32 s98, s98, 1
    s_cbranch_scc1 m_Pf4_sg_x
    s_waitcnt lgkmcnt(0)
    v_cmp_gt_u32 vcc, 4, v13
    s_cbranch_vccnz m_Pf4_sg
m_Pf4_sg_x:
    s_waitcnt lgkmcnt(0)
    s_mul_i32 s96, s96, 0x9e3779b1
    s_add_u32 s96, s96, 0x7f4a7c15
    buffer_store_dwordx4 v[16:19], v8, s[56:59], s62 offen offset:0 sc1
    buffer_store_dwordx4 v[20:23], v9, s[56:59], s62 offen offset:0 sc1
    buffer_store_dwordx4 v[24:27], v10, s[56:59], s62 offen offset:0 sc1
    buffer_store_dwordx4 v[28:31], v11, s[56:59], s62 offen offset:0 sc1
    s_branch m_A_comp
m_P_aux5:
    v_lshlrev_b32 v4, 3, v1
    s_add_u32 s30, s30, 578
    s_waitcnt lgkmcnt(0)
    s_mov_b32 s10, 0x1200000
    s_mov_b32 s11, 0x20000
    s_mov_b32 s54, 0x121000
    s_mov_b32 s55, 0x20000
    s_mov_b32 s46, 0x121000
    s_mov_b32 s47, 0x20000
    s_load_dword s96, s[28:29], s97
    s_barrier
    buffer_load_dwordx2 v[16:17], v4, s[52:55], s30 offen nt
    buffer_load_dwordx2 v[24:25], v4, s[44:47], s30 offen nt
    s_add_u32 s30, s30, 18496
    buffer_load_dwordx2 v[18:19], v4, s[52:55], s30 offen nt
    buffer_load_dwordx2 v[26:27], v4, s[44:47], s30 offen nt
    s_add_u32 s30, s30, 18496
    buffer_load_dwordx2 v[20:21], v4, s[52:55], s30 offen nt
    buffer_load_dwordx2 v[28:29], v4, s[44:47], s30 offen nt
    s_add_u32 s30, s30, 18496
    buffer_load_dwordx2 v[22:23], v4, s[52:55], s30 offen nt
    buffer_load_dwordx2 v[30:31], v4, s[44:47], s30 offen nt
    s_cmp_lt_u32 s2, 216
    s_cbranch_scc1 m_A0
    s_add_u32 s56, s28, 0x1b00000
    s_addc_u32 s57, s29, 0
    s_mov_b32 s58, 0x250000
    s_mov_b32 s59, 0x20000
    s_mov_b32 s60, 0x05040100
    s_mov_b32 s61, 0x07060302
    s_lshl_b32 s62, s2, 8
    v_lshlrev_b32 v2, 6, v1
    v_add_u32 v2, 122880, v2
    v_lshlrev_b32 v3, 4, v1
    v_add_u32 v3, 122880, v3
    v_lshrrev_b32 v5, 3, v1
    v_lshlrev_b32 v5, 16, v5
    v_and_b32 v6, 7, v1
    v_xor_b32 v6, s33, v6
    v_lshl_add_u32 v8, v6, 4, v5
    v_add_u32 v9, 524288, v8
    v_add_u32 v10, 1048576, v8
    v_add_u32 v11, 1572864, v8
    s_waitcnt vmcnt(0)
    v_perm_b32 v32, v24, v16, s60
    v_perm_b32 v33, v26, v18, s60
    v_perm_b32 v34, v28, v20, s60
    v_perm_b32 v35, v30, v22, s60
    ds_write_b128 v2, v[32:35] offset:0
    v_perm_b32 v36, v24, v16, s61
    v_perm_b32 v37, v26, v18, s61
    v_perm_b32 v38, v28, v20, s61
    v_perm_b32 v39, v30, v22, s61
    ds_write_b128 v2, v[36:39] offset:16
    v_perm_b32 v40, v25, v17, s60
    v_perm_b32 v41, v27, v19, s60
    v_perm_b32 v42, v29, v21, s60
    v_perm_b32 v43, v31, v23, s60
    ds_write_b128 v2, v[40:43] offset:32
    v_perm_b32 v44, v25, v17, s61
    v_perm_b32 v45, v27, v19, s61
    v_perm_b32 v46, v29, v21, s61
    v_perm_b32 v47, v31, v23, s61
    ds_write_b128 v2, v[44:47] offset:48
    ds_read_b128 v[16:19], v3 offset:0
    ds_read_b128 v[20:23], v3 offset:1024
    ds_read_b128 v[24:27], v3 offset:2048
    ds_read_b128 v[28:31], v3 offset:3072
    s_waitcnt lgkmcnt(0)
    v_mov_b32 v12, 163824
    s_mov_b32 s98, 0x800000
m_Pf5_sg:
    ds_read_b32 v13, v12 offset:8
    s_sub_u32 s98, s98, 1
    s_cbranch_scc1 m_Pf5_sg_x
    s_waitcnt lgkmcnt(0)
    v_cmp_gt_u32 vcc, 4, v13
    s_cbranch_vccnz m_Pf5_sg
m_Pf5_sg_x:
    s_waitcnt lgkmcnt(0)
    s_mul_i32 s96, s96, 0x9e3779b1
    s_add_u32 s96, s96, 0x7f4a7c15
    buffer_store_dwordx4 v[16:19], v8, s[56:59], s62 offen offset:128 sc1
    buffer_store_dwordx4 v[20:23], v9, s[56:59], s62 offen offset:128 sc1
    buffer_store_dwordx4 v[24:27], v10, s[56:59], s62 offen offset:128 sc1
    buffer_store_dwordx4 v[28:31], v11, s[56:59], s62 offen offset:128 sc1
    s_branch m_A_comp
m_P_aux6:
    v_and_b32 v4, 15, v1
    v_lshlrev_b32 v4, 3, v4
    v_min_u32 v4, 58, v4
    v_lshrrev_b32 v5, 4, v1
    v_mul_u32_u24 v5, 578, v5
    v_add3_u32 v4, v4, v5, 64
    s_add_u32 s30, s30, 448
    s_waitcnt lgkmcnt(0)
    s_mov_b32 s10, 0x1200000
    s_mov_b32 s11, 0x20000
    s_mov_b32 s54, 0x121000
    s_mov_b32 s55, 0x20000
    s_mov_b32 s46, 0x121000
    s_mov_b32 s47, 0x20000
    s_load_dword s96, s[28:29], s97
    s_barrier
    s_mov_b32 exec_hi, 0
    buffer_load_dwordx2 v[16:17], v4, s[52:55], s30 offen nt
    buffer_load_dwordx2 v[24:25], v4, s[44:47], s30 offen nt
    s_add_u32 s30, s30, 18496
    buffer_load_dwordx2 v[18:19], v4, s[52:55], s30 offen nt
    buffer_load_dwordx2 v[26:27], v4, s[44:47], s30 offen nt
    s_add_u32 s30, s30, 18496
    buffer_load_dwordx2 v[20:21], v4, s[52:55], s30 offen nt
    buffer_load_dwordx2 v[28:29], v4, s[44:47], s30 offen nt
    s_add_u32 s30, s30, 18496
    buffer_load_dwordx2 v[22:23], v4, s[52:55], s30 offen nt
    buffer_load_dwordx2 v[30:31], v4, s[44:47], s30 offen nt
    s_mov_b64 exec, -1
    s_cmp_lt_u32 s2, 216
    s_cbranch_scc1 m_A0
    s_add_u32 s56, s28, 0x1b00000
    s_addc_u32 s57, s29, 0
    s_mov_b32 s58, 0x250000
    s_mov_b32 s59, 0x20000
    s_mov_b32 s60, 0x05040100
    s_mov_b32 s61, 0x07060302
    s_lshl_b32 s62, s2, 8
    v_lshlrev_b32 v2, 6, v1
    v_add_u32 v2, 126976, v2
    v_lshlrev_b32 v3, 4, v1
    v_add_u32 v3, 126976, v3
    v_lshrrev_b32 v5, 3, v1
    v_lshlrev_b32 v5, 16, v5
    v_and_b32 v6, 7, v1
    v_xor_b32 v6, s33, v6
    v_lshl_add_u32 v8, v6, 4, v5
    v_add_u32 v8, 2097152, v8
    s_waitcnt vmcnt(0)
    v_perm_b32 v32, v24, v16, s60
    v_perm_b32 v33, v26, v18, s60
    v_perm_b32 v34, v28, v20, s60
    v_perm_b32 v35, v30, v22, s60
    ds_write_b128 v2, v[32:35] offset:0
    v_perm_b32 v36, v24, v16, s61
    v_perm_b32 v37, v26, v18, s61
    v_perm_b32 v38, v28, v20, s61
    v_perm_b32 v39, v30, v22, s61
    ds_write_b128 v2, v[36:39] offset:16
    v_perm_b32 v40, v25, v17, s60
    v_perm_b32 v41, v27, v19, s60
    v_perm_b32 v42, v29, v21, s60
    v_perm_b32 v43, v31, v23, s60
    ds_write_b128 v2, v[40:43] offset:32
    v_perm_b32 v44, v25, v17, s61
    v_perm_b32 v45, v27, v19, s61
    v_perm_b32 v46, v29, v21, s61
    v_perm_b32 v47, v31, v23, s61
    ds_write_b128 v2, v[44:47] offset:48
    ds_read_b128 v[16:19], v3 offset:0
    ds_read_b128 v[20:23], v3 offset:1024
    s_waitcnt lgkmcnt(0)
    v_mov_b32 v12, 163824
    s_mov_b32 s98, 0x800000
m_Pf6_sg:
    ds_read_b32 v13, v12 offset:8
    s_sub_u32 s98, s98, 1
    s_cbranch_scc1 m_Pf6_sg_x
    s_waitcnt lgkmcnt(0)
    v_cmp_gt_u32 vcc, 4, v13
    s_cbranch_vccnz m_Pf6_sg
m_Pf6_sg_x:
    s_waitcnt lgkmcnt(0)
    s_mul_i32 s96, s96, 0x9e3779b1
    s_add_u32 s96, s96, 0x7f4a7c15
    buffer_store_dwordx4 v[16:19], v8, s[56:59], s62 offen offset:0 sc1
    buffer_store_dwordx4 v[20:23], v8, s[56:59], s62 offen offset:128 sc1
    s_branch m_A_comp
m_P_aux7:
    v_add_u32 v5, 0, v1
    v_mul_u32_u24 v6, 6554, v5
    v_lshrrev_b32 v6, 16, v6
    v_mul_u32_u24 v6, 7936, v6
    v_lshl_add_u32 v5, v5, 7, v6
    v_add_u32 v48, s34, v5
    v_add_u32 v5, 64, v1
    v_mul_u32_u24 v6, 6554, v5
    v_lshrrev_b32 v6, 16, v6
    v_mul_u32_u24 v6, 7936, v6
    v_lshl_add_u32 v5, v5, 7, v6
    v_add_u32 v49, s34, v5
    s_waitcnt lgkmcnt(0)
    s_mov_b32 s10, 0x1200000
    s_mov_b32 s11, 0x20000
    s_mov_b32 s54, 0x121000
    s_mov_b32 s55, 0x20000
    s_mov_b32 s46, 0x121000
    s_mov_b32 s47, 0x20000
    s_load_dword s96, s[28:29], s97
    s_barrier
    buffer_load_dword v127, v48, s[8:11], 0 offen
    buffer_load_dword v127, v49, s[8:11], 0 offen
    s_cmp_lt_u32 s2, 216
    s_cbranch_scc1 m_A0
    v_mov_b32 v12, 163824
    s_mov_b32 s98, 0x800000
m_Pf7_sg:
    ds_read_b32 v13, v12 offset:8
    s_sub_u32 s98, s98, 1
    s_cbranch_scc1 m_Pf7_sg_x
    s_waitcnt lgkmcnt(0)
    v_cmp_gt_u32 vcc, 4, v13
    s_cbranch_vccnz m_Pf7_sg
m_Pf7_sg_x:
    s_waitcnt lgkmcnt(0)
    s_mul_i32 s96, s96, 0x9e3779b1
    s_add_u32 s96, s96, 0x7f4a7c15
    s_branch m_A_comp
m_A0:
    s_mov_b32 s19, s24
    s_and_b32 s33, s2, 7
    s_lshr_b32 s34, s2, 3
    s_mov_b64 s[40:41], s[28:29]
    s_mul_i32 s35, s33, 27
    s_add_u32 s35, s35, s34
    s_mul_i32 s36, s35, 43691
    s_lshr_b32 s36, s36, 18
    s_mul_i32 s37, s36, 6
    s_sub_u32 s37, s35, s37
    s_and_b32 s38, s36, 63
    s_lshl_b32 s16, s38, 8
    s_mul_i32 s17, s37, 6144
    s_mov_b32 s18, 64
    v_and_b32 v104, 63, v0
    s_sub_u32 s22, s19, 4
    s_mul_i32 s23, s22, 4718592
    s_mov_b32 s24, 589824
    v_lshrrev_b32 v105, 4, v104
    v_add_u32 v105, 0, v105
    v_bfe_u32 v106, v104, 1, 3
    v_xor_b32 v106, v106, v105
    v_mul_lo_u32 v105, v105, s24
    v_lshl_add_u32 v105, v106, 5, v105
    v_and_b32 v106, 1, v104
    v_lshl_add_u32 v105, v106, 4, v105
    v_add_u32 v108, s23, v105
    v_lshrrev_b32 v105, 4, v104
    v_add_u32 v105, 4, v105
    v_bfe_u32 v106, v104, 1, 3
    v_xor_b32 v106, v106, v105
    v_mul_lo_u32 v105, v105, s24
    v_lshl_add_u32 v105, v106, 5, v105
    v_and_b32 v106, 1, v104
    v_lshl_add_u32 v105, v106, 4, v105
    v_add_u32 v109, s23, v105
    v_subrev_u32 v109, 1024, v109
    v_lshlrev_b32 v110, 4, v104
    s_cmp_eq_u32 s22, 1
    s_cbranch_scc1 m_A_ld1
    s_cmp_eq_u32 s22, 2
    s_cbranch_scc1 m_A_ld2
    s_cmp_eq_u32 s22, 3
    s_cbranch_scc1 m_A_ld3
m_A_ld0:
    s_add_u32 s20, s17, 36864
    s_load_dwordx2 s[4:5], s[0:1], 48
    s_lshl_b32 s26, s34, 8
    s_mov_b32 s27, 52429
    s_add_u32 s26, s26, 6720
    v_add_u32 v102, s26, v1
    v_mul_u32_u24 v103, s27, v102
    v_lshrrev_b32 v103, 19, v103
    v_mul_u32_u24 v98, 10, v103
    v_sub_u32 v102, v102, v98
    v_and_b32 v98, 31, v103
    v_lshrrev_b32 v103, 5, v103
    v_min_u32 v103, 63, v103
    v_lshl_add_u32 v103, v98, 6, v103
    v_mul_u32_u24 v103, 9216, v103
    v_lshl_add_u32 v98, v102, 7, v103
    v_add_u32 v98, s31, v98
    s_add_u32 s26, s26, 6912
    v_add_u32 v102, s26, v1
    v_mul_u32_u24 v103, s27, v102
    v_lshrrev_b32 v103, 19, v103
    v_mul_u32_u24 v99, 10, v103
    v_sub_u32 v102, v102, v99
    v_and_b32 v99, 31, v103
    v_lshrrev_b32 v103, 5, v103
    v_min_u32 v103, 63, v103
    v_lshl_add_u32 v103, v99, 6, v103
    v_mul_u32_u24 v103, 9216, v103
    v_lshl_add_u32 v99, v102, 7, v103
    v_add_u32 v99, s31, v99
    s_lshr_b32 s27, s33, 1
    s_mov_b32 s26, 0
    s_cmp_eq_u32 s27, 1
    s_cselect_b32 s26, 72, s26
    s_cmp_eq_u32 s27, 2
    s_cselect_b32 s26, 144, s26
    s_cmp_eq_u32 s27, 3
    s_cselect_b32 s26, 216, s26
    s_add_u32 s26, s26, s34
    s_lshl_b32 s26, s26, 5
    s_and_b32 s27, s33, 1
    s_add_u32 s26, s26, s27
    s_lshl_b32 s26, s26, 11
    s_add_u32 s26, s26, 0
    v_and_b32 v102, 15, v1
    v_lshrrev_b32 v103, 4, v1
    v_lshl_add_u32 v102, v103, 5, v102
    v_lshl_add_u32 v100, v102, 7, s26
    s_mul_i32 s26, s34, 77
    s_lshr_b32 s26, s26, 8
    s_add_u32 s26, s26, 1
    s_mov_b32 s27, 2
    s_mov_b32 m0, 0
    s_mov_b32 s12, s40
    s_mov_b32 s13, s41
    s_mov_b32 s14, 0x240000
    s_mov_b32 s15, 0x20000
    s_add_u32 s56, s28, 0x1b00000
    s_addc_u32 s57, s29, 0
    s_mov_b32 s58, 0x250000
    s_mov_b32 s59, 0x20000
    s_mov_b32 s60, 0x05040100
    s_mov_b32 s61, 0x07060302
    s_lshl_b32 s62, s2, 8
    v_lshlrev_b32 v2, 6, v1
    v_add_u32 v2, 118784, v2
    v_lshlrev_b32 v3, 4, v1
    v_add_u32 v3, 118784, v3
    v_lshrrev_b32 v5, 3, v1
    v_lshlrev_b32 v5, 16, v5
    v_and_b32 v6, 7, v1
    v_xor_b32 v6, s33, v6
    v_lshl_add_u32 v8, v6, 4, v5
    v_add_u32 v9, 524288, v8
    v_add_u32 v10, 1048576, v8
    v_add_u32 v11, 1572864, v8
    s_lshl2_add_u32 s38, s2, 0
    s_add_u32 s48, s28, 0x800000
    s_addc_u32 s49, s29, 0
    s_mov_b32 s50, 0x5b2000
    s_mov_b32 s51, 0x20000
    s_mul_i32 s39, s38, 1821
    s_lshr_b32 s39, s39, 16
    s_mul_i32 s42, s39, 36
    s_sub_u32 s42, s38, s42
    s_lshr_b32 s43, s42, 1
    s_lshl_b32 s43, s43, 5
    s_and_b32 s42, s42, 1
    s_lshl2_add_u32 s43, s42, s43
    v_bfe_u32 v60, v1, 2, 2
    v_and_b32 v61, 3, v1
    v_lshl_add_u32 v60, v60, 3, v61
    v_add_u32 v62, s43, v60
    s_lshl_b32 s42, s39, 4
    v_lshrrev_b32 v60, 4, v1
    v_lshl_add_u32 v63, v60, 1, s42
    v_add_u32 v60, 0, v63
    v_mul_u32_u24 v60, v60, v62
    v_cvt_f32_u32 v60, v60
    v_mul_f32 v60, 0x3ae38e39, v60
    v_fract_f32 v68, v60
    v_add_u32 v60, 1, v63
    v_mul_u32_u24 v60, v60, v62
    v_cvt_f32_u32 v60, v60
    v_mul_f32 v60, 0x3ae38e39, v60
    v_fract_f32 v69, v60
    v_add_u32 v60, 8, v63
    v_mul_u32_u24 v60, v60, v62
    v_cvt_f32_u32 v60, v60
    v_mul_f32 v60, 0x3ae38e39, v60
    v_fract_f32 v70, v60
    v_add_u32 v60, 9, v63
    v_mul_u32_u24 v60, v60, v62
    v_cvt_f32_u32 v60, v60
    v_mul_f32 v60, 0x3ae38e39, v60
    v_fract_f32 v71, v60
    v_cos_f32 v72, v68
    v_sin_f32 v73, v68
    v_cos_f32 v74, v69
    v_sin_f32 v75, v69
    v_cos_f32 v76, v70
    v_sin_f32 v77, v70
    v_cos_f32 v78, v71
    v_sin_f32 v79, v71
    v_cvt_pk_bf16_f32 v64, v72, v73
    v_cvt_pk_bf16_f32 v65, v74, v75
    v_cvt_pk_bf16_f32 v66, v76, v77
    v_cvt_pk_bf16_f32 v67, v78, v79
    v_lshlrev_b32 v60, 31, v62
    v_or_b32 v60, 0x3f003f00, v60
    v_cmp_eq_u32 vcc, 0, v63
    s_nop 1
    v_cndmask_b32 v64, v64, v60, vcc
    s_add_u32 s38, s38, 5184
    s_lshl_b32 s38, s38, 10
    v_lshlrev_b32 v60, 4, v1
    s_waitcnt vmcnt(0)
    v_perm_b32 v32, v24, v16, s60
    v_perm_b32 v33, v26, v18, s60
    v_perm_b32 v34, v28, v20, s60
    v_perm_b32 v35, v30, v22, s60
    ds_write_b128 v2, v[32:35] offset:0
    v_perm_b32 v36, v24, v16, s61
    v_perm_b32 v37, v26, v18, s61
    v_perm_b32 v38, v28, v20, s61
    v_perm_b32 v39, v30, v22, s61
    ds_write_b128 v2, v[36:39] offset:16
    v_perm_b32 v40, v25, v17, s60
    v_perm_b32 v41, v27, v19, s60
    v_perm_b32 v42, v29, v21, s60
    v_perm_b32 v43, v31, v23, s60
    ds_write_b128 v2, v[40:43] offset:32
    v_perm_b32 v44, v25, v17, s61
    v_perm_b32 v45, v27, v19, s61
    v_perm_b32 v46, v29, v21, s61
    v_perm_b32 v47, v31, v23, s61
    ds_write_b128 v2, v[44:47] offset:48
    ds_read_b128 v[16:19], v3 offset:0
    ds_read_b128 v[20:23], v3 offset:1024
    ds_read_b128 v[24:27], v3 offset:2048
    ds_read_b128 v[28:31], v3 offset:3072
    s_waitcnt lgkmcnt(0)
    v_mov_b32 v12, 163824
    s_mov_b32 s98, 0x800000
m_Ag4_sg:
    ds_read_b32 v13, v12 offset:8
    s_sub_u32 s98, s98, 1
    s_cbranch_scc1 m_Ag4_sg_x
    s_waitcnt lgkmcnt(0)
    v_cmp_gt_u32 vcc, 4, v13
    s_cbranch_vccnz m_Ag4_sg
m_Ag4_sg_x:
    s_waitcnt lgkmcnt(0)
    s_mul_i32 s96, s96, 0x9e3779b1
    s_add_u32 s96, s96, 0x7f4a7c15
    buffer_load_dwordx4 v108, s[8:11], s16 offen lds
    buffer_load_dwordx4 v109, s[8:11], s16 offen offset:1024 lds
    s_add_u32 s16, s16, 9216
    s_mov_b32 m0, 14336
    s_nop 0
    buffer_load_dwordx4 v108, s[8:11], s16 offen lds
    buffer_load_dwordx4 v109, s[8:11], s16 offen offset:1024 lds
    s_add_u32 s16, s16, 9216
    s_mov_b32 m0, 28672
    s_nop 0
    buffer_load_dwordx4 v108, s[8:11], s16 offen lds
    buffer_load_dwordx4 v109, s[8:11], s16 offen offset:1024 lds
    s_add_u32 s16, s16, 9216
    s_mov_b32 m0, 43008
    s_nop 0
    buffer_load_dwordx4 v108, s[8:11], s16 offen lds
    buffer_load_dwordx4 v109, s[8:11], s16 offen offset:1024 lds
    s_add_u32 s16, s16, 9216
    s_mov_b32 m0, 57344
    s_nop 0
    buffer_load_dwordx4 v108, s[8:11], s16 offen lds
    buffer_load_dwordx4 v109, s[8:11], s16 offen offset:1024 lds
    s_add_u32 s16, s16, 9216
    s_mov_b32 m0, 71680
    s_nop 0
    buffer_load_dwordx4 v108, s[8:11], s16 offen lds
    buffer_load_dwordx4 v109, s[8:11], s16 offen offset:1024 lds
    s_add_u32 s16, s16, 9216
    s_mov_b32 m0, 86016
    s_nop 0
    buffer_load_dwordx4 v108, s[8:11], s16 offen lds
    buffer_load_dwordx4 v109, s[8:11], s16 offen offset:1024 lds
    s_add_u32 s16, s16, 9216
    s_mov_b32 m0, 100352
    s_nop 0
    buffer_load_dwordx4 v108, s[8:11], s16 offen lds
    buffer_load_dwordx4 v109, s[8:11], s16 offen offset:1024 lds
    s_add_u32 s16, s16, 9216
    s_mov_b32 m0, 8192
    v_mov_b32 v96, 163824
    s_cmp_ge_u32 s2, 162
    s_cbranch_scc1 m_Ag4_nomt
    buffer_store_dwordx4 v[64:67], v60, s[48:51], s38 offen sc1
m_Ag4_nomt:
    buffer_store_dwordx4 v[16:19], v8, s[56:59], s62 offen offset:0 sc1
    buffer_store_dwordx4 v[20:23], v9, s[56:59], s62 offen offset:0 sc1
    buffer_store_dwordx4 v[24:27], v10, s[56:59], s62 offen offset:0 sc1
    buffer_store_dwordx4 v[28:31], v11, s[56:59], s62 offen offset:0 sc1
    s_add_u32 s48, s40, 0x310000
    s_addc_u32 s49, s41, 0
    s_mov_b32 s50, 0xa8000
    s_mov_b32 s51, 0x20000
    v_lshlrev_b32 v105, 7, v104
    s_and_b32 s52, s2, 31
    s_lshl_b32 s52, s52, 13
    s_add_u32 s52, s52, 425984
    s_bfm_b64 exec, 48, 0
    s_mov_b32 s98, 0x80000
m_A_pp:
    v_mov_b32 v106, 0
    buffer_atomic_or v106, v105, s[48:51], s52 offen sc0 sc1
    s_sub_u32 s98, s98, 1
    s_cbranch_scc1 m_A_pp_x
    s_waitcnt vmcnt(0)
    v_cmp_ne_u32 vcc, s96, v106
    s_nop 0
    s_and_b64 exec, exec, vcc
    s_cbranch_scc1 m_A_pp
m_A_pp_x:
    s_mov_b64 exec, -1
    v_mov_b32 v97, 2
    ds_write_b32 v96, v97
    buffer_load_dwordx4 v110, s[12:15], s17 offen offset:0 lds
    buffer_load_dwordx4 v110, s[12:15], s17 offen offset:1024 lds
    s_mov_b32 m0, 22528
    s_add_u32 s17, s17, 73728
    buffer_load_dwordx4 v110, s[12:15], s20 offen offset:0 lds
    s_mov_b32 m0, 36864
    s_add_u32 s20, s20, 73728
    buffer_load_dwordx4 v110, s[12:15], s17 offen offset:0 lds
    buffer_load_dwordx4 v110, s[12:15], s17 offen offset:1024 lds
    s_mov_b32 m0, 51200
    s_add_u32 s17, s17, 73728
    buffer_load_dwordx4 v110, s[12:15], s20 offen offset:0 lds
    s_mov_b32 m0, 65536
    s_add_u32 s20, s20, 73728
    buffer_load_dwordx4 v110, s[12:15], s17 offen offset:0 lds
    buffer_load_dwordx4 v110, s[12:15], s17 offen offset:1024 lds
    s_mov_b32 m0, 79872
    s_add_u32 s17, s17, 73728
    buffer_load_dwordx4 v110, s[12:15], s20 offen offset:0 lds
    s_mov_b32 m0, 94208
    s_add_u32 s20, s20, 73728
    buffer_load_dwordx4 v110, s[12:15], s17 offen offset:0 lds
    buffer_load_dwordx4 v110, s[12:15], s17 offen offset:1024 lds
    s_mov_b32 m0, 108544
    s_add_u32 s17, s17, 73728
    buffer_load_dwordx4 v110, s[12:15], s20 offen offset:0 lds
    s_mov_b32 m0, 114688
    s_mov_b32 s44, s8
    s_mov_b32 s45, s9
    s_mov_b32 s46, 0x1200000
    s_mov_b32 s47, 0x20000
    s_sub_u32 s26, s26, 1
    s_cbranch_scc0 m_A_tb_1
    buffer_load_dword v127, v98, s[44:47], 0 offen
    s_cmp_eq_u32 s27, 1
    s_cselect_b64 s[44:45], s[4:5], s[44:45]
    s_sub_u32 s27, s27, 1
    s_cselect_b32 s26, 1000, 8
    v_mov_b32 v98, v99
    v_mov_b32 v99, v100
m_A_tb_1:
    s_waitcnt vmcnt(7)
    s_barrier
    buffer_load_dwordx4 v108, s[8:11], s16 offen lds
    buffer_load_dwordx4 v109, s[8:11], s16 offen offset:1024 lds
    s_mov_b32 m0, 122880
    s_add_u32 s16, s16, 9216
    s_add_u32 s20, s20, 73728
    buffer_load_dwordx4 v110, s[12:15], s17 offen offset:0 lds
    buffer_load_dwordx4 v110, s[12:15], s17 offen offset:1024 lds
    s_mov_b32 m0, 129024
    s_nop 0
    buffer_load_dwordx4 v108, s[8:11], s16 offen lds
    buffer_load_dwordx4 v109, s[8:11], s16 offen offset:1024 lds
    s_mov_b32 m0, 137216
    s_add_u32 s16, s16, 9216
    s_add_u32 s17, s17, 73728
    buffer_load_dwordx4 v110, s[12:15], s20 offen offset:0 lds
    s_mov_b32 m0, 0
    s_sub_u32 s26, s26, 1
    s_cbranch_scc0 m_A_tb_2
    buffer_load_dword v127, v98, s[44:47], 0 offen
    s_cmp_eq_u32 s27, 1
    s_cselect_b64 s[44:45], s[4:5], s[44:45]
    s_sub_u32 s27, s27, 1
    s_cselect_b32 s26, 1000, 8
    v_mov_b32 v98, v99
    v_mov_b32 v99, v100
m_A_tb_2:
    s_waitcnt vmcnt(11)
    s_barrier
    buffer_load_dwordx4 v108, s[8:11], s16 offen lds
    buffer_load_dwordx4 v109, s[8:11], s16 offen offset:1024 lds
    s_mov_b32 m0, 8192
    s_add_u32 s16, s16, 9216
    s_add_u32 s20, s20, 73728
    buffer_load_dwordx4 v110, s[12:15], s17 offen offset:0 lds
    buffer_load_dwordx4 v110, s[12:15], s17 offen offset:1024 lds
    s_mov_b32 m0, 14336
    s_nop 0
    buffer_load_dwordx4 v108, s[8:11], s16 offen lds
    buffer_load_dwordx4 v109, s[8:11], s16 offen offset:1024 lds
    s_mov_b32 m0, 22528
    s_add_u32 s16, s16, 9216
    s_add_u32 s17, s17, 73728
    buffer_load_dwordx4 v110, s[12:15], s20 offen offset:0 lds
    s_mov_b32 m0, 28672
    s_sub_u32 s26, s26, 1
    s_cbranch_scc0 m_A_tb_3
    buffer_load_dword v127, v98, s[44:47], 0 offen
    s_cmp_eq_u32 s27, 1
    s_cselect_b64 s[44:45], s[4:5], s[44:45]
    s_sub_u32 s27, s27, 1
    s_cselect_b32 s26, 1000, 8
    v_mov_b32 v98, v99
    v_mov_b32 v99, v100
m_A_tb_3:
    s_waitcnt vmcnt(15)
    s_barrier
    buffer_load_dwordx4 v108, s[8:11], s16 offen lds
    buffer_load_dwordx4 v109, s[8:11], s16 offen offset:1024 lds
    s_mov_b32 m0, 36864
    s_add_u32 s16, s16, 9216
    s_add_u32 s20, s20, 73728
    buffer_load_dwordx4 v110, s[12:15], s17 offen offset:0 lds
    buffer_load_dwordx4 v110, s[12:15], s17 offen offset:1024 lds
    s_mov_b32 m0, 43008
    s_nop 0
    buffer_load_dwordx4 v108, s[8:11], s16 offen lds
    buffer_load_dwordx4 v109, s[8:11], s16 offen offset:1024 lds
    s_mov_b32 m0, 51200
    s_add_u32 s16, s16, 9216
    s_add_u32 s17, s17, 73728
    buffer_load_dwordx4 v110, s[12:15], s20 offen offset:0 lds
    s_mov_b32 m0, 57344
    s_sub_u32 s26, s26, 1
    s_cbranch_scc0 m_A_tb_4
    buffer_load_dword v127, v98, s[44:47], 0 offen
    s_cmp_eq_u32 s27, 1
    s_cselect_b64 s[44:45], s[4:5], s[44:45]
    s_sub_u32 s27, s27, 1
    s_cselect_b32 s26, 1000, 8
    v_mov_b32 v98, v99
    v_mov_b32 v99, v100
m_A_tb_4:
    s_mov_b32 s21, 5
m_A_main_5:
    s_waitcnt vmcnt(17)
    s_barrier
    buffer_load_dwordx4 v108, s[8:11], s16 offen lds
    buffer_load_dwordx4 v109, s[8:11], s16 offen offset:1024 lds
    s_mov_b32 m0, 65536
    s_add_u32 s16, s16, 9216
    s_add_u32 s20, s20, 73728
    buffer_load_dwordx4 v110, s[12:15], s17 offen offset:0 lds
    buffer_load_dwordx4 v110, s[12:15], s17 offen offset:1024 lds
    s_mov_b32 m0, 71680
    s_nop 0
    buffer_load_dwordx4 v108, s[8:11], s16 offen lds
    buffer_load_dwordx4 v109, s[8:11], s16 offen offset:1024 lds
    s_mov_b32 m0, 79872
    s_add_u32 s16, s16, 9216
    s_add_u32 s17, s17, 73728
    buffer_load_dwordx4 v110, s[12:15], s20 offen offset:0 lds
    s_mov_b32 m0, 86016
    s_sub_u32 s26, s26, 1
    s_cbranch_scc0 m_A_tb_6
    buffer_load_dword v127, v98, s[44:47], 0 offen
    s_cmp_eq_u32 s27, 1
    s_cselect_b64 s[44:45], s[4:5], s[44:45]
    s_sub_u32 s27, s27, 1
    s_cselect_b32 s26, 1000, 8
    v_mov_b32 v98, v99
    v_mov_b32 v99, v100
m_A_tb_6:
    s_waitcnt vmcnt(17)
    s_barrier
    buffer_load_dwordx4 v108, s[8:11], s16 offen lds
    buffer_load_dwordx4 v109, s[8:11], s16 offen offset:1024 lds
    s_mov_b32 m0, 94208
    s_add_u32 s16, s16, 9216
    s_add_u32 s20, s20, 73728
    buffer_load_dwordx4 v110, s[12:15], s17 offen offset:0 lds
    buffer_load_dwordx4 v110, s[12:15], s17 offen offset:1024 lds
    s_mov_b32 m0, 100352
    s_nop 0
    buffer_load_dwordx4 v108, s[8:11], s16 offen lds
    buffer_load_dwordx4 v109, s[8:11], s16 offen offset:1024 lds
    s_mov_b32 m0, 108544
    s_add_u32 s16, s16, 9216
    s_add_u32 s17, s17, 73728
    buffer_load_dwordx4 v110, s[12:15], s20 offen offset:0 lds
    s_mov_b32 m0, 114688
    s_sub_u32 s26, s26, 1
    s_cbranch_scc0 m_A_tb_7
    buffer_load_dword v127, v98, s[44:47], 0 offen
    s_cmp_eq_u32 s27, 1
    s_cselect_b64 s[44:45], s[4:5], s[44:45]
    s_sub_u32 s27, s27, 1
    s_cselect_b32 s26, 1000, 8
    v_mov_b32 v98, v99
    v_mov_b32 v99, v100
m_A_tb_7:
    s_waitcnt vmcnt(17)
    s_barrier
    buffer_load_dwordx4 v108, s[8:11], s16 offen lds
    buffer_load_dwordx4 v109, s[8:11], s16 offen offset:1024 lds
    s_mov_b32 m0, 122880
    s_add_u32 s16, s16, 9216
    s_add_u32 s20, s20, 73728
    buffer_load_dwordx4 v110, s[12:15], s17 offen offset:0 lds
    buffer_load_dwordx4 v110, s[12:15], s17 offen offset:1024 lds
    s_mov_b32 m0, 129024
    s_nop 0
    buffer_load_dwordx4 v108, s[8:11], s16 offen lds
    buffer_load_dwordx4 v109, s[8:11], s16 offen offset:1024 lds
    s_mov_b32 m0, 137216
    s_add_u32 s16, s16, 9216
    s_add_u32 s17, s17, 73728
    buffer_load_dwordx4 v110, s[12:15], s20 offen offset:0 lds
    s_mov_b32 m0, 0
    s_sub_u32 s26, s26, 1
    s_cbranch_scc0 m_A_tb_8
    buffer_load_dword v127, v98, s[44:47], 0 offen
    s_cmp_eq_u32 s27, 1
    s_cselect_b64 s[44:45], s[4:5], s[44:45]
    s_sub_u32 s27, s27, 1
    s_cselect_b32 s26, 1000, 8
    v_mov_b32 v98, v99
    v_mov_b32 v99, v100
m_A_tb_8:
    s_waitcnt vmcnt(17)
    s_barrier
    buffer_load_dwordx4 v108, s[8:11], s16 offen lds
    buffer_load_dwordx4 v109, s[8:11], s16 offen offset:1024 lds
    s_mov_b32 m0, 8192
    s_add_u32 s16, s16, 9216
    s_add_u32 s20, s20, 73728
    buffer_load_dwordx4 v110, s[12:15], s17 offen offset:0 lds
    buffer_load_dwordx4 v110, s[12:15], s17 offen offset:1024 lds
    s_mov_b32 m0, 14336
    s_nop 0
    buffer_load_dwordx4 v108, s[8:11], s16 offen lds
    buffer_load_dwordx4 v109, s[8:11], s16 offen offset:1024 lds
    s_mov_b32 m0, 22528
    s_add_u32 s16, s16, 9216
    s_add_u32 s17, s17, 73728
    buffer_load_dwordx4 v110, s[12:15], s20 offen offset:0 lds
    s_mov_b32 m0, 28672
    s_sub_u32 s26, s26, 1
    s_cbranch_scc0 m_A_tb_9
    buffer_load_dword v127, v98, s[44:47], 0 offen
    s_cmp_eq_u32 s27, 1
    s_cselect_b64 s[44:45], s[4:5], s[44:45]
    s_sub_u32 s27, s27, 1
    s_cselect_b32 s26, 1000, 8
    v_mov_b32 v98, v99
    v_mov_b32 v99, v100
m_A_tb_9:
    s_waitcnt vmcnt(17)
    s_barrier
    buffer_load_dwordx4 v108, s[8:11], s16 offen lds
    buffer_load_dwordx4 v109, s[8:11], s16 offen offset:1024 lds
    s_mov_b32 m0, 36864
    s_add_u32 s16, s16, 9216
    s_add_u32 s20, s20, 73728
    buffer_load_dwordx4 v110, s[12:15], s17 offen offset:0 lds
    buffer_load_dwordx4 v110, s[12:15], s17 offen offset:1024 lds
    s_mov_b32 m0, 43008
    s_nop 0
    buffer_load_dwordx4 v108, s[8:11], s16 offen lds
    buffer_load_dwordx4 v109, s[8:11], s16 offen offset:1024 lds
    s_mov_b32 m0, 51200
    s_add_u32 s16, s16, 9216
    s_add_u32 s17, s17, 73728
    buffer_load_dwordx4 v110, s[12:15], s20 offen offset:0 lds
    s_mov_b32 m0, 57344
    s_sub_u32 s26, s26, 1
    s_cbranch_scc0 m_A_tb_10
    buffer_load_dword v127, v98, s[44:47], 0 offen
    s_cmp_eq_u32 s27, 1
    s_cselect_b64 s[44:45], s[4:5], s[44:45]
    s_sub_u32 s27, s27, 1
    s_cselect_b32 s26, 1000, 8
    v_mov_b32 v98, v99
    v_mov_b32 v99, v100
m_A_tb_10:
    s_sub_u32 s21, s21, 1
    s_cmp_lg_u32 s21, 0
    s_cbranch_scc1 m_A_main_5
m_A_lt_12:
    s_waitcnt vmcnt(17)
    s_barrier
    s_and_b32 s34, s2, 1
    s_lshl_b32 s52, s34, 7
    s_add_u32 s52, s52, 246400
    s_add_u32 s48, s40, 0x310000
    s_addc_u32 s49, s41, 0
    s_mov_b32 s50, 0xa8000
    s_mov_b32 s51, 0x20000
    s_buffer_load_dword s54, s[48:51], s52
    s_bfe_u32 s33, s2, 0x20001
    s_bfe_u32 s35, s2, 0x20003
    s_mul_i32 s37, s35, 9
    s_mul_i32 s3, s33, 5
    s_sub_u32 s3, s3, 2
    s_lshl_b32 s53, s33, 2
    s_max_i32 s3, s3, s53
    s_lshl_b32 s53, s3, 1
    s_lshl_b32 s26, s3, 17
    s_add_u32 s32, s32, s26
    s_mul_i32 s3, s3, 36
    s_add_u32 s3, s3, s37
    s_add_u32 s3, s3, 5184
    s_lshl_b32 s26, s3, 10
    s_and_b32 s3, s35, 1
    s_add_u32 s12, s40, 0x7ff800
    s_addc_u32 s13, s41, 0
    s_mov_b32 s14, 0x5b2800
    s_mov_b32 s15, 0x20000
    s_add_u32 s23, s33, 0
    s_and_b32 s23, s23, 3
    s_lshl1_add_u32 s23, s23, s3
    s_add_u32 s23, s23, 2
    s_lshl_b32 s23, s23, 10
    v_add_u32 v111, s23, v110
    s_add_u32 s23, s33, 0
    s_and_b32 s23, s23, 3
    s_lshl1_add_u32 s23, s23, s3
    s_add_u32 s23, s23, 2
    s_lshl_b32 s23, s23, 10
    v_add_u32 v112, s23, v110
    s_add_u32 s23, s33, 1
    s_and_b32 s23, s23, 3
    s_lshl1_add_u32 s23, s23, s3
    s_add_u32 s23, s23, 0
    s_lshl_b32 s23, s23, 10
    v_add_u32 v113, s23, v110
    v_mov_b32 v126, 0
    s_waitcnt vmcnt(10)
    s_barrier
    s_waitcnt lgkmcnt(0)
    s_cmp_eq_u32 s54, s96
    s_cbranch_scc1 m_A_zk0_x
    s_mov_b64 exec, 1
    s_mov_b32 s98, 0x80000
m_A_zk0:
    v_mov_b32 v125, 0
    buffer_atomic_or v125, v126, s[48:51], s52 offen sc0 sc1
    s_sub_u32 s98, s98, 1
    s_cbranch_scc1 m_A_zk0_x
    s_waitcnt vmcnt(0)
    v_cmp_ne_u32 vcc, s96, v125
    s_nop 0
    s_and_b64 exec, exec, vcc
    s_cbranch_scc1 m_A_zk0
m_A_zk0_x:
    s_mov_b64 exec, -1
    s_mov_b32 m0, 77824
    s_nop 0
    buffer_load_dwordx4 v111, s[12:15], s26 offen offset:0 lds
    buffer_load_dwordx4 v112, s[12:15], s26 offen offset:1024 lds
    buffer_load_dwordx4 v113, s[12:15], s26 offen offset:2048 lds
    s_add_u32 s26, s26, 36864
    s_mov_b32 m0, 95232
    s_nop 0
    buffer_load_dwordx4 v111, s[12:15], s26 offen offset:0 lds
    buffer_load_dwordx4 v112, s[12:15], s26 offen offset:1024 lds
    s_add_u32 s26, s26, 36864
    s_waitcnt vmcnt(8)
    s_barrier
    s_mov_b32 m0, 112640
    s_nop 0
    buffer_load_dwordx4 v111, s[12:15], s26 offen offset:0 lds
    buffer_load_dwordx4 v112, s[12:15], s26 offen offset:1024 lds
    buffer_load_dwordx4 v113, s[12:15], s26 offen offset:2048 lds
    s_add_u32 s26, s26, 36864
    s_mov_b32 m0, 130048
    s_nop 0
    buffer_load_dwordx4 v111, s[12:15], s26 offen offset:0 lds
    buffer_load_dwordx4 v112, s[12:15], s26 offen offset:1024 lds
    s_add_u32 s26, s26, 36864
    s_waitcnt vmcnt(10)
    s_barrier
    s_cmp_lt_u32 s33, 2
    s_cbranch_scc1 m_A_zs0
    s_mov_b32 m0, 147456
    s_nop 0
    buffer_load_dwordx4 v111, s[12:15], s26 offen offset:0 lds
    buffer_load_dwordx4 v112, s[12:15], s26 offen offset:1024 lds
    buffer_load_dwordx4 v113, s[12:15], s26 offen offset:2048 lds
    s_add_u32 s26, s26, 36864
m_A_zs0:
m_A_le_11:
    s_branch m_B
m_A_ld1:
    s_add_u32 s20, s17, 37888
    s_add_u32 s17, s17, 2048
    s_load_dwordx2 s[4:5], s[0:1], 48
    s_lshl_b32 s26, s34, 8
    s_mov_b32 s27, 52429
    s_add_u32 s26, s26, 6784
    v_add_u32 v102, s26, v1
    v_mul_u32_u24 v103, s27, v102
    v_lshrrev_b32 v103, 19, v103
    v_mul_u32_u24 v98, 10, v103
    v_sub_u32 v102, v102, v98
    v_and_b32 v98, 31, v103
    v_lshrrev_b32 v103, 5, v103
    v_min_u32 v103, 63, v103
    v_lshl_add_u32 v103, v98, 6, v103
    v_mul_u32_u24 v103, 9216, v103
    v_lshl_add_u32 v98, v102, 7, v103
    v_add_u32 v98, s31, v98
    s_add_u32 s26, s26, 6912
    v_add_u32 v102, s26, v1
    v_mul_u32_u24 v103, s27, v102
    v_lshrrev_b32 v103, 19, v103
    v_mul_u32_u24 v99, 10, v103
    v_sub_u32 v102, v102, v99
    v_and_b32 v99, 31, v103
    v_lshrrev_b32 v103, 5, v103
    v_min_u32 v103, 63, v103
    v_lshl_add_u32 v103, v99, 6, v103
    v_mul_u32_u24 v103, 9216, v103
    v_lshl_add_u32 v99, v102, 7, v103
    v_add_u32 v99, s31, v99
    s_lshr_b32 s27, s33, 1
    s_mov_b32 s26, 0
    s_cmp_eq_u32 s27, 1
    s_cselect_b32 s26, 72, s26
    s_cmp_eq_u32 s27, 2
    s_cselect_b32 s26, 144, s26
    s_cmp_eq_u32 s27, 3
    s_cselect_b32 s26, 216, s26
    s_add_u32 s26, s26, s34
    s_lshl_b32 s26, s26, 5
    s_and_b32 s27, s33, 1
    s_add_u32 s26, s26, s27
    s_lshl_b32 s26, s26, 11
    s_add_u32 s26, s26, 16384
    v_and_b32 v102, 15, v1
    v_lshrrev_b32 v103, 4, v1
    v_lshl_add_u32 v102, v103, 5, v102
    v_lshl_add_u32 v100, v102, 7, s26
    s_mul_i32 s26, s34, 77
    s_lshr_b32 s26, s26, 8
    s_add_u32 s26, s26, 1
    s_mov_b32 s27, 2
    s_mov_b32 m0, 2048
    s_mov_b32 s12, s40
    s_mov_b32 s13, s41
    s_mov_b32 s14, 0x240000
    s_mov_b32 s15, 0x20000
    s_add_u32 s56, s28, 0x1b00000
    s_addc_u32 s57, s29, 0
    s_mov_b32 s58, 0x250000
    s_mov_b32 s59, 0x20000
    s_mov_b32 s60, 0x05040100
    s_mov_b32 s61, 0x07060302
    s_lshl_b32 s62, s2, 8
    v_lshlrev_b32 v2, 6, v1
    v_add_u32 v2, 122880, v2
    v_lshlrev_b32 v3, 4, v1
    v_add_u32 v3, 122880, v3
    v_lshrrev_b32 v5, 3, v1
    v_lshlrev_b32 v5, 16, v5
    v_and_b32 v6, 7, v1
    v_xor_b32 v6, s33, v6
    v_lshl_add_u32 v8, v6, 4, v5
    v_add_u32 v9, 524288, v8
    v_add_u32 v10, 1048576, v8
    v_add_u32 v11, 1572864, v8
    s_lshl2_add_u32 s38, s2, 1
    s_add_u32 s48, s28, 0x800000
    s_addc_u32 s49, s29, 0
    s_mov_b32 s50, 0x5b2000
    s_mov_b32 s51, 0x20000
    s_mul_i32 s39, s38, 1821
    s_lshr_b32 s39, s39, 16
    s_mul_i32 s42, s39, 36
    s_sub_u32 s42, s38, s42
    s_lshr_b32 s43, s42, 1
    s_lshl_b32 s43, s43, 5
    s_and_b32 s42, s42, 1
    s_lshl2_add_u32 s43, s42, s43
    v_bfe_u32 v60, v1, 2, 2
    v_and_b32 v61, 3, v1
    v_lshl_add_u32 v60, v60, 3, v61
    v_add_u32 v62, s43, v60
    s_lshl_b32 s42, s39, 4
    v_lshrrev_b32 v60, 4, v1
    v_lshl_add_u32 v63, v60, 1, s42
    v_add_u32 v60, 0, v63
    v_mul_u32_u24 v60, v60, v62
    v_cvt_f32_u32 v60, v60
    v_mul_f32 v60, 0x3ae38e39, v60
    v_fract_f32 v68, v60
    v_add_u32 v60, 1, v63
    v_mul_u32_u24 v60, v60, v62
    v_cvt_f32_u32 v60, v60
    v_mul_f32 v60, 0x3ae38e39, v60
    v_fract_f32 v69, v60
    v_add_u32 v60, 8, v63
    v_mul_u32_u24 v60, v60, v62
    v_cvt_f32_u32 v60, v60
    v_mul_f32 v60, 0x3ae38e39, v60
    v_fract_f32 v70, v60
    v_add_u32 v60, 9, v63
    v_mul_u32_u24 v60, v60, v62
    v_cvt_f32_u32 v60, v60
    v_mul_f32 v60, 0x3ae38e39, v60
    v_fract_f32 v71, v60
    v_cos_f32 v72, v68
    v_sin_f32 v73, v68
    v_cos_f32 v74, v69
    v_sin_f32 v75, v69
    v_cos_f32 v76, v70
    v_sin_f32 v77, v70
    v_cos_f32 v78, v71
    v_sin_f32 v79, v71
    v_cvt_pk_bf16_f32 v64, v72, v73
    v_cvt_pk_bf16_f32 v65, v74, v75
    v_cvt_pk_bf16_f32 v66, v76, v77
    v_cvt_pk_bf16_f32 v67, v78, v79
    v_lshlrev_b32 v60, 31, v62
    v_or_b32 v60, 0x3f003f00, v60
    v_cmp_eq_u32 vcc, 0, v63
    s_nop 1
    v_cndmask_b32 v64, v64, v60, vcc
    s_add_u32 s38, s38, 5184
    s_lshl_b32 s38, s38, 10
    v_lshlrev_b32 v60, 4, v1
    s_waitcnt vmcnt(0)
    v_perm_b32 v32, v24, v16, s60
    v_perm_b32 v33, v26, v18, s60
    v_perm_b32 v34, v28, v20, s60
    v_perm_b32 v35, v30, v22, s60
    ds_write_b128 v2, v[32:35] offset:0
    v_perm_b32 v36, v24, v16, s61
    v_perm_b32 v37, v26, v18, s61
    v_perm_b32 v38, v28, v20, s61
    v_perm_b32 v39, v30, v22, s61
    ds_write_b128 v2, v[36:39] offset:16
    v_perm_b32 v40, v25, v17, s60
    v_perm_b32 v41, v27, v19, s60
    v_perm_b32 v42, v29, v21, s60
    v_perm_b32 v43, v31, v23, s60
    ds_write_b128 v2, v[40:43] offset:32
    v_perm_b32 v44, v25, v17, s61
    v_perm_b32 v45, v27, v19, s61
    v_perm_b32 v46, v29, v21, s61
    v_perm_b32 v47, v31, v23, s61
    ds_write_b128 v2, v[44:47] offset:48
    ds_read_b128 v[16:19], v3 offset:0
    ds_read_b128 v[20:23], v3 offset:1024
    ds_read_b128 v[24:27], v3 offset:2048
    ds_read_b128 v[28:31], v3 offset:3072
    s_waitcnt lgkmcnt(0)
    v_mov_b32 v12, 163824
    s_mov_b32 s98, 0x800000
m_Ag5_sg:
    ds_read_b32 v13, v12 offset:8
    s_sub_u32 s98, s98, 1
    s_cbranch_scc1 m_Ag5_sg_x
    s_waitcnt lgkmcnt(0)
    v_cmp_gt_u32 vcc, 4, v13
    s_cbranch_vccnz m_Ag5_sg
m_Ag5_sg_x:
    s_waitcnt lgkmcnt(0)
    s_mul_i32 s96, s96, 0x9e3779b1
    s_add_u32 s96, s96, 0x7f4a7c15
    buffer_load_dwordx4 v108, s[8:11], s16 offen lds
    buffer_load_dwordx4 v109, s[8:11], s16 offen offset:1024 lds
    s_add_u32 s16, s16, 9216
    s_mov_b32 m0, 16384
    s_nop 0
    buffer_load_dwordx4 v108, s[8:11], s16 offen lds
    buffer_load_dwordx4 v109, s[8:11], s16 offen offset:1024 lds
    s_add_u32 s16, s16, 9216
    s_mov_b32 m0, 30720
    s_nop 0
    buffer_load_dwordx4 v108, s[8:11], s16 offen lds
    buffer_load_dwordx4 v109, s[8:11], s16 offen offset:1024 lds
    s_add_u32 s16, s16, 9216
    s_mov_b32 m0, 45056
    s_nop 0
    buffer_load_dwordx4 v108, s[8:11], s16 offen lds
    buffer_load_dwordx4 v109, s[8:11], s16 offen offset:1024 lds
    s_add_u32 s16, s16, 9216
    s_mov_b32 m0, 59392
    s_nop 0
    buffer_load_dwordx4 v108, s[8:11], s16 offen lds
    buffer_load_dwordx4 v109, s[8:11], s16 offen offset:1024 lds
    s_add_u32 s16, s16, 9216
    s_mov_b32 m0, 73728
    s_nop 0
    buffer_load_dwordx4 v108, s[8:11], s16 offen lds
    buffer_load_dwordx4 v109, s[8:11], s16 offen offset:1024 lds
    s_add_u32 s16, s16, 9216
    s_mov_b32 m0, 88064
    s_nop 0
    buffer_load_dwordx4 v108, s[8:11], s16 offen lds
    buffer_load_dwordx4 v109, s[8:11], s16 offen offset:1024 lds
    s_add_u32 s16, s16, 9216
    s_mov_b32 m0, 102400
    s_nop 0
    buffer_load_dwordx4 v108, s[8:11], s16 offen lds
    buffer_load_dwordx4 v109, s[8:11], s16 offen offset:1024 lds
    s_add_u32 s16, s16, 9216
    s_mov_b32 m0, 10240
    v_mov_b32 v96, 163824
    s_cmp_ge_u32 s2, 162
    s_cbranch_scc1 m_Ag5_nomt
    buffer_store_dwordx4 v[64:67], v60, s[48:51], s38 offen sc1
m_Ag5_nomt:
    buffer_store_dwordx4 v[16:19], v8, s[56:59], s62 offen offset:128 sc1
    buffer_store_dwordx4 v[20:23], v9, s[56:59], s62 offen offset:128 sc1
    buffer_store_dwordx4 v[24:27], v10, s[56:59], s62 offen offset:128 sc1
    buffer_store_dwordx4 v[28:31], v11, s[56:59], s62 offen offset:128 sc1
    s_mov_b32 s98, 0x800000
m_A_sp1:
    ds_read_b32 v97, v96 offset:0
    s_sub_u32 s98, s98, 1
    s_cbranch_scc1 m_A_sp1_x
    s_waitcnt lgkmcnt(0)
    v_cmp_ne_u32 vcc, 2, v97
    s_cbranch_vccnz m_A_sp1
m_A_sp1_x:
    buffer_load_dwordx4 v110, s[12:15], s17 offen offset:0 lds
    buffer_load_dwordx4 v110, s[12:15], s17 offen offset:1024 lds
    s_mov_b32 m0, 23552
    s_add_u32 s17, s17, 73728
    buffer_load_dwordx4 v110, s[12:15], s20 offen offset:0 lds
    s_mov_b32 m0, 38912
    s_add_u32 s20, s20, 73728
    buffer_load_dwordx4 v110, s[12:15], s17 offen offset:0 lds
    buffer_load_dwordx4 v110, s[12:15], s17 offen offset:1024 lds
    s_mov_b32 m0, 52224
    s_add_u32 s17, s17, 73728
    buffer_load_dwordx4 v110, s[12:15], s20 offen offset:0 lds
    s_mov_b32 m0, 67584
    s_add_u32 s20, s20, 73728
    buffer_load_dwordx4 v110, s[12:15], s17 offen offset:0 lds
    buffer_load_dwordx4 v110, s[12:15], s17 offen offset:1024 lds
    s_mov_b32 m0, 80896
    s_add_u32 s17, s17, 73728
    buffer_load_dwordx4 v110, s[12:15], s20 offen offset:0 lds
    s_mov_b32 m0, 96256
    s_add_u32 s20, s20, 73728
    buffer_load_dwordx4 v110, s[12:15], s17 offen offset:0 lds
    buffer_load_dwordx4 v110, s[12:15], s17 offen offset:1024 lds
    s_mov_b32 m0, 109568
    s_add_u32 s17, s17, 73728
    buffer_load_dwordx4 v110, s[12:15], s20 offen offset:0 lds
    s_mov_b32 m0, 116736
    s_mov_b32 s44, s8
    s_mov_b32 s45, s9
    s_mov_b32 s46, 0x1200000
    s_mov_b32 s47, 0x20000
    s_sub_u32 s26, s26, 1
    s_cbranch_scc0 m_A_tb_13
    buffer_load_dword v127, v98, s[44:47], 0 offen
    s_cmp_eq_u32 s27, 1
    s_cselect_b64 s[44:45], s[4:5], s[44:45]
    s_sub_u32 s27, s27, 1
    s_cselect_b32 s26, 1000, 8
    v_mov_b32 v98, v99
    v_mov_b32 v99, v100
m_A_tb_13:
    s_waitcnt vmcnt(7)
    s_barrier
    buffer_load_dwordx4 v108, s[8:11], s16 offen lds
    buffer_load_dwordx4 v109, s[8:11], s16 offen offset:1024 lds
    s_mov_b32 m0, 124928
    s_add_u32 s16, s16, 9216
    s_add_u32 s20, s20, 73728
    buffer_load_dwordx4 v110, s[12:15], s17 offen offset:0 lds
    buffer_load_dwordx4 v110, s[12:15], s17 offen offset:1024 lds
    s_mov_b32 m0, 131072
    s_nop 0
    buffer_load_dwordx4 v108, s[8:11], s16 offen lds
    buffer_load_dwordx4 v109, s[8:11], s16 offen offset:1024 lds
    s_mov_b32 m0, 138240
    s_add_u32 s16, s16, 9216
    s_add_u32 s17, s17, 73728
    buffer_load_dwordx4 v110, s[12:15], s20 offen offset:0 lds
    s_mov_b32 m0, 2048
    s_sub_u32 s26, s26, 1
    s_cbranch_scc0 m_A_tb_14
    buffer_load_dword v127, v98, s[44:47], 0 offen
    s_cmp_eq_u32 s27, 1
    s_cselect_b64 s[44:45], s[4:5], s[44:45]
    s_sub_u32 s27, s27, 1
    s_cselect_b32 s26, 1000, 8
    v_mov_b32 v98, v99
    v_mov_b32 v99, v100
m_A_tb_14:
    s_waitcnt vmcnt(11)
    s_barrier
    buffer_load_dwordx4 v108, s[8:11], s16 offen lds
    buffer_load_dwordx4 v109, s[8:11], s16 offen offset:1024 lds
    s_mov_b32 m0, 10240
    s_add_u32 s16, s16, 9216
    s_add_u32 s20, s20, 73728
    buffer_load_dwordx4 v110, s[12:15], s17 offen offset:0 lds
    buffer_load_dwordx4 v110, s[12:15], s17 offen offset:1024 lds
    s_mov_b32 m0, 16384
    s_nop 0
    buffer_load_dwordx4 v108, s[8:11], s16 offen lds
    buffer_load_dwordx4 v109, s[8:11], s16 offen offset:1024 lds
    s_mov_b32 m0, 23552
    s_add_u32 s16, s16, 9216
    s_add_u32 s17, s17, 73728
    buffer_load_dwordx4 v110, s[12:15], s20 offen offset:0 lds
    s_mov_b32 m0, 30720
    s_sub_u32 s26, s26, 1
    s_cbranch_scc0 m_A_tb_15
    buffer_load_dword v127, v98, s[44:47], 0 offen
    s_cmp_eq_u32 s27, 1
    s_cselect_b64 s[44:45], s[4:5], s[44:45]
    s_sub_u32 s27, s27, 1
    s_cselect_b32 s26, 1000, 8
    v_mov_b32 v98, v99
    v_mov_b32 v99, v100
m_A_tb_15:
    s_waitcnt vmcnt(15)
    s_barrier
    buffer_load_dwordx4 v108, s[8:11], s16 offen lds
    buffer_load_dwordx4 v109, s[8:11], s16 offen offset:1024 lds
    s_mov_b32 m0, 38912
    s_add_u32 s16, s16, 9216
    s_add_u32 s20, s20, 73728
    buffer_load_dwordx4 v110, s[12:15], s17 offen offset:0 lds
    buffer_load_dwordx4 v110, s[12:15], s17 offen offset:1024 lds
    s_mov_b32 m0, 45056
    s_nop 0
    buffer_load_dwordx4 v108, s[8:11], s16 offen lds
    buffer_load_dwordx4 v109, s[8:11], s16 offen offset:1024 lds
    s_mov_b32 m0, 52224
    s_add_u32 s16, s16, 9216
    s_add_u32 s17, s17, 73728
    buffer_load_dwordx4 v110, s[12:15], s20 offen offset:0 lds
    s_mov_b32 m0, 59392
    s_sub_u32 s26, s26, 1
    s_cbranch_scc0 m_A_tb_16
    buffer_load_dword v127, v98, s[44:47], 0 offen
    s_cmp_eq_u32 s27, 1
    s_cselect_b64 s[44:45], s[4:5], s[44:45]
    s_sub_u32 s27, s27, 1
    s_cselect_b32 s26, 1000, 8
    v_mov_b32 v98, v99
    v_mov_b32 v99, v100
m_A_tb_16:
    s_mov_b32 s21, 5
m_A_main_17:
    s_waitcnt vmcnt(17)
    s_barrier
    buffer_load_dwordx4 v108, s[8:11], s16 offen lds
    buffer_load_dwordx4 v109, s[8:11], s16 offen offset:1024 lds
    s_mov_b32 m0, 67584
    s_add_u32 s16, s16, 9216
    s_add_u32 s20, s20, 73728
    buffer_load_dwordx4 v110, s[12:15], s17 offen offset:0 lds
    buffer_load_dwordx4 v110, s[12:15], s17 offen offset:1024 lds
    s_mov_b32 m0, 73728
    s_nop 0
    buffer_load_dwordx4 v108, s[8:11], s16 offen lds
    buffer_load_dwordx4 v109, s[8:11], s16 offen offset:1024 lds
    s_mov_b32 m0, 80896
    s_add_u32 s16, s16, 9216
    s_add_u32 s17, s17, 73728
    buffer_load_dwordx4 v110, s[12:15], s20 offen offset:0 lds
    s_mov_b32 m0, 88064
    s_sub_u32 s26, s26, 1
    s_cbranch_scc0 m_A_tb_18
    buffer_load_dword v127, v98, s[44:47], 0 offen
    s_cmp_eq_u32 s27, 1
    s_cselect_b64 s[44:45], s[4:5], s[44:45]
    s_sub_u32 s27, s27, 1
    s_cselect_b32 s26, 1000, 8
    v_mov_b32 v98, v99
    v_mov_b32 v99, v100
m_A_tb_18:
    s_waitcnt vmcnt(17)
    s_barrier
    buffer_load_dwordx4 v108, s[8:11], s16 offen lds
    buffer_load_dwordx4 v109, s[8:11], s16 offen offset:1024 lds
    s_mov_b32 m0, 96256
    s_add_u32 s16, s16, 9216
    s_add_u32 s20, s20, 73728
    buffer_load_dwordx4 v110, s[12:15], s17 offen offset:0 lds
    buffer_load_dwordx4 v110, s[12:15], s17 offen offset:1024 lds
    s_mov_b32 m0, 102400
    s_nop 0
    buffer_load_dwordx4 v108, s[8:11], s16 offen lds
    buffer_load_dwordx4 v109, s[8:11], s16 offen offset:1024 lds
    s_mov_b32 m0, 109568
    s_add_u32 s16, s16, 9216
    s_add_u32 s17, s17, 73728
    buffer_load_dwordx4 v110, s[12:15], s20 offen offset:0 lds
    s_mov_b32 m0, 116736
    s_sub_u32 s26, s26, 1
    s_cbranch_scc0 m_A_tb_19
    buffer_load_dword v127, v98, s[44:47], 0 offen
    s_cmp_eq_u32 s27, 1
    s_cselect_b64 s[44:45], s[4:5], s[44:45]
    s_sub_u32 s27, s27, 1
    s_cselect_b32 s26, 1000, 8
    v_mov_b32 v98, v99
    v_mov_b32 v99, v100
m_A_tb_19:
    s_waitcnt vmcnt(17)
    s_barrier
    buffer_load_dwordx4 v108, s[8:11], s16 offen lds
    buffer_load_dwordx4 v109, s[8:11], s16 offen offset:1024 lds
    s_mov_b32 m0, 124928
    s_add_u32 s16, s16, 9216
    s_add_u32 s20, s20, 73728
    buffer_load_dwordx4 v110, s[12:15], s17 offen offset:0 lds
    buffer_load_dwordx4 v110, s[12:15], s17 offen offset:1024 lds
    s_mov_b32 m0, 131072
    s_nop 0
    buffer_load_dwordx4 v108, s[8:11], s16 offen lds
    buffer_load_dwordx4 v109, s[8:11], s16 offen offset:1024 lds
    s_mov_b32 m0, 138240
    s_add_u32 s16, s16, 9216
    s_add_u32 s17, s17, 73728
    buffer_load_dwordx4 v110, s[12:15], s20 offen offset:0 lds
    s_mov_b32 m0, 2048
    s_sub_u32 s26, s26, 1
    s_cbranch_scc0 m_A_tb_20
    buffer_load_dword v127, v98, s[44:47], 0 offen
    s_cmp_eq_u32 s27, 1
    s_cselect_b64 s[44:45], s[4:5], s[44:45]
    s_sub_u32 s27, s27, 1
    s_cselect_b32 s26, 1000, 8
    v_mov_b32 v98, v99
    v_mov_b32 v99, v100
m_A_tb_20:
    s_waitcnt vmcnt(17)
    s_barrier
    buffer_load_dwordx4 v108, s[8:11], s16 offen lds
    buffer_load_dwordx4 v109, s[8:11], s16 offen offset:1024 lds
    s_mov_b32 m0, 10240
    s_add_u32 s16, s16, 9216
    s_add_u32 s20, s20, 73728
    buffer_load_dwordx4 v110, s[12:15], s17 offen offset:0 lds
    buffer_load_dwordx4 v110, s[12:15], s17 offen offset:1024 lds
    s_mov_b32 m0, 16384
    s_nop 0
    buffer_load_dwordx4 v108, s[8:11], s16 offen lds
    buffer_load_dwordx4 v109, s[8:11], s16 offen offset:1024 lds
    s_mov_b32 m0, 23552
    s_add_u32 s16, s16, 9216
    s_add_u32 s17, s17, 73728
    buffer_load_dwordx4 v110, s[12:15], s20 offen offset:0 lds
    s_mov_b32 m0, 30720
    s_sub_u32 s26, s26, 1
    s_cbranch_scc0 m_A_tb_21
    buffer_load_dword v127, v98, s[44:47], 0 offen
    s_cmp_eq_u32 s27, 1
    s_cselect_b64 s[44:45], s[4:5], s[44:45]
    s_sub_u32 s27, s27, 1
    s_cselect_b32 s26, 1000, 8
    v_mov_b32 v98, v99
    v_mov_b32 v99, v100
m_A_tb_21:
    s_waitcnt vmcnt(17)
    s_barrier
    buffer_load_dwordx4 v108, s[8:11], s16 offen lds
    buffer_load_dwordx4 v109, s[8:11], s16 offen offset:1024 lds
    s_mov_b32 m0, 38912
    s_add_u32 s16, s16, 9216
    s_add_u32 s20, s20, 73728
    buffer_load_dwordx4 v110, s[12:15], s17 offen offset:0 lds
    buffer_load_dwordx4 v110, s[12:15], s17 offen offset:1024 lds
    s_mov_b32 m0, 45056
    s_nop 0
    buffer_load_dwordx4 v108, s[8:11], s16 offen lds
    buffer_load_dwordx4 v109, s[8:11], s16 offen offset:1024 lds
    s_mov_b32 m0, 52224
    s_add_u32 s16, s16, 9216
    s_add_u32 s17, s17, 73728
    buffer_load_dwordx4 v110, s[12:15], s20 offen offset:0 lds
    s_mov_b32 m0, 59392
    s_sub_u32 s26, s26, 1
    s_cbranch_scc0 m_A_tb_22
    buffer_load_dword v127, v98, s[44:47], 0 offen
    s_cmp_eq_u32 s27, 1
    s_cselect_b64 s[44:45], s[4:5], s[44:45]
    s_sub_u32 s27, s27, 1
    s_cselect_b32 s26, 1000, 8
    v_mov_b32 v98, v99
    v_mov_b32 v99, v100
m_A_tb_22:
    s_sub_u32 s21, s21, 1
    s_cmp_lg_u32 s21, 0
    s_cbranch_scc1 m_A_main_17
m_A_lt_24:
    s_waitcnt vmcnt(17)
    s_barrier
    s_and_b32 s34, s2, 1
    s_lshl_b32 s52, s34, 7
    s_add_u32 s52, s52, 246400
    s_add_u32 s48, s40, 0x310000
    s_addc_u32 s49, s41, 0
    s_mov_b32 s50, 0xa8000
    s_mov_b32 s51, 0x20000
    s_buffer_load_dword s54, s[48:51], s52
    s_bfe_u32 s33, s2, 0x20001
    s_bfe_u32 s35, s2, 0x20003
    s_mul_i32 s37, s35, 9
    s_mul_i32 s3, s33, 5
    s_sub_u32 s3, s3, 2
    s_lshl_b32 s53, s33, 2
    s_max_i32 s3, s3, s53
    s_lshl_b32 s53, s3, 1
    s_lshl_b32 s26, s3, 17
    s_add_u32 s32, s32, s26
    s_mul_i32 s3, s3, 36
    s_add_u32 s3, s3, s37
    s_add_u32 s3, s3, 5184
    s_lshl_b32 s26, s3, 10
    s_and_b32 s3, s35, 1
    s_add_u32 s12, s40, 0x7ff800
    s_addc_u32 s13, s41, 0
    s_mov_b32 s14, 0x5b2800
    s_mov_b32 s15, 0x20000
    s_add_u32 s23, s33, 1
    s_and_b32 s23, s23, 3
    s_lshl1_add_u32 s23, s23, s3
    s_add_u32 s23, s23, 3
    s_lshl_b32 s23, s23, 10
    v_add_u32 v111, s23, v110
    s_add_u32 s23, s33, 2
    s_and_b32 s23, s23, 3
    s_lshl1_add_u32 s23, s23, s3
    s_add_u32 s23, s23, 1
    s_lshl_b32 s23, s23, 10
    v_add_u32 v112, s23, v110
    s_add_u32 s23, s33, 1
    s_and_b32 s23, s23, 3
    s_lshl1_add_u32 s23, s23, s3
    s_add_u32 s23, s23, 2
    s_lshl_b32 s23, s23, 10
    v_add_u32 v113, s23, v110
    s_add_u32 s23, s33, 1
    s_and_b32 s23, s23, 3
    s_lshl1_add_u32 s23, s23, s3
    s_add_u32 s23, s23, 2
    s_lshl_b32 s23, s23, 10
    v_add_u32 v114, s23, v110
    v_mov_b32 v126, 0
    s_waitcnt vmcnt(10)
    s_barrier
    s_waitcnt lgkmcnt(0)
    s_cmp_eq_u32 s54, s96
    s_cbranch_scc1 m_A_zk1_x
    s_mov_b64 exec, 1
    s_mov_b32 s98, 0x80000
m_A_zk1:
    v_mov_b32 v125, 0
    buffer_atomic_or v125, v126, s[48:51], s52 offen sc0 sc1
    s_sub_u32 s98, s98, 1
    s_cbranch_scc1 m_A_zk1_x
    s_waitcnt vmcnt(0)
    v_cmp_ne_u32 vcc, s96, v125
    s_nop 0
    s_and_b64 exec, exec, vcc
    s_cbranch_scc1 m_A_zk1
m_A_zk1_x:
    s_mov_b64 exec, -1
    s_mov_b32 m0, 80896
    s_nop 0
    buffer_load_dwordx4 v111, s[12:15], s26 offen offset:0 lds
    buffer_load_dwordx4 v112, s[12:15], s26 offen offset:1024 lds
    s_add_u32 s26, s26, 36864
    s_mov_b32 m0, 97280
    s_nop 0
    buffer_load_dwordx4 v113, s[12:15], s26 offen offset:0 lds
    buffer_load_dwordx4 v114, s[12:15], s26 offen offset:1024 lds
    s_add_u32 s26, s26, 36864
    s_waitcnt vmcnt(7)
    s_barrier
    s_mov_b32 m0, 115712
    s_nop 0
    buffer_load_dwordx4 v111, s[12:15], s26 offen offset:0 lds
    buffer_load_dwordx4 v112, s[12:15], s26 offen offset:1024 lds
    s_add_u32 s26, s26, 36864
    s_mov_b32 m0, 132096
    s_nop 0
    buffer_load_dwordx4 v113, s[12:15], s26 offen offset:0 lds
    buffer_load_dwordx4 v114, s[12:15], s26 offen offset:1024 lds
    s_add_u32 s26, s26, 36864
    s_waitcnt vmcnt(8)
    s_barrier
    s_cmp_lt_u32 s33, 2
    s_cbranch_scc1 m_A_zs1
    s_mov_b32 m0, 150528
    s_nop 0
    buffer_load_dwordx4 v111, s[12:15], s26 offen offset:0 lds
    buffer_load_dwordx4 v112, s[12:15], s26 offen offset:1024 lds
    s_add_u32 s26, s26, 36864
m_A_zs1:
m_A_le_23:
    s_branch m_B
m_A_ld2:
    s_add_u32 s20, s17, 38912
    s_add_u32 s17, s17, 4096
    s_load_dwordx2 s[4:5], s[0:1], 48
    s_lshl_b32 s26, s34, 8
    s_mov_b32 s27, 52429
    s_add_u32 s26, s26, 6848
    v_add_u32 v102, s26, v1
    v_mul_u32_u24 v103, s27, v102
    v_lshrrev_b32 v103, 19, v103
    v_mul_u32_u24 v98, 10, v103
    v_sub_u32 v102, v102, v98
    v_and_b32 v98, 31, v103
    v_lshrrev_b32 v103, 5, v103
    v_min_u32 v103, 63, v103
    v_lshl_add_u32 v103, v98, 6, v103
    v_mul_u32_u24 v103, 9216, v103
    v_lshl_add_u32 v98, v102, 7, v103
    v_add_u32 v98, s31, v98
    s_add_u32 s26, s26, 6912
    v_add_u32 v102, s26, v1
    v_mul_u32_u24 v103, s27, v102
    v_lshrrev_b32 v103, 19, v103
    v_mul_u32_u24 v99, 10, v103
    v_sub_u32 v102, v102, v99
    v_and_b32 v99, 31, v103
    v_lshrrev_b32 v103, 5, v103
    v_min_u32 v103, 63, v103
    v_lshl_add_u32 v103, v99, 6, v103
    v_mul_u32_u24 v103, 9216, v103
    v_lshl_add_u32 v99, v102, 7, v103
    v_add_u32 v99, s31, v99
    s_lshr_b32 s27, s33, 1
    s_mov_b32 s26, 0
    s_cmp_eq_u32 s27, 1
    s_cselect_b32 s26, 72, s26
    s_cmp_eq_u32 s27, 2
    s_cselect_b32 s26, 144, s26
    s_cmp_eq_u32 s27, 3
    s_cselect_b32 s26, 216, s26
    s_add_u32 s26, s26, s34
    s_lshl_b32 s26, s26, 5
    s_and_b32 s27, s33, 1
    s_add_u32 s26, s26, s27
    s_lshl_b32 s26, s26, 11
    s_add_u32 s26, s26, 32768
    v_and_b32 v102, 15, v1
    v_lshrrev_b32 v103, 4, v1
    v_lshl_add_u32 v102, v103, 5, v102
    v_lshl_add_u32 v100, v102, 7, s26
    s_mul_i32 s26, s34, 77
    s_lshr_b32 s26, s26, 8
    s_add_u32 s26, s26, 1
    s_mov_b32 s27, 2
    s_mov_b32 m0, 4096
    s_mov_b32 s12, s40
    s_mov_b32 s13, s41
    s_mov_b32 s14, 0x240000
    s_mov_b32 s15, 0x20000
    s_add_u32 s56, s28, 0x1b00000
    s_addc_u32 s57, s29, 0
    s_mov_b32 s58, 0x250000
    s_mov_b32 s59, 0x20000
    s_mov_b32 s60, 0x05040100
    s_mov_b32 s61, 0x07060302
    s_lshl_b32 s62, s2, 8
    v_lshlrev_b32 v2, 6, v1
    v_add_u32 v2, 126976, v2
    v_lshlrev_b32 v3, 4, v1
    v_add_u32 v3, 126976, v3
    v_lshrrev_b32 v5, 3, v1
    v_lshlrev_b32 v5, 16, v5
    v_and_b32 v6, 7, v1
    v_xor_b32 v6, s33, v6
    v_lshl_add_u32 v8, v6, 4, v5
    v_add_u32 v8, 2097152, v8
    s_lshl2_add_u32 s38, s2, 2
    s_add_u32 s48, s28, 0x800000
    s_addc_u32 s49, s29, 0
    s_mov_b32 s50, 0x5b2000
    s_mov_b32 s51, 0x20000
    s_mul_i32 s39, s38, 1821
    s_lshr_b32 s39, s39, 16
    s_mul_i32 s42, s39, 36
    s_sub_u32 s42, s38, s42
    s_lshr_b32 s43, s42, 1
    s_lshl_b32 s43, s43, 5
    s_and_b32 s42, s42, 1
    s_lshl2_add_u32 s43, s42, s43
    v_bfe_u32 v60, v1, 2, 2
    v_and_b32 v61, 3, v1
    v_lshl_add_u32 v60, v60, 3, v61
    v_add_u32 v62, s43, v60
    s_lshl_b32 s42, s39, 4
    v_lshrrev_b32 v60, 4, v1
    v_lshl_add_u32 v63, v60, 1, s42
    v_add_u32 v60, 0, v63
    v_mul_u32_u24 v60, v60, v62
    v_cvt_f32_u32 v60, v60
    v_mul_f32 v60, 0x3ae38e39, v60
    v_fract_f32 v68, v60
    v_add_u32 v60, 1, v63
    v_mul_u32_u24 v60, v60, v62
    v_cvt_f32_u32 v60, v60
    v_mul_f32 v60, 0x3ae38e39, v60
    v_fract_f32 v69, v60
    v_add_u32 v60, 8, v63
    v_mul_u32_u24 v60, v60, v62
    v_cvt_f32_u32 v60, v60
    v_mul_f32 v60, 0x3ae38e39, v60
    v_fract_f32 v70, v60
    v_add_u32 v60, 9, v63
    v_mul_u32_u24 v60, v60, v62
    v_cvt_f32_u32 v60, v60
    v_mul_f32 v60, 0x3ae38e39, v60
    v_fract_f32 v71, v60
    v_cos_f32 v72, v68
    v_sin_f32 v73, v68
    v_cos_f32 v74, v69
    v_sin_f32 v75, v69
    v_cos_f32 v76, v70
    v_sin_f32 v77, v70
    v_cos_f32 v78, v71
    v_sin_f32 v79, v71
    v_cvt_pk_bf16_f32 v64, v72, v73
    v_cvt_pk_bf16_f32 v65, v74, v75
    v_cvt_pk_bf16_f32 v66, v76, v77
    v_cvt_pk_bf16_f32 v67, v78, v79
    v_lshlrev_b32 v60, 31, v62
    v_or_b32 v60, 0x3f003f00, v60
    v_cmp_eq_u32 vcc, 0, v63
    s_nop 1
    v_cndmask_b32 v64, v64, v60, vcc
    s_add_u32 s38, s38, 5184
    s_lshl_b32 s38, s38, 10
    v_lshlrev_b32 v60, 4, v1
    s_waitcnt vmcnt(0)
    v_perm_b32 v32, v24, v16, s60
    v_perm_b32 v33, v26, v18, s60
    v_perm_b32 v34, v28, v20, s60
    v_perm_b32 v35, v30, v22, s60
    ds_write_b128 v2, v[32:35] offset:0
    v_perm_b32 v36, v24, v16, s61
    v_perm_b32 v37, v26, v18, s61
    v_perm_b32 v38, v28, v20, s61
    v_perm_b32 v39, v30, v22, s61
    ds_write_b128 v2, v[36:39] offset:16
    v_perm_b32 v40, v25, v17, s60
    v_perm_b32 v41, v27, v19, s60
    v_perm_b32 v42, v29, v21, s60
    v_perm_b32 v43, v31, v23, s60
    ds_write_b128 v2, v[40:43] offset:32
    v_perm_b32 v44, v25, v17, s61
    v_perm_b32 v45, v27, v19, s61
    v_perm_b32 v46, v29, v21, s61
    v_perm_b32 v47, v31, v23, s61
    ds_write_b128 v2, v[44:47] offset:48
    ds_read_b128 v[16:19], v3 offset:0
    ds_read_b128 v[20:23], v3 offset:1024
    s_waitcnt lgkmcnt(0)
    v_mov_b32 v12, 163824
    s_mov_b32 s98, 0x800000
m_Ag6_sg:
    ds_read_b32 v13, v12 offset:8
    s_sub_u32 s98, s98, 1
    s_cbranch_scc1 m_Ag6_sg_x
    s_waitcnt lgkmcnt(0)
    v_cmp_gt_u32 vcc, 4, v13
    s_cbranch_vccnz m_Ag6_sg
m_Ag6_sg_x:
    s_waitcnt lgkmcnt(0)
    s_mul_i32 s96, s96, 0x9e3779b1
    s_add_u32 s96, s96, 0x7f4a7c15
    buffer_load_dwordx4 v108, s[8:11], s16 offen lds
    buffer_load_dwordx4 v109, s[8:11], s16 offen offset:1024 lds
    s_add_u32 s16, s16, 9216
    s_mov_b32 m0, 18432
    s_nop 0
    buffer_load_dwordx4 v108, s[8:11], s16 offen lds
    buffer_load_dwordx4 v109, s[8:11], s16 offen offset:1024 lds
    s_add_u32 s16, s16, 9216
    s_mov_b32 m0, 32768
    s_nop 0
    buffer_load_dwordx4 v108, s[8:11], s16 offen lds
    buffer_load_dwordx4 v109, s[8:11], s16 offen offset:1024 lds
    s_add_u32 s16, s16, 9216
    s_mov_b32 m0, 47104
    s_nop 0
    buffer_load_dwordx4 v108, s[8:11], s16 offen lds
    buffer_load_dwordx4 v109, s[8:11], s16 offen offset:1024 lds
    s_add_u32 s16, s16, 9216
    s_mov_b32 m0, 61440
    s_nop 0
    buffer_load_dwordx4 v108, s[8:11], s16 offen lds
    buffer_load_dwordx4 v109, s[8:11], s16 offen offset:1024 lds
    s_add_u32 s16, s16, 9216
    s_mov_b32 m0, 75776
    s_nop 0
    buffer_load_dwordx4 v108, s[8:11], s16 offen lds
    buffer_load_dwordx4 v109, s[8:11], s16 offen offset:1024 lds
    s_add_u32 s16, s16, 9216
    s_mov_b32 m0, 90112
    s_nop 0
    buffer_load_dwordx4 v108, s[8:11], s16 offen lds
    buffer_load_dwordx4 v109, s[8:11], s16 offen offset:1024 lds
    s_add_u32 s16, s16, 9216
    s_mov_b32 m0, 104448
    s_nop 0
    buffer_load_dwordx4 v108, s[8:11], s16 offen lds
    buffer_load_dwordx4 v109, s[8:11], s16 offen offset:1024 lds
    s_add_u32 s16, s16, 9216
    s_mov_b32 m0, 12288
    v_mov_b32 v96, 163824
    s_cmp_ge_u32 s2, 162
    s_cbranch_scc1 m_Ag6_nomt
    buffer_store_dwordx4 v[64:67], v60, s[48:51], s38 offen sc1
m_Ag6_nomt:
    buffer_store_dwordx4 v[16:19], v8, s[56:59], s62 offen offset:0 sc1
    buffer_store_dwordx4 v[20:23], v8, s[56:59], s62 offen offset:128 sc1
    s_mov_b32 s98, 0x800000
m_A_sp2:
    ds_read_b32 v97, v96 offset:0
    s_sub_u32 s98, s98, 1
    s_cbranch_scc1 m_A_sp2_x
    s_waitcnt lgkmcnt(0)
    v_cmp_ne_u32 vcc, 2, v97
    s_cbranch_vccnz m_A_sp2
m_A_sp2_x:
    buffer_load_dwordx4 v110, s[12:15], s17 offen offset:0 lds
    s_mov_b32 m0, 24576
    s_add_u32 s17, s17, 73728
    buffer_load_dwordx4 v110, s[12:15], s20 offen offset:0 lds
    buffer_load_dwordx4 v110, s[12:15], s20 offen offset:1024 lds
    s_mov_b32 m0, 40960
    s_add_u32 s20, s20, 73728
    buffer_load_dwordx4 v110, s[12:15], s17 offen offset:0 lds
    s_mov_b32 m0, 53248
    s_add_u32 s17, s17, 73728
    buffer_load_dwordx4 v110, s[12:15], s20 offen offset:0 lds
    buffer_load_dwordx4 v110, s[12:15], s20 offen offset:1024 lds
    s_mov_b32 m0, 69632
    s_add_u32 s20, s20, 73728
    buffer_load_dwordx4 v110, s[12:15], s17 offen offset:0 lds
    s_mov_b32 m0, 81920
    s_add_u32 s17, s17, 73728
    buffer_load_dwordx4 v110, s[12:15], s20 offen offset:0 lds
    buffer_load_dwordx4 v110, s[12:15], s20 offen offset:1024 lds
    s_mov_b32 m0, 98304
    s_add_u32 s20, s20, 73728
    buffer_load_dwordx4 v110, s[12:15], s17 offen offset:0 lds
    s_mov_b32 m0, 110592
    s_add_u32 s17, s17, 73728
    buffer_load_dwordx4 v110, s[12:15], s20 offen offset:0 lds
    buffer_load_dwordx4 v110, s[12:15], s20 offen offset:1024 lds
    s_mov_b32 m0, 118784
    s_mov_b32 s44, s8
    s_mov_b32 s45, s9
    s_mov_b32 s46, 0x1200000
    s_mov_b32 s47, 0x20000
    s_sub_u32 s26, s26, 1
    s_cbranch_scc0 m_A_tb_25
    buffer_load_dword v127, v98, s[44:47], 0 offen
    s_cmp_eq_u32 s27, 1
    s_cselect_b64 s[44:45], s[4:5], s[44:45]
    s_sub_u32 s27, s27, 1
    s_cselect_b32 s26, 1000, 8
    v_mov_b32 v98, v99
    v_mov_b32 v99, v100
m_A_tb_25:
    s_waitcnt vmcnt(8)
    s_barrier
    buffer_load_dwordx4 v108, s[8:11], s16 offen lds
    buffer_load_dwordx4 v109, s[8:11], s16 offen offset:1024 lds
    s_mov_b32 m0, 126976
    s_add_u32 s16, s16, 9216
    s_add_u32 s20, s20, 73728
    buffer_load_dwordx4 v110, s[12:15], s17 offen offset:0 lds
    s_mov_b32 m0, 133120
    s_nop 0
    buffer_load_dwordx4 v108, s[8:11], s16 offen lds
    buffer_load_dwordx4 v109, s[8:11], s16 offen offset:1024 lds
    s_mov_b32 m0, 139264
    s_add_u32 s16, s16, 9216
    s_add_u32 s17, s17, 73728
    buffer_load_dwordx4 v110, s[12:15], s20 offen offset:0 lds
    buffer_load_dwordx4 v110, s[12:15], s20 offen offset:1024 lds
    s_mov_b32 m0, 4096
    s_sub_u32 s26, s26, 1
    s_cbranch_scc0 m_A_tb_26
    buffer_load_dword v127, v98, s[44:47], 0 offen
    s_cmp_eq_u32 s27, 1
    s_cselect_b64 s[44:45], s[4:5], s[44:45]
    s_sub_u32 s27, s27, 1
    s_cselect_b32 s26, 1000, 8
    v_mov_b32 v98, v99
    v_mov_b32 v99, v100
m_A_tb_26:
    s_waitcnt vmcnt(12)
    s_barrier
    buffer_load_dwordx4 v108, s[8:11], s16 offen lds
    buffer_load_dwordx4 v109, s[8:11], s16 offen offset:1024 lds
    s_mov_b32 m0, 12288
    s_add_u32 s16, s16, 9216
    s_add_u32 s20, s20, 73728
    buffer_load_dwordx4 v110, s[12:15], s17 offen offset:0 lds
    s_mov_b32 m0, 18432
    s_nop 0
    buffer_load_dwordx4 v108, s[8:11], s16 offen lds
    buffer_load_dwordx4 v109, s[8:11], s16 offen offset:1024 lds
    s_mov_b32 m0, 24576
    s_add_u32 s16, s16, 9216
    s_add_u32 s17, s17, 73728
    buffer_load_dwordx4 v110, s[12:15], s20 offen offset:0 lds
    buffer_load_dwordx4 v110, s[12:15], s20 offen offset:1024 lds
    s_mov_b32 m0, 32768
    s_sub_u32 s26, s26, 1
    s_cbranch_scc0 m_A_tb_27
    buffer_load_dword v127, v98, s[44:47], 0 offen
    s_cmp_eq_u32 s27, 1
    s_cselect_b64 s[44:45], s[4:5], s[44:45]
    s_sub_u32 s27, s27, 1
    s_cselect_b32 s26, 1000, 8
    v_mov_b32 v98, v99
    v_mov_b32 v99, v100
m_A_tb_27:
    s_waitcnt vmcnt(16)
    s_barrier
    buffer_load_dwordx4 v108, s[8:11], s16 offen lds
    buffer_load_dwordx4 v109, s[8:11], s16 offen offset:1024 lds
    s_mov_b32 m0, 40960
    s_add_u32 s16, s16, 9216
    s_add_u32 s20, s20, 73728
    buffer_load_dwordx4 v110, s[12:15], s17 offen offset:0 lds
    s_mov_b32 m0, 47104
    s_nop 0
    buffer_load_dwordx4 v108, s[8:11], s16 offen lds
    buffer_load_dwordx4 v109, s[8:11], s16 offen offset:1024 lds
    s_mov_b32 m0, 53248
    s_add_u32 s16, s16, 9216
    s_add_u32 s17, s17, 73728
    buffer_load_dwordx4 v110, s[12:15], s20 offen offset:0 lds
    buffer_load_dwordx4 v110, s[12:15], s20 offen offset:1024 lds
    s_mov_b32 m0, 61440
    s_sub_u32 s26, s26, 1
    s_cbranch_scc0 m_A_tb_28
    buffer_load_dword v127, v98, s[44:47], 0 offen
    s_cmp_eq_u32 s27, 1
    s_cselect_b64 s[44:45], s[4:5], s[44:45]
    s_sub_u32 s27, s27, 1
    s_cselect_b32 s26, 1000, 8
    v_mov_b32 v98, v99
    v_mov_b32 v99, v100
m_A_tb_28:
    s_mov_b32 s21, 5
m_A_main_29:
    s_waitcnt vmcnt(18)
    s_barrier
    buffer_load_dwordx4 v108, s[8:11], s16 offen lds
    buffer_load_dwordx4 v109, s[8:11], s16 offen offset:1024 lds
    s_mov_b32 m0, 69632
    s_add_u32 s16, s16, 9216
    s_add_u32 s20, s20, 73728
    buffer_load_dwordx4 v110, s[12:15], s17 offen offset:0 lds
    s_mov_b32 m0, 75776
    s_nop 0
    buffer_load_dwordx4 v108, s[8:11], s16 offen lds
    buffer_load_dwordx4 v109, s[8:11], s16 offen offset:1024 lds
    s_mov_b32 m0, 81920
    s_add_u32 s16, s16, 9216
    s_add_u32 s17, s17, 73728
    buffer_load_dwordx4 v110, s[12:15], s20 offen offset:0 lds
    buffer_load_dwordx4 v110, s[12:15], s20 offen offset:1024 lds
    s_mov_b32 m0, 90112
    s_sub_u32 s26, s26, 1
    s_cbranch_scc0 m_A_tb_30
    buffer_load_dword v127, v98, s[44:47], 0 offen
    s_cmp_eq_u32 s27, 1
    s_cselect_b64 s[44:45], s[4:5], s[44:45]
    s_sub_u32 s27, s27, 1
    s_cselect_b32 s26, 1000, 8
    v_mov_b32 v98, v99
    v_mov_b32 v99, v100
m_A_tb_30:
    s_waitcnt vmcnt(18)
    s_barrier
    buffer_load_dwordx4 v108, s[8:11], s16 offen lds
    buffer_load_dwordx4 v109, s[8:11], s16 offen offset:1024 lds
    s_mov_b32 m0, 98304
    s_add_u32 s16, s16, 9216
    s_add_u32 s20, s20, 73728
    buffer_load_dwordx4 v110, s[12:15], s17 offen offset:0 lds
    s_mov_b32 m0, 104448
    s_nop 0
    buffer_load_dwordx4 v108, s[8:11], s16 offen lds
    buffer_load_dwordx4 v109, s[8:11], s16 offen offset:1024 lds
    s_mov_b32 m0, 110592
    s_add_u32 s16, s16, 9216
    s_add_u32 s17, s17, 73728
    buffer_load_dwordx4 v110, s[12:15], s20 offen offset:0 lds
    buffer_load_dwordx4 v110, s[12:15], s20 offen offset:1024 lds
    s_mov_b32 m0, 118784
    s_sub_u32 s26, s26, 1
    s_cbranch_scc0 m_A_tb_31
    buffer_load_dword v127, v98, s[44:47], 0 offen
    s_cmp_eq_u32 s27, 1
    s_cselect_b64 s[44:45], s[4:5], s[44:45]
    s_sub_u32 s27, s27, 1
    s_cselect_b32 s26, 1000, 8
    v_mov_b32 v98, v99
    v_mov_b32 v99, v100
m_A_tb_31:
    s_waitcnt vmcnt(18)
    s_barrier
    buffer_load_dwordx4 v108, s[8:11], s16 offen lds
    buffer_load_dwordx4 v109, s[8:11], s16 offen offset:1024 lds
    s_mov_b32 m0, 126976
    s_add_u32 s16, s16, 9216
    s_add_u32 s20, s20, 73728
    buffer_load_dwordx4 v110, s[12:15], s17 offen offset:0 lds
    s_mov_b32 m0, 133120
    s_nop 0
    buffer_load_dwordx4 v108, s[8:11], s16 offen lds
    buffer_load_dwordx4 v109, s[8:11], s16 offen offset:1024 lds
    s_mov_b32 m0, 139264
    s_add_u32 s16, s16, 9216
    s_add_u32 s17, s17, 73728
    buffer_load_dwordx4 v110, s[12:15], s20 offen offset:0 lds
    buffer_load_dwordx4 v110, s[12:15], s20 offen offset:1024 lds
    s_mov_b32 m0, 4096
    s_sub_u32 s26, s26, 1
    s_cbranch_scc0 m_A_tb_32
    buffer_load_dword v127, v98, s[44:47], 0 offen
    s_cmp_eq_u32 s27, 1
    s_cselect_b64 s[44:45], s[4:5], s[44:45]
    s_sub_u32 s27, s27, 1
    s_cselect_b32 s26, 1000, 8
    v_mov_b32 v98, v99
    v_mov_b32 v99, v100
m_A_tb_32:
    s_waitcnt vmcnt(18)
    s_barrier
    buffer_load_dwordx4 v108, s[8:11], s16 offen lds
    buffer_load_dwordx4 v109, s[8:11], s16 offen offset:1024 lds
    s_mov_b32 m0, 12288
    s_add_u32 s16, s16, 9216
    s_add_u32 s20, s20, 73728
    buffer_load_dwordx4 v110, s[12:15], s17 offen offset:0 lds
    s_mov_b32 m0, 18432
    s_nop 0
    buffer_load_dwordx4 v108, s[8:11], s16 offen lds
    buffer_load_dwordx4 v109, s[8:11], s16 offen offset:1024 lds
    s_mov_b32 m0, 24576
    s_add_u32 s16, s16, 9216
    s_add_u32 s17, s17, 73728
    buffer_load_dwordx4 v110, s[12:15], s20 offen offset:0 lds
    buffer_load_dwordx4 v110, s[12:15], s20 offen offset:1024 lds
    s_mov_b32 m0, 32768
    s_sub_u32 s26, s26, 1
    s_cbranch_scc0 m_A_tb_33
    buffer_load_dword v127, v98, s[44:47], 0 offen
    s_cmp_eq_u32 s27, 1
    s_cselect_b64 s[44:45], s[4:5], s[44:45]
    s_sub_u32 s27, s27, 1
    s_cselect_b32 s26, 1000, 8
    v_mov_b32 v98, v99
    v_mov_b32 v99, v100
m_A_tb_33:
    s_waitcnt vmcnt(18)
    s_barrier
    buffer_load_dwordx4 v108, s[8:11], s16 offen lds
    buffer_load_dwordx4 v109, s[8:11], s16 offen offset:1024 lds
    s_mov_b32 m0, 40960
    s_add_u32 s16, s16, 9216
    s_add_u32 s20, s20, 73728
    buffer_load_dwordx4 v110, s[12:15], s17 offen offset:0 lds
    s_mov_b32 m0, 47104
    s_nop 0
    buffer_load_dwordx4 v108, s[8:11], s16 offen lds
    buffer_load_dwordx4 v109, s[8:11], s16 offen offset:1024 lds
    s_mov_b32 m0, 53248
    s_add_u32 s16, s16, 9216
    s_add_u32 s17, s17, 73728
    buffer_load_dwordx4 v110, s[12:15], s20 offen offset:0 lds
    buffer_load_dwordx4 v110, s[12:15], s20 offen offset:1024 lds
    s_mov_b32 m0, 61440
    s_sub_u32 s26, s26, 1
    s_cbranch_scc0 m_A_tb_34
    buffer_load_dword v127, v98, s[44:47], 0 offen
    s_cmp_eq_u32 s27, 1
    s_cselect_b64 s[44:45], s[4:5], s[44:45]
    s_sub_u32 s27, s27, 1
    s_cselect_b32 s26, 1000, 8
    v_mov_b32 v98, v99
    v_mov_b32 v99, v100
m_A_tb_34:
    s_sub_u32 s21, s21, 1
    s_cmp_lg_u32 s21, 0
    s_cbranch_scc1 m_A_main_29
m_A_lt_36:
    s_waitcnt vmcnt(18)
    s_barrier
    s_and_b32 s34, s2, 1
    s_lshl_b32 s52, s34, 7
    s_add_u32 s52, s52, 246400
    s_add_u32 s48, s40, 0x310000
    s_addc_u32 s49, s41, 0
    s_mov_b32 s50, 0xa8000
    s_mov_b32 s51, 0x20000
    s_buffer_load_dword s54, s[48:51], s52
    s_bfe_u32 s33, s2, 0x20001
    s_bfe_u32 s35, s2, 0x20003
    s_mul_i32 s37, s35, 9
    s_mul_i32 s3, s33, 5
    s_sub_u32 s3, s3, 2
    s_lshl_b32 s53, s33, 2
    s_max_i32 s3, s3, s53
    s_lshl_b32 s53, s3, 1
    s_lshl_b32 s26, s3, 17
    s_add_u32 s32, s32, s26
    s_mul_i32 s3, s3, 36
    s_add_u32 s3, s3, s37
    s_add_u32 s3, s3, 5184
    s_lshl_b32 s26, s3, 10
    s_and_b32 s3, s35, 1
    s_add_u32 s12, s40, 0x7ff800
    s_addc_u32 s13, s41, 0
    s_mov_b32 s14, 0x5b2800
    s_mov_b32 s15, 0x20000
    s_add_u32 s23, s33, 2
    s_and_b32 s23, s23, 3
    s_lshl1_add_u32 s23, s23, s3
    s_add_u32 s23, s23, 3
    s_lshl_b32 s23, s23, 10
    v_add_u32 v111, s23, v110
    s_add_u32 s23, s33, 3
    s_and_b32 s23, s23, 3
    s_lshl1_add_u32 s23, s23, s3
    s_add_u32 s23, s23, 1
    s_lshl_b32 s23, s23, 10
    v_add_u32 v112, s23, v110
    s_add_u32 s23, s33, 2
    s_and_b32 s23, s23, 3
    s_lshl1_add_u32 s23, s23, s3
    s_add_u32 s23, s23, 2
    s_lshl_b32 s23, s23, 10
    v_add_u32 v113, s23, v110
    s_add_u32 s23, s33, 2
    s_and_b32 s23, s23, 3
    s_lshl1_add_u32 s23, s23, s3
    s_add_u32 s23, s23, 2
    s_lshl_b32 s23, s23, 10
    v_add_u32 v114, s23, v110
    s_add_u32 s23, s33, 3
    s_and_b32 s23, s23, 3
    s_lshl1_add_u32 s23, s23, s3
    s_add_u32 s23, s23, 0
    s_lshl_b32 s23, s23, 10
    v_add_u32 v115, s23, v110
    v_mov_b32 v126, 0
    s_waitcnt vmcnt(11)
    s_barrier
    s_waitcnt lgkmcnt(0)
    s_cmp_eq_u32 s54, s96
    s_cbranch_scc1 m_A_zk2_x
    s_mov_b64 exec, 1
    s_mov_b32 s98, 0x80000
m_A_zk2:
    v_mov_b32 v125, 0
    buffer_atomic_or v125, v126, s[48:51], s52 offen sc0 sc1
    s_sub_u32 s98, s98, 1
    s_cbranch_scc1 m_A_zk2_x
    s_waitcnt vmcnt(0)
    v_cmp_ne_u32 vcc, s96, v125
    s_nop 0
    s_and_b64 exec, exec, vcc
    s_cbranch_scc1 m_A_zk2
m_A_zk2_x:
    s_mov_b64 exec, -1
    s_mov_b32 m0, 82944
    s_nop 0
    buffer_load_dwordx4 v111, s[12:15], s26 offen offset:0 lds
    buffer_load_dwordx4 v112, s[12:15], s26 offen offset:1024 lds
    s_add_u32 s26, s26, 36864
    s_mov_b32 m0, 99328
    s_nop 0
    buffer_load_dwordx4 v113, s[12:15], s26 offen offset:0 lds
    buffer_load_dwordx4 v114, s[12:15], s26 offen offset:1024 lds
    buffer_load_dwordx4 v115, s[12:15], s26 offen offset:2048 lds
    s_add_u32 s26, s26, 36864
    s_waitcnt vmcnt(9)
    s_barrier
    s_mov_b32 m0, 117760
    s_nop 0
    buffer_load_dwordx4 v111, s[12:15], s26 offen offset:0 lds
    buffer_load_dwordx4 v112, s[12:15], s26 offen offset:1024 lds
    s_add_u32 s26, s26, 36864
    s_mov_b32 m0, 134144
    s_nop 0
    buffer_load_dwordx4 v113, s[12:15], s26 offen offset:0 lds
    buffer_load_dwordx4 v114, s[12:15], s26 offen offset:1024 lds
    buffer_load_dwordx4 v115, s[12:15], s26 offen offset:2048 lds
    s_add_u32 s26, s26, 36864
    s_waitcnt vmcnt(10)
    s_barrier
    s_cmp_lt_u32 s33, 2
    s_cbranch_scc1 m_A_zs2
    s_mov_b32 m0, 152576
    s_nop 0
    buffer_load_dwordx4 v111, s[12:15], s26 offen offset:0 lds
    buffer_load_dwordx4 v112, s[12:15], s26 offen offset:1024 lds
    s_add_u32 s26, s26, 36864
m_A_zs2:
m_A_le_35:
    s_branch m_B
m_A_ld3:
    s_add_u32 s20, s17, 40960
    s_add_u32 s17, s17, 5120
    s_load_dwordx2 s[4:5], s[0:1], 48
    s_lshl_b32 s26, s34, 8
    s_mov_b32 s27, 52429
    s_add_u32 s26, s26, 6912
    v_add_u32 v102, s26, v1
    v_mul_u32_u24 v103, s27, v102
    v_lshrrev_b32 v103, 19, v103
    v_mul_u32_u24 v98, 10, v103
    v_sub_u32 v102, v102, v98
    v_and_b32 v98, 31, v103
    v_lshrrev_b32 v103, 5, v103
    v_min_u32 v103, 63, v103
    v_lshl_add_u32 v103, v98, 6, v103
    v_mul_u32_u24 v103, 9216, v103
    v_lshl_add_u32 v98, v102, 7, v103
    v_add_u32 v98, s31, v98
    s_add_u32 s26, s26, 6912
    v_add_u32 v102, s26, v1
    v_mul_u32_u24 v103, s27, v102
    v_lshrrev_b32 v103, 19, v103
    v_mul_u32_u24 v99, 10, v103
    v_sub_u32 v102, v102, v99
    v_and_b32 v99, 31, v103
    v_lshrrev_b32 v103, 5, v103
    v_min_u32 v103, 63, v103
    v_lshl_add_u32 v103, v99, 6, v103
    v_mul_u32_u24 v103, 9216, v103
    v_lshl_add_u32 v99, v102, 7, v103
    v_add_u32 v99, s31, v99
    s_lshr_b32 s27, s33, 1
    s_mov_b32 s26, 0
    s_cmp_eq_u32 s27, 1
    s_cselect_b32 s26, 72, s26
    s_cmp_eq_u32 s27, 2
    s_cselect_b32 s26, 144, s26
    s_cmp_eq_u32 s27, 3
    s_cselect_b32 s26, 216, s26
    s_add_u32 s26, s26, s34
    s_lshl_b32 s26, s26, 5
    s_and_b32 s27, s33, 1
    s_add_u32 s26, s26, s27
    s_lshl_b32 s26, s26, 11
    s_add_u32 s26, s26, 49152
    v_and_b32 v102, 15, v1
    v_lshrrev_b32 v103, 4, v1
    v_lshl_add_u32 v102, v103, 5, v102
    v_lshl_add_u32 v100, v102, 7, s26
    s_mul_i32 s26, s34, 77
    s_lshr_b32 s26, s26, 8
    s_add_u32 s26, s26, 1
    s_mov_b32 s27, 2
    s_mov_b32 m0, 6144
    s_mov_b32 s12, s40
    s_mov_b32 s13, s41
    s_mov_b32 s14, 0x240000
    s_mov_b32 s15, 0x20000
    s_lshl2_add_u32 s38, s2, 3
    s_add_u32 s48, s28, 0x800000
    s_addc_u32 s49, s29, 0
    s_mov_b32 s50, 0x5b2000
    s_mov_b32 s51, 0x20000
    s_mul_i32 s39, s38, 1821
    s_lshr_b32 s39, s39, 16
    s_mul_i32 s42, s39, 36
    s_sub_u32 s42, s38, s42
    s_lshr_b32 s43, s42, 1
    s_lshl_b32 s43, s43, 5
    s_and_b32 s42, s42, 1
    s_lshl2_add_u32 s43, s42, s43
    v_bfe_u32 v60, v1, 2, 2
    v_and_b32 v61, 3, v1
    v_lshl_add_u32 v60, v60, 3, v61
    v_add_u32 v62, s43, v60
    s_lshl_b32 s42, s39, 4
    v_lshrrev_b32 v60, 4, v1
    v_lshl_add_u32 v63, v60, 1, s42
    v_add_u32 v60, 0, v63
    v_mul_u32_u24 v60, v60, v62
    v_cvt_f32_u32 v60, v60
    v_mul_f32 v60, 0x3ae38e39, v60
    v_fract_f32 v68, v60
    v_add_u32 v60, 1, v63
    v_mul_u32_u24 v60, v60, v62
    v_cvt_f32_u32 v60, v60
    v_mul_f32 v60, 0x3ae38e39, v60
    v_fract_f32 v69, v60
    v_add_u32 v60, 8, v63
    v_mul_u32_u24 v60, v60, v62
    v_cvt_f32_u32 v60, v60
    v_mul_f32 v60, 0x3ae38e39, v60
    v_fract_f32 v70, v60
    v_add_u32 v60, 9, v63
    v_mul_u32_u24 v60, v60, v62
    v_cvt_f32_u32 v60, v60
    v_mul_f32 v60, 0x3ae38e39, v60
    v_fract_f32 v71, v60
    v_cos_f32 v72, v68
    v_sin_f32 v73, v68
    v_cos_f32 v74, v69
    v_sin_f32 v75, v69
    v_cos_f32 v76, v70
    v_sin_f32 v77, v70
    v_cos_f32 v78, v71
    v_sin_f32 v79, v71
    v_cvt_pk_bf16_f32 v64, v72, v73
    v_cvt_pk_bf16_f32 v65, v74, v75
    v_cvt_pk_bf16_f32 v66, v76, v77
    v_cvt_pk_bf16_f32 v67, v78, v79
    v_lshlrev_b32 v60, 31, v62
    v_or_b32 v60, 0x3f003f00, v60
    v_cmp_eq_u32 vcc, 0, v63
    s_nop 1
    v_cndmask_b32 v64, v64, v60, vcc
    s_add_u32 s38, s38, 5184
    s_lshl_b32 s38, s38, 10
    v_lshlrev_b32 v60, 4, v1
    v_mov_b32 v12, 163824
    s_mov_b32 s98, 0x800000
m_Ag7_sg:
    ds_read_b32 v13, v12 offset:8
    s_sub_u32 s98, s98, 1
    s_cbranch_scc1 m_Ag7_sg_x
    s_waitcnt lgkmcnt(0)
    v_cmp_gt_u32 vcc, 4, v13
    s_cbranch_vccnz m_Ag7_sg
m_Ag7_sg_x:
    s_waitcnt lgkmcnt(0)
    s_mul_i32 s96, s96, 0x9e3779b1
    s_add_u32 s96, s96, 0x7f4a7c15
    buffer_load_dwordx4 v108, s[8:11], s16 offen lds
    buffer_load_dwordx4 v109, s[8:11], s16 offen offset:1024 lds
    s_add_u32 s16, s16, 9216
    s_mov_b32 m0, 20480
    s_nop 0
    buffer_load_dwordx4 v108, s[8:11], s16 offen lds
    buffer_load_dwordx4 v109, s[8:11], s16 offen offset:1024 lds
    s_add_u32 s16, s16, 9216
    s_mov_b32 m0, 34816
    s_nop 0
    buffer_load_dwordx4 v108, s[8:11], s16 offen lds
    buffer_load_dwordx4 v109, s[8:11], s16 offen offset:1024 lds
    s_add_u32 s16, s16, 9216
    s_mov_b32 m0, 49152
    s_nop 0
    buffer_load_dwordx4 v108, s[8:11], s16 offen lds
    buffer_load_dwordx4 v109, s[8:11], s16 offen offset:1024 lds
    s_add_u32 s16, s16, 9216
    s_mov_b32 m0, 63488
    s_nop 0
    buffer_load_dwordx4 v108, s[8:11], s16 offen lds
    buffer_load_dwordx4 v109, s[8:11], s16 offen offset:1024 lds
    s_add_u32 s16, s16, 9216
    s_mov_b32 m0, 77824
    s_nop 0
    buffer_load_dwordx4 v108, s[8:11], s16 offen lds
    buffer_load_dwordx4 v109, s[8:11], s16 offen offset:1024 lds
    s_add_u32 s16, s16, 9216
    s_mov_b32 m0, 92160
    s_nop 0
    buffer_load_dwordx4 v108, s[8:11], s16 offen lds
    buffer_load_dwordx4 v109, s[8:11], s16 offen offset:1024 lds
    s_add_u32 s16, s16, 9216
    s_mov_b32 m0, 106496
    s_nop 0
    buffer_load_dwordx4 v108, s[8:11], s16 offen lds
    buffer_load_dwordx4 v109, s[8:11], s16 offen offset:1024 lds
    s_add_u32 s16, s16, 9216
    s_mov_b32 m0, 13312
    v_mov_b32 v96, 163824
    s_cmp_ge_u32 s2, 162
    s_cbranch_scc1 m_Ag7_nomt
    buffer_store_dwordx4 v[64:67], v60, s[48:51], s38 offen sc1
m_Ag7_nomt:
    s_mov_b32 s98, 0x800000
m_A_sp3:
    ds_read_b32 v97, v96 offset:0
    s_sub_u32 s98, s98, 1
    s_cbranch_scc1 m_A_sp3_x
    s_waitcnt lgkmcnt(0)
    v_cmp_ne_u32 vcc, 2, v97
    s_cbranch_vccnz m_A_sp3
m_A_sp3_x:
    buffer_load_dwordx4 v110, s[12:15], s17 offen offset:0 lds
    s_mov_b32 m0, 26624
    s_add_u32 s17, s17, 73728
    buffer_load_dwordx4 v110, s[12:15], s20 offen offset:0 lds
    buffer_load_dwordx4 v110, s[12:15], s20 offen offset:1024 lds
    s_mov_b32 m0, 41984
    s_add_u32 s20, s20, 73728
    buffer_load_dwordx4 v110, s[12:15], s17 offen offset:0 lds
    s_mov_b32 m0, 55296
    s_add_u32 s17, s17, 73728
    buffer_load_dwordx4 v110, s[12:15], s20 offen offset:0 lds
    buffer_load_dwordx4 v110, s[12:15], s20 offen offset:1024 lds
    s_mov_b32 m0, 70656
    s_add_u32 s20, s20, 73728
    buffer_load_dwordx4 v110, s[12:15], s17 offen offset:0 lds
    s_mov_b32 m0, 83968
    s_add_u32 s17, s17, 73728
    buffer_load_dwordx4 v110, s[12:15], s20 offen offset:0 lds
    buffer_load_dwordx4 v110, s[12:15], s20 offen offset:1024 lds
    s_mov_b32 m0, 99328
    s_add_u32 s20, s20, 73728
    buffer_load_dwordx4 v110, s[12:15], s17 offen offset:0 lds
    s_mov_b32 m0, 112640
    s_add_u32 s17, s17, 73728
    buffer_load_dwordx4 v110, s[12:15], s20 offen offset:0 lds
    buffer_load_dwordx4 v110, s[12:15], s20 offen offset:1024 lds
    s_mov_b32 m0, 120832
    s_mov_b32 s44, s8
    s_mov_b32 s45, s9
    s_mov_b32 s46, 0x1200000
    s_mov_b32 s47, 0x20000
    s_sub_u32 s26, s26, 1
    s_cbranch_scc0 m_A_tb_37
    buffer_load_dword v127, v98, s[44:47], 0 offen
    s_cmp_eq_u32 s27, 1
    s_cselect_b64 s[44:45], s[4:5], s[44:45]
    s_sub_u32 s27, s27, 1
    s_cselect_b32 s26, 1000, 8
    v_mov_b32 v98, v99
    v_mov_b32 v99, v100
m_A_tb_37:
    s_waitcnt vmcnt(8)
    s_barrier
    buffer_load_dwordx4 v108, s[8:11], s16 offen lds
    buffer_load_dwordx4 v109, s[8:11], s16 offen offset:1024 lds
    s_mov_b32 m0, 128000
    s_add_u32 s16, s16, 9216
    s_add_u32 s20, s20, 73728
    buffer_load_dwordx4 v110, s[12:15], s17 offen offset:0 lds
    s_mov_b32 m0, 135168
    s_nop 0
    buffer_load_dwordx4 v108, s[8:11], s16 offen lds
    buffer_load_dwordx4 v109, s[8:11], s16 offen offset:1024 lds
    s_mov_b32 m0, 141312
    s_add_u32 s16, s16, 9216
    s_add_u32 s17, s17, 73728
    buffer_load_dwordx4 v110, s[12:15], s20 offen offset:0 lds
    buffer_load_dwordx4 v110, s[12:15], s20 offen offset:1024 lds
    s_mov_b32 m0, 6144
    s_sub_u32 s26, s26, 1
    s_cbranch_scc0 m_A_tb_38
    buffer_load_dword v127, v98, s[44:47], 0 offen
    s_cmp_eq_u32 s27, 1
    s_cselect_b64 s[44:45], s[4:5], s[44:45]
    s_sub_u32 s27, s27, 1
    s_cselect_b32 s26, 1000, 8
    v_mov_b32 v98, v99
    v_mov_b32 v99, v100
m_A_tb_38:
    s_waitcnt vmcnt(12)
    s_barrier
    buffer_load_dwordx4 v108, s[8:11], s16 offen lds
    buffer_load_dwordx4 v109, s[8:11], s16 offen offset:1024 lds
    s_mov_b32 m0, 13312
    s_add_u32 s16, s16, 9216
    s_add_u32 s20, s20, 73728
    buffer_load_dwordx4 v110, s[12:15], s17 offen offset:0 lds
    s_mov_b32 m0, 20480
    s_nop 0
    buffer_load_dwordx4 v108, s[8:11], s16 offen lds
    buffer_load_dwordx4 v109, s[8:11], s16 offen offset:1024 lds
    s_mov_b32 m0, 26624
    s_add_u32 s16, s16, 9216
    s_add_u32 s17, s17, 73728
    buffer_load_dwordx4 v110, s[12:15], s20 offen offset:0 lds
    buffer_load_dwordx4 v110, s[12:15], s20 offen offset:1024 lds
    s_mov_b32 m0, 34816
    s_sub_u32 s26, s26, 1
    s_cbranch_scc0 m_A_tb_39
    buffer_load_dword v127, v98, s[44:47], 0 offen
    s_cmp_eq_u32 s27, 1
    s_cselect_b64 s[44:45], s[4:5], s[44:45]
    s_sub_u32 s27, s27, 1
    s_cselect_b32 s26, 1000, 8
    v_mov_b32 v98, v99
    v_mov_b32 v99, v100
m_A_tb_39:
    s_waitcnt vmcnt(16)
    s_barrier
    buffer_load_dwordx4 v108, s[8:11], s16 offen lds
    buffer_load_dwordx4 v109, s[8:11], s16 offen offset:1024 lds
    s_mov_b32 m0, 41984
    s_add_u32 s16, s16, 9216
    s_add_u32 s20, s20, 73728
    buffer_load_dwordx4 v110, s[12:15], s17 offen offset:0 lds
    s_mov_b32 m0, 49152
    s_nop 0
    buffer_load_dwordx4 v108, s[8:11], s16 offen lds
    buffer_load_dwordx4 v109, s[8:11], s16 offen offset:1024 lds
    s_mov_b32 m0, 55296
    s_add_u32 s16, s16, 9216
    s_add_u32 s17, s17, 73728
    buffer_load_dwordx4 v110, s[12:15], s20 offen offset:0 lds
    buffer_load_dwordx4 v110, s[12:15], s20 offen offset:1024 lds
    s_mov_b32 m0, 63488
    s_sub_u32 s26, s26, 1
    s_cbranch_scc0 m_A_tb_40
    buffer_load_dword v127, v98, s[44:47], 0 offen
    s_cmp_eq_u32 s27, 1
    s_cselect_b64 s[44:45], s[4:5], s[44:45]
    s_sub_u32 s27, s27, 1
    s_cselect_b32 s26, 1000, 8
    v_mov_b32 v98, v99
    v_mov_b32 v99, v100
m_A_tb_40:
    s_mov_b32 s21, 5
m_A_main_41:
    s_waitcnt vmcnt(18)
    s_barrier
    buffer_load_dwordx4 v108, s[8:11], s16 offen lds
    buffer_load_dwordx4 v109, s[8:11], s16 offen offset:1024 lds
    s_mov_b32 m0, 70656
    s_add_u32 s16, s16, 9216
    s_add_u32 s20, s20, 73728
    buffer_load_dwordx4 v110, s[12:15], s17 offen offset:0 lds
    s_mov_b32 m0, 77824
    s_nop 0
    buffer_load_dwordx4 v108, s[8:11], s16 offen lds
    buffer_load_dwordx4 v109, s[8:11], s16 offen offset:1024 lds
    s_mov_b32 m0, 83968
    s_add_u32 s16, s16, 9216
    s_add_u32 s17, s17, 73728
    buffer_load_dwordx4 v110, s[12:15], s20 offen offset:0 lds
    buffer_load_dwordx4 v110, s[12:15], s20 offen offset:1024 lds
    s_mov_b32 m0, 92160
    s_sub_u32 s26, s26, 1
    s_cbranch_scc0 m_A_tb_42
    buffer_load_dword v127, v98, s[44:47], 0 offen
    s_cmp_eq_u32 s27, 1
    s_cselect_b64 s[44:45], s[4:5], s[44:45]
    s_sub_u32 s27, s27, 1
    s_cselect_b32 s26, 1000, 8
    v_mov_b32 v98, v99
    v_mov_b32 v99, v100
m_A_tb_42:
    s_waitcnt vmcnt(18)
    s_barrier
    buffer_load_dwordx4 v108, s[8:11], s16 offen lds
    buffer_load_dwordx4 v109, s[8:11], s16 offen offset:1024 lds
    s_mov_b32 m0, 99328
    s_add_u32 s16, s16, 9216
    s_add_u32 s20, s20, 73728
    buffer_load_dwordx4 v110, s[12:15], s17 offen offset:0 lds
    s_mov_b32 m0, 106496
    s_nop 0
    buffer_load_dwordx4 v108, s[8:11], s16 offen lds
    buffer_load_dwordx4 v109, s[8:11], s16 offen offset:1024 lds
    s_mov_b32 m0, 112640
    s_add_u32 s16, s16, 9216
    s_add_u32 s17, s17, 73728
    buffer_load_dwordx4 v110, s[12:15], s20 offen offset:0 lds
    buffer_load_dwordx4 v110, s[12:15], s20 offen offset:1024 lds
    s_mov_b32 m0, 120832
    s_sub_u32 s26, s26, 1
    s_cbranch_scc0 m_A_tb_43
    buffer_load_dword v127, v98, s[44:47], 0 offen
    s_cmp_eq_u32 s27, 1
    s_cselect_b64 s[44:45], s[4:5], s[44:45]
    s_sub_u32 s27, s27, 1
    s_cselect_b32 s26, 1000, 8
    v_mov_b32 v98, v99
    v_mov_b32 v99, v100
m_A_tb_43:
    s_waitcnt vmcnt(18)
    s_barrier
    buffer_load_dwordx4 v108, s[8:11], s16 offen lds
    buffer_load_dwordx4 v109, s[8:11], s16 offen offset:1024 lds
    s_mov_b32 m0, 128000
    s_add_u32 s16, s16, 9216
    s_add_u32 s20, s20, 73728
    buffer_load_dwordx4 v110, s[12:15], s17 offen offset:0 lds
    s_mov_b32 m0, 135168
    s_nop 0
    buffer_load_dwordx4 v108, s[8:11], s16 offen lds
    buffer_load_dwordx4 v109, s[8:11], s16 offen offset:1024 lds
    s_mov_b32 m0, 141312
    s_add_u32 s16, s16, 9216
    s_add_u32 s17, s17, 73728
    buffer_load_dwordx4 v110, s[12:15], s20 offen offset:0 lds
    buffer_load_dwordx4 v110, s[12:15], s20 offen offset:1024 lds
    s_mov_b32 m0, 6144
    s_sub_u32 s26, s26, 1
    s_cbranch_scc0 m_A_tb_44
    buffer_load_dword v127, v98, s[44:47], 0 offen
    s_cmp_eq_u32 s27, 1
    s_cselect_b64 s[44:45], s[4:5], s[44:45]
    s_sub_u32 s27, s27, 1
    s_cselect_b32 s26, 1000, 8
    v_mov_b32 v98, v99
    v_mov_b32 v99, v100
m_A_tb_44:
    s_waitcnt vmcnt(18)
    s_barrier
    buffer_load_dwordx4 v108, s[8:11], s16 offen lds
    buffer_load_dwordx4 v109, s[8:11], s16 offen offset:1024 lds
    s_mov_b32 m0, 13312
    s_add_u32 s16, s16, 9216
    s_add_u32 s20, s20, 73728
    buffer_load_dwordx4 v110, s[12:15], s17 offen offset:0 lds
    s_mov_b32 m0, 20480
    s_nop 0
    buffer_load_dwordx4 v108, s[8:11], s16 offen lds
    buffer_load_dwordx4 v109, s[8:11], s16 offen offset:1024 lds
    s_mov_b32 m0, 26624
    s_add_u32 s16, s16, 9216
    s_add_u32 s17, s17, 73728
    buffer_load_dwordx4 v110, s[12:15], s20 offen offset:0 lds
    buffer_load_dwordx4 v110, s[12:15], s20 offen offset:1024 lds
    s_mov_b32 m0, 34816
    s_sub_u32 s26, s26, 1
    s_cbranch_scc0 m_A_tb_45
    buffer_load_dword v127, v98, s[44:47], 0 offen
    s_cmp_eq_u32 s27, 1
    s_cselect_b64 s[44:45], s[4:5], s[44:45]
    s_sub_u32 s27, s27, 1
    s_cselect_b32 s26, 1000, 8
    v_mov_b32 v98, v99
    v_mov_b32 v99, v100
m_A_tb_45:
    s_waitcnt vmcnt(18)
    s_barrier
    buffer_load_dwordx4 v108, s[8:11], s16 offen lds
    buffer_load_dwordx4 v109, s[8:11], s16 offen offset:1024 lds
    s_mov_b32 m0, 41984
    s_add_u32 s16, s16, 9216
    s_add_u32 s20, s20, 73728
    buffer_load_dwordx4 v110, s[12:15], s17 offen offset:0 lds
    s_mov_b32 m0, 49152
    s_nop 0
    buffer_load_dwordx4 v108, s[8:11], s16 offen lds
    buffer_load_dwordx4 v109, s[8:11], s16 offen offset:1024 lds
    s_mov_b32 m0, 55296
    s_add_u32 s16, s16, 9216
    s_add_u32 s17, s17, 73728
    buffer_load_dwordx4 v110, s[12:15], s20 offen offset:0 lds
    buffer_load_dwordx4 v110, s[12:15], s20 offen offset:1024 lds
    s_mov_b32 m0, 63488
    s_sub_u32 s26, s26, 1
    s_cbranch_scc0 m_A_tb_46
    buffer_load_dword v127, v98, s[44:47], 0 offen
    s_cmp_eq_u32 s27, 1
    s_cselect_b64 s[44:45], s[4:5], s[44:45]
    s_sub_u32 s27, s27, 1
    s_cselect_b32 s26, 1000, 8
    v_mov_b32 v98, v99
    v_mov_b32 v99, v100
m_A_tb_46:
    s_sub_u32 s21, s21, 1
    s_cmp_lg_u32 s21, 0
    s_cbranch_scc1 m_A_main_41
m_A_lt_48:
    s_waitcnt vmcnt(18)
    s_barrier
    s_and_b32 s34, s2, 1
    s_lshl_b32 s52, s34, 7
    s_add_u32 s52, s52, 246400
    s_add_u32 s48, s40, 0x310000
    s_addc_u32 s49, s41, 0
    s_mov_b32 s50, 0xa8000
    s_mov_b32 s51, 0x20000
    s_buffer_load_dword s54, s[48:51], s52
    s_bfe_u32 s33, s2, 0x20001
    s_bfe_u32 s35, s2, 0x20003
    s_mul_i32 s37, s35, 9
    s_mul_i32 s3, s33, 5
    s_sub_u32 s3, s3, 2
    s_lshl_b32 s53, s33, 2
    s_max_i32 s3, s3, s53
    s_lshl_b32 s53, s3, 1
    s_lshl_b32 s26, s3, 17
    s_add_u32 s32, s32, s26
    s_mul_i32 s3, s3, 36
    s_add_u32 s3, s3, s37
    s_add_u32 s3, s3, 5184
    s_lshl_b32 s26, s3, 10
    s_and_b32 s3, s35, 1
    s_add_u32 s12, s40, 0x7ff800
    s_addc_u32 s13, s41, 0
    s_mov_b32 s14, 0x5b2800
    s_mov_b32 s15, 0x20000
    s_add_u32 s23, s33, 3
    s_and_b32 s23, s23, 3
    s_lshl1_add_u32 s23, s23, s3
    s_add_u32 s23, s23, 3
    s_lshl_b32 s23, s23, 10
    v_add_u32 v111, s23, v110
    s_cmp_eq_u32 s3, 0
    s_cselect_b32 s23, 9216, 0
    s_max_u32 s23, s23, 1024
    v_add_u32 v112, s23, v110
    v_mov_b32 v126, 0
    s_waitcnt vmcnt(11)
    s_barrier
    s_waitcnt lgkmcnt(0)
    s_cmp_eq_u32 s54, s96
    s_cbranch_scc1 m_A_zk3_x
    s_mov_b64 exec, 1
    s_mov_b32 s98, 0x80000
m_A_zk3:
    v_mov_b32 v125, 0
    buffer_atomic_or v125, v126, s[48:51], s52 offen sc0 sc1
    s_sub_u32 s98, s98, 1
    s_cbranch_scc1 m_A_zk3_x
    s_waitcnt vmcnt(0)
    v_cmp_ne_u32 vcc, s96, v125
    s_nop 0
    s_and_b64 exec, exec, vcc
    s_cbranch_scc1 m_A_zk3
m_A_zk3_x:
    s_mov_b64 exec, -1
    s_mov_b32 m0, 84992
    s_nop 0
    buffer_load_dwordx4 v111, s[12:15], s26 offen offset:0 lds
    buffer_load_dwordx4 v112, s[12:15], s26 offen offset:1024 lds
    s_add_u32 s26, s26, 36864
    s_mov_b32 m0, 102400
    s_nop 0
    buffer_load_dwordx4 v111, s[12:15], s26 offen offset:0 lds
    buffer_load_dwordx4 v112, s[12:15], s26 offen offset:1024 lds
    s_add_u32 s26, s26, 36864
    s_waitcnt vmcnt(8)
    s_barrier
    s_mov_b32 m0, 119808
    s_nop 0
    buffer_load_dwordx4 v111, s[12:15], s26 offen offset:0 lds
    buffer_load_dwordx4 v112, s[12:15], s26 offen offset:1024 lds
    s_add_u32 s26, s26, 36864
    s_mov_b32 m0, 137216
    s_nop 0
    buffer_load_dwordx4 v111, s[12:15], s26 offen offset:0 lds
    buffer_load_dwordx4 v112, s[12:15], s26 offen offset:1024 lds
    s_add_u32 s26, s26, 36864
    s_waitcnt vmcnt(8)
    s_barrier
    s_cmp_lt_u32 s33, 2
    s_cbranch_scc1 m_A_zs3
    s_mov_b32 m0, 154624
    s_nop 0
    buffer_load_dwordx4 v111, s[12:15], s26 offen offset:0 lds
    buffer_load_dwordx4 v112, s[12:15], s26 offen offset:1024 lds
    s_add_u32 s26, s26, 36864
m_A_zs3:
m_A_le_47:
    s_branch m_B
m_A_comp:
    s_mov_b32 s19, s24
    s_and_b32 s33, s2, 7
    s_lshr_b32 s34, s2, 3
    s_cmp_ge_u32 s34, 27
    s_cbranch_scc1 m_fft
    s_mov_b64 s[40:41], s[28:29]
    s_mul_i32 s35, s33, 27
    s_add_u32 s35, s35, s34
    s_mul_i32 s36, s35, 43691
    s_lshr_b32 s36, s36, 18
    s_mul_i32 s37, s36, 6
    s_sub_u32 s37, s35, s37
    s_and_b32 s38, s36, 63
    s_lshl_b32 s16, s38, 8
    s_mul_i32 s17, s37, 6144
    s_mov_b32 s18, 64
    v_and_b32 v2, 63, v0
    v_lshlrev_b32 v2, 7, v2
    s_and_b32 s22, s19, 1
    s_lshr_b32 s23, s19, 1
    v_and_b32 v3, 63, v0
    v_lshrrev_b32 v4, 2, v3
    v_and_b32 v5, 7, v4
    s_mul_i32 s24, s22, 4
    v_xor_b32 v5, s24, v5
    v_lshlrev_b32 v5, 5, v5
    v_lshl_add_u32 v4, v4, 8, v5
    v_and_b32 v5, 3, v3
    v_lshl_add_u32 v10, v5, 3, v4
    v_xor_b32 v11, 32, v10
    v_xor_b32 v12, 64, v10
    v_xor_b32 v13, 96, v10
    s_mul_i32 s24, s23, 3072
    s_add_u32 s24, s24, 8192
    v_lshl_add_u32 v6, v3, 4, s24
    v_add_u32 v14, 57344, v10
    v_add_u32 v15, 57344, v11
    v_add_u32 v16, 57344, v12
    v_add_u32 v17, 57344, v13
    v_add_u32 v7, 57344, v6
    v_add_u32 v18, 114688, v10
    v_add_u32 v19, 114688, v11
    v_add_u32 v20, 114688, v12
    v_add_u32 v21, 114688, v13
    v_add_u32 v8, 114688, v6
    s_waitcnt lgkmcnt(0)
    s_add_u32 s12, s40, 0x310000
    s_addc_u32 s13, s41, 0
    s_mov_b32 s14, 0xa8000
    s_mov_b32 s15, 0x20000
    s_and_b32 s53, s2, 63
    s_lshr_b32 s52, s2, 6
    s_lshl2_add_u32 s53, s53, s52
    s_lshl_b32 s52, s19, 8
    s_add_u32 s53, s53, s52
    s_add_u32 s53, s53, 2048
    s_lshl_b32 s53, s53, 7
    v_mov_b32 v5, s96
    s_lshl_b32 s52, s19, 13
    s_add_u32 s52, s52, 393216
    s_add_u32 s48, s40, 0x800000
    s_addc_u32 s49, s41, 0
    s_mov_b32 s50, 0x5b2000
    s_mov_b32 s51, 0x20000
    s_lshl_b32 s38, s36, 2
    s_lshl_b32 s39, s22, 1
    s_add_u32 s38, s38, s39
    s_mul_i32 s38, s38, 36
    s_mul_i32 s39, s37, 6
    s_add_u32 s38, s38, s39
    s_mul_i32 s39, s23, 3
    s_add_u32 s38, s38, s39
    s_lshl_b32 s38, s38, 10
    s_add_u32 s39, s38, 36864
    s_lshl1_add_u32 s42, s36, s22
    s_mul_i32 s42, s42, 12
    s_lshl1_add_u32 s43, s37, s23
    s_add_u32 s42, s42, s43
    s_add_u32 s42, s42, 1024
    s_lshl_b32 s97, s42, 7
    s_waitcnt vmcnt(0)
m_A_nw:
    v_lshlrev_b32 v24, 16, v248
    v_and_b32 v25, 0xffff0000, v248
    v_lshlrev_b32 v26, 16, v249
    v_and_b32 v27, 0xffff0000, v249
    v_lshlrev_b32 v28, 16, v248
    v_and_b32 v29, 0xffff0000, v248
    v_lshlrev_b32 v30, 16, v249
    v_and_b32 v31, 0xffff0000, v249
    v_lshlrev_b32 v32, 16, v248
    v_and_b32 v33, 0xffff0000, v248
    v_lshlrev_b32 v34, 16, v249
    v_and_b32 v35, 0xffff0000, v249
    v_lshlrev_b32 v36, 16, v250
    v_and_b32 v37, 0xffff0000, v250
    v_lshlrev_b32 v38, 16, v251
    v_and_b32 v39, 0xffff0000, v251
    v_lshlrev_b32 v40, 16, v250
    v_and_b32 v41, 0xffff0000, v250
    v_lshlrev_b32 v42, 16, v251
    v_and_b32 v43, 0xffff0000, v251
    v_lshlrev_b32 v44, 16, v250
    v_and_b32 v45, 0xffff0000, v250
    v_lshlrev_b32 v46, 16, v251
    v_and_b32 v47, 0xffff0000, v251
    v_lshlrev_b32 v48, 16, v252
    v_and_b32 v49, 0xffff0000, v252
    v_lshlrev_b32 v50, 16, v253
    v_and_b32 v51, 0xffff0000, v253
    v_lshlrev_b32 v52, 16, v252
    v_and_b32 v53, 0xffff0000, v252
    v_lshlrev_b32 v54, 16, v253
    v_and_b32 v55, 0xffff0000, v253
    v_lshlrev_b32 v56, 16, v252
    v_and_b32 v57, 0xffff0000, v252
    v_lshlrev_b32 v58, 16, v253
    v_and_b32 v59, 0xffff0000, v253
    v_lshlrev_b32 v60, 16, v254
    v_and_b32 v61, 0xffff0000, v254
    v_lshlrev_b32 v62, 16, v255
    v_and_b32 v63, 0xffff0000, v255
    v_lshlrev_b32 v64, 16, v254
    v_and_b32 v65, 0xffff0000, v254
    v_lshlrev_b32 v66, 16, v255
    v_and_b32 v67, 0xffff0000, v255
    v_lshlrev_b32 v68, 16, v254
    v_and_b32 v69, 0xffff0000, v254
    v_lshlrev_b32 v70, 16, v255
    v_and_b32 v71, 0xffff0000, v255
    s_barrier
    ds_read_b128 v[104:107], v6 offset:0
    ds_read_b64_tr_b16 v[72:73], v10 offset:0
    ds_read_b64_tr_b16 v[74:75], v10 offset:4096
    ds_read_b128 v[108:111], v6 offset:1024
    ds_read_b128 v[112:115], v6 offset:2048
    ds_read_b64_tr_b16 v[76:77], v11 offset:0
    ds_read_b64_tr_b16 v[78:79], v11 offset:4096
    ds_read_b64_tr_b16 v[80:81], v12 offset:0
    ds_read_b64_tr_b16 v[82:83], v12 offset:4096
    ds_read_b64_tr_b16 v[84:85], v13 offset:0
    ds_read_b64_tr_b16 v[86:87], v13 offset:4096
    s_mov_b64 exec, 1
    buffer_store_dword v5, off, s[12:15], s53 sc1
    s_mov_b64 exec, -1
    s_mov_b32 s21, s18
    s_waitcnt lgkmcnt(4)
    v_mfma_f32_16x16x32_bf16 v[24:27], v[72:75], v[104:107], v[24:27]
    ds_read_b128 v[116:119], v6 offset:14336
    v_mfma_f32_16x16x32_bf16 v[28:31], v[72:75], v[108:111], v[28:31]
    ds_read_b64_tr_b16 v[88:89], v10 offset:14336
    v_mfma_f32_16x16x32_bf16 v[32:35], v[72:75], v[112:115], v[32:35]
    ds_read_b64_tr_b16 v[90:91], v10 offset:18432
    v_mfma_f32_16x16x32_bf16 v[36:39], v[76:79], v[104:107], v[36:39]
    ds_read_b128 v[120:123], v6 offset:15360
    v_mfma_f32_16x16x32_bf16 v[40:43], v[76:79], v[108:111], v[40:43]
    ds_read_b128 v[124:127], v6 offset:16384
    v_mfma_f32_16x16x32_bf16 v[44:47], v[76:79], v[112:115], v[44:47]
    ds_read_b64_tr_b16 v[92:93], v11 offset:14336
    s_waitcnt lgkmcnt(6)
    v_mfma_f32_16x16x32_bf16 v[48:51], v[80:83], v[104:107], v[48:51]
    ds_read_b64_tr_b16 v[94:95], v11 offset:18432
    v_mfma_f32_16x16x32_bf16 v[52:55], v[80:83], v[108:111], v[52:55]
    ds_read_b64_tr_b16 v[96:97], v12 offset:14336
    v_mfma_f32_16x16x32_bf16 v[56:59], v[80:83], v[112:115], v[56:59]
    ds_read_b64_tr_b16 v[98:99], v12 offset:18432
    v_mfma_f32_16x16x32_bf16 v[60:63], v[84:87], v[104:107], v[60:63]
    ds_read_b64_tr_b16 v[100:101], v13 offset:14336
    v_mfma_f32_16x16x32_bf16 v[64:67], v[84:87], v[108:111], v[64:67]
    ds_read_b64_tr_b16 v[102:103], v13 offset:18432
    v_mfma_f32_16x16x32_bf16 v[68:71], v[84:87], v[112:115], v[68:71]
    buffer_load_dword v1, v2, s[12:15], s52 offen sc1
    s_branch m_A_c1_51
m_A_cl_49:
    s_waitcnt lgkmcnt(4)
    v_mfma_f32_16x16x32_bf16 v[24:27], v[72:75], v[104:107], v[24:27]
    s_barrier
    ds_read_b128 v[116:119], v6 offset:14336
    v_mfma_f32_16x16x32_bf16 v[28:31], v[72:75], v[108:111], v[28:31]
    ds_read_b64_tr_b16 v[88:89], v10 offset:14336
    v_mfma_f32_16x16x32_bf16 v[32:35], v[72:75], v[112:115], v[32:35]
    ds_read_b64_tr_b16 v[90:91], v10 offset:18432
    v_mfma_f32_16x16x32_bf16 v[36:39], v[76:79], v[104:107], v[36:39]
    ds_read_b128 v[120:123], v6 offset:15360
    v_mfma_f32_16x16x32_bf16 v[40:43], v[76:79], v[108:111], v[40:43]
    ds_read_b128 v[124:127], v6 offset:16384
    v_mfma_f32_16x16x32_bf16 v[44:47], v[76:79], v[112:115], v[44:47]
    ds_read_b64_tr_b16 v[92:93], v11 offset:14336
    s_waitcnt lgkmcnt(6)
    v_mfma_f32_16x16x32_bf16 v[48:51], v[80:83], v[104:107], v[48:51]
    ds_read_b64_tr_b16 v[94:95], v11 offset:18432
    v_mfma_f32_16x16x32_bf16 v[52:55], v[80:83], v[108:111], v[52:55]
    ds_read_b64_tr_b16 v[96:97], v12 offset:14336
    v_mfma_f32_16x16x32_bf16 v[56:59], v[80:83], v[112:115], v[56:59]
    ds_read_b64_tr_b16 v[98:99], v12 offset:18432
    v_mfma_f32_16x16x32_bf16 v[60:63], v[84:87], v[104:107], v[60:63]
    ds_read_b64_tr_b16 v[100:101], v13 offset:14336
    v_mfma_f32_16x16x32_bf16 v[64:67], v[84:87], v[108:111], v[64:67]
    ds_read_b64_tr_b16 v[102:103], v13 offset:18432
    v_mfma_f32_16x16x32_bf16 v[68:71], v[84:87], v[112:115], v[68:71]
m_A_c1_51:
    s_waitcnt lgkmcnt(4)
    v_mfma_f32_16x16x32_bf16 v[24:27], v[88:91], v[116:119], v[24:27]
    ds_read_b128 v[104:107], v6 offset:28672
    v_mfma_f32_16x16x32_bf16 v[28:31], v[88:91], v[120:123], v[28:31]
    ds_read_b64_tr_b16 v[72:73], v10 offset:28672
    v_mfma_f32_16x16x32_bf16 v[32:35], v[88:91], v[124:127], v[32:35]
    ds_read_b64_tr_b16 v[74:75], v10 offset:32768
    v_mfma_f32_16x16x32_bf16 v[36:39], v[92:95], v[116:119], v[36:39]
    ds_read_b128 v[108:111], v6 offset:29696
    v_mfma_f32_16x16x32_bf16 v[40:43], v[92:95], v[120:123], v[40:43]
    ds_read_b128 v[112:115], v6 offset:30720
    v_mfma_f32_16x16x32_bf16 v[44:47], v[92:95], v[124:127], v[44:47]
    ds_read_b64_tr_b16 v[76:77], v11 offset:28672
    s_waitcnt lgkmcnt(6)
    v_mfma_f32_16x16x32_bf16 v[48:51], v[96:99], v[116:119], v[48:51]
    ds_read_b64_tr_b16 v[78:79], v11 offset:32768
    v_mfma_f32_16x16x32_bf16 v[52:55], v[96:99], v[120:123], v[52:55]
    ds_read_b64_tr_b16 v[80:81], v12 offset:28672
    v_mfma_f32_16x16x32_bf16 v[56:59], v[96:99], v[124:127], v[56:59]
    ds_read_b64_tr_b16 v[82:83], v12 offset:32768
    v_mfma_f32_16x16x32_bf16 v[60:63], v[100:103], v[116:119], v[60:63]
    ds_read_b64_tr_b16 v[84:85], v13 offset:28672
    v_mfma_f32_16x16x32_bf16 v[64:67], v[100:103], v[120:123], v[64:67]
    ds_read_b64_tr_b16 v[86:87], v13 offset:32768
    v_mfma_f32_16x16x32_bf16 v[68:71], v[100:103], v[124:127], v[68:71]
    s_waitcnt lgkmcnt(4)
    v_mfma_f32_16x16x32_bf16 v[24:27], v[72:75], v[104:107], v[24:27]
    s_barrier
    ds_read_b128 v[116:119], v6 offset:43008
    v_mfma_f32_16x16x32_bf16 v[28:31], v[72:75], v[108:111], v[28:31]
    ds_read_b64_tr_b16 v[88:89], v10 offset:43008
    v_mfma_f32_16x16x32_bf16 v[32:35], v[72:75], v[112:115], v[32:35]
    ds_read_b64_tr_b16 v[90:91], v10 offset:47104
    v_mfma_f32_16x16x32_bf16 v[36:39], v[76:79], v[104:107], v[36:39]
    ds_read_b128 v[120:123], v6 offset:44032
    v_mfma_f32_16x16x32_bf16 v[40:43], v[76:79], v[108:111], v[40:43]
    ds_read_b128 v[124:127], v6 offset:45056
    v_mfma_f32_16x16x32_bf16 v[44:47], v[76:79], v[112:115], v[44:47]
    ds_read_b64_tr_b16 v[92:93], v11 offset:43008
    s_waitcnt lgkmcnt(6)
    v_mfma_f32_16x16x32_bf16 v[48:51], v[80:83], v[104:107], v[48:51]
    ds_read_b64_tr_b16 v[94:95], v11 offset:47104
    v_mfma_f32_16x16x32_bf16 v[52:55], v[80:83], v[108:111], v[52:55]
    ds_read_b64_tr_b16 v[96:97], v12 offset:43008
    v_mfma_f32_16x16x32_bf16 v[56:59], v[80:83], v[112:115], v[56:59]
    ds_read_b64_tr_b16 v[98:99], v12 offset:47104
    v_mfma_f32_16x16x32_bf16 v[60:63], v[84:87], v[104:107], v[60:63]
    ds_read_b64_tr_b16 v[100:101], v13 offset:43008
    v_mfma_f32_16x16x32_bf16 v[64:67], v[84:87], v[108:111], v[64:67]
    ds_read_b64_tr_b16 v[102:103], v13 offset:47104
    v_mfma_f32_16x16x32_bf16 v[68:71], v[84:87], v[112:115], v[68:71]
    s_waitcnt lgkmcnt(4)
    v_mfma_f32_16x16x32_bf16 v[24:27], v[88:91], v[116:119], v[24:27]
    ds_read_b128 v[104:107], v7 offset:0
    v_mfma_f32_16x16x32_bf16 v[28:31], v[88:91], v[120:123], v[28:31]
    ds_read_b64_tr_b16 v[72:73], v14 offset:0
    v_mfma_f32_16x16x32_bf16 v[32:35], v[88:91], v[124:127], v[32:35]
    ds_read_b64_tr_b16 v[74:75], v14 offset:4096
    v_mfma_f32_16x16x32_bf16 v[36:39], v[92:95], v[116:119], v[36:39]
    ds_read_b128 v[108:111], v7 offset:1024
    v_mfma_f32_16x16x32_bf16 v[40:43], v[92:95], v[120:123], v[40:43]
    ds_read_b128 v[112:115], v7 offset:2048
    v_mfma_f32_16x16x32_bf16 v[44:47], v[92:95], v[124:127], v[44:47]
    ds_read_b64_tr_b16 v[76:77], v15 offset:0
    s_waitcnt lgkmcnt(6)
    v_mfma_f32_16x16x32_bf16 v[48:51], v[96:99], v[116:119], v[48:51]
    ds_read_b64_tr_b16 v[78:79], v15 offset:4096
    v_mfma_f32_16x16x32_bf16 v[52:55], v[96:99], v[120:123], v[52:55]
    ds_read_b64_tr_b16 v[80:81], v16 offset:0
    v_mfma_f32_16x16x32_bf16 v[56:59], v[96:99], v[124:127], v[56:59]
    ds_read_b64_tr_b16 v[82:83], v16 offset:4096
    v_mfma_f32_16x16x32_bf16 v[60:63], v[100:103], v[116:119], v[60:63]
    ds_read_b64_tr_b16 v[84:85], v17 offset:0
    v_mfma_f32_16x16x32_bf16 v[64:67], v[100:103], v[120:123], v[64:67]
    ds_read_b64_tr_b16 v[86:87], v17 offset:4096
    s_cmp_eq_u32 s21, 4
    v_mfma_f32_16x16x32_bf16 v[68:71], v[100:103], v[124:127], v[68:71]
    s_cbranch_scc1 m_A_cd_50
    s_cmp_eq_u32 s21, 64
    s_cbranch_scc1 m_A_hk_52
m_A_hk_52_back:
    s_waitcnt lgkmcnt(4)
    v_mfma_f32_16x16x32_bf16 v[24:27], v[72:75], v[104:107], v[24:27]
    s_barrier
    ds_read_b128 v[116:119], v7 offset:14336
    v_mfma_f32_16x16x32_bf16 v[28:31], v[72:75], v[108:111], v[28:31]
    ds_read_b64_tr_b16 v[88:89], v14 offset:14336
    v_mfma_f32_16x16x32_bf16 v[32:35], v[72:75], v[112:115], v[32:35]
    ds_read_b64_tr_b16 v[90:91], v14 offset:18432
    v_mfma_f32_16x16x32_bf16 v[36:39], v[76:79], v[104:107], v[36:39]
    ds_read_b128 v[120:123], v7 offset:15360
    v_mfma_f32_16x16x32_bf16 v[40:43], v[76:79], v[108:111], v[40:43]
    ds_read_b128 v[124:127], v7 offset:16384
    v_mfma_f32_16x16x32_bf16 v[44:47], v[76:79], v[112:115], v[44:47]
    ds_read_b64_tr_b16 v[92:93], v15 offset:14336
    s_waitcnt lgkmcnt(6)
    v_mfma_f32_16x16x32_bf16 v[48:51], v[80:83], v[104:107], v[48:51]
    ds_read_b64_tr_b16 v[94:95], v15 offset:18432
    v_mfma_f32_16x16x32_bf16 v[52:55], v[80:83], v[108:111], v[52:55]
    ds_read_b64_tr_b16 v[96:97], v16 offset:14336
    v_mfma_f32_16x16x32_bf16 v[56:59], v[80:83], v[112:115], v[56:59]
    ds_read_b64_tr_b16 v[98:99], v16 offset:18432
    v_mfma_f32_16x16x32_bf16 v[60:63], v[84:87], v[104:107], v[60:63]
    ds_read_b64_tr_b16 v[100:101], v17 offset:14336
    v_mfma_f32_16x16x32_bf16 v[64:67], v[84:87], v[108:111], v[64:67]
    ds_read_b64_tr_b16 v[102:103], v17 offset:18432
    v_mfma_f32_16x16x32_bf16 v[68:71], v[84:87], v[112:115], v[68:71]
    s_waitcnt lgkmcnt(4)
    v_mfma_f32_16x16x32_bf16 v[24:27], v[88:91], v[116:119], v[24:27]
    ds_read_b128 v[104:107], v7 offset:28672
    v_mfma_f32_16x16x32_bf16 v[28:31], v[88:91], v[120:123], v[28:31]
    ds_read_b64_tr_b16 v[72:73], v14 offset:28672
    v_mfma_f32_16x16x32_bf16 v[32:35], v[88:91], v[124:127], v[32:35]
    ds_read_b64_tr_b16 v[74:75], v14 offset:32768
    v_mfma_f32_16x16x32_bf16 v[36:39], v[92:95], v[116:119], v[36:39]
    ds_read_b128 v[108:111], v7 offset:29696
    v_mfma_f32_16x16x32_bf16 v[40:43], v[92:95], v[120:123], v[40:43]
    ds_read_b128 v[112:115], v7 offset:30720
    v_mfma_f32_16x16x32_bf16 v[44:47], v[92:95], v[124:127], v[44:47]
    ds_read_b64_tr_b16 v[76:77], v15 offset:28672
    s_waitcnt lgkmcnt(6)
    v_mfma_f32_16x16x32_bf16 v[48:51], v[96:99], v[116:119], v[48:51]
    ds_read_b64_tr_b16 v[78:79], v15 offset:32768
    v_mfma_f32_16x16x32_bf16 v[52:55], v[96:99], v[120:123], v[52:55]
    ds_read_b64_tr_b16 v[80:81], v16 offset:28672
    v_mfma_f32_16x16x32_bf16 v[56:59], v[96:99], v[124:127], v[56:59]
    ds_read_b64_tr_b16 v[82:83], v16 offset:32768
    v_mfma_f32_16x16x32_bf16 v[60:63], v[100:103], v[116:119], v[60:63]
    ds_read_b64_tr_b16 v[84:85], v17 offset:28672
    v_mfma_f32_16x16x32_bf16 v[64:67], v[100:103], v[120:123], v[64:67]
    ds_read_b64_tr_b16 v[86:87], v17 offset:32768
    v_mfma_f32_16x16x32_bf16 v[68:71], v[100:103], v[124:127], v[68:71]
    s_waitcnt lgkmcnt(4)
    v_mfma_f32_16x16x32_bf16 v[24:27], v[72:75], v[104:107], v[24:27]
    s_barrier
    ds_read_b128 v[116:119], v7 offset:43008
    v_mfma_f32_16x16x32_bf16 v[28:31], v[72:75], v[108:111], v[28:31]
    ds_read_b64_tr_b16 v[88:89], v14 offset:43008
    v_mfma_f32_16x16x32_bf16 v[32:35], v[72:75], v[112:115], v[32:35]
    ds_read_b64_tr_b16 v[90:91], v14 offset:47104
    v_mfma_f32_16x16x32_bf16 v[36:39], v[76:79], v[104:107], v[36:39]
    ds_read_b128 v[120:123], v7 offset:44032
    v_mfma_f32_16x16x32_bf16 v[40:43], v[76:79], v[108:111], v[40:43]
    ds_read_b128 v[124:127], v7 offset:45056
    v_mfma_f32_16x16x32_bf16 v[44:47], v[76:79], v[112:115], v[44:47]
    ds_read_b64_tr_b16 v[92:93], v15 offset:43008
    s_waitcnt lgkmcnt(6)
    v_mfma_f32_16x16x32_bf16 v[48:51], v[80:83], v[104:107], v[48:51]
    ds_read_b64_tr_b16 v[94:95], v15 offset:47104
    v_mfma_f32_16x16x32_bf16 v[52:55], v[80:83], v[108:111], v[52:55]
    ds_read_b64_tr_b16 v[96:97], v16 offset:43008
    v_mfma_f32_16x16x32_bf16 v[56:59], v[80:83], v[112:115], v[56:59]
    ds_read_b64_tr_b16 v[98:99], v16 offset:47104
    v_mfma_f32_16x16x32_bf16 v[60:63], v[84:87], v[104:107], v[60:63]
    ds_read_b64_tr_b16 v[100:101], v17 offset:43008
    v_mfma_f32_16x16x32_bf16 v[64:67], v[84:87], v[108:111], v[64:67]
    ds_read_b64_tr_b16 v[102:103], v17 offset:47104
    v_mfma_f32_16x16x32_bf16 v[68:71], v[84:87], v[112:115], v[68:71]
    s_waitcnt lgkmcnt(4)
    v_mfma_f32_16x16x32_bf16 v[24:27], v[88:91], v[116:119], v[24:27]
    ds_read_b128 v[104:107], v8 offset:0
    v_mfma_f32_16x16x32_bf16 v[28:31], v[88:91], v[120:123], v[28:31]
    ds_read_b64_tr_b16 v[72:73], v18 offset:0
    v_mfma_f32_16x16x32_bf16 v[32:35], v[88:91], v[124:127], v[32:35]
    ds_read_b64_tr_b16 v[74:75], v18 offset:4096
    v_mfma_f32_16x16x32_bf16 v[36:39], v[92:95], v[116:119], v[36:39]
    ds_read_b128 v[108:111], v8 offset:1024
    v_mfma_f32_16x16x32_bf16 v[40:43], v[92:95], v[120:123], v[40:43]
    ds_read_b128 v[112:115], v8 offset:2048
    v_mfma_f32_16x16x32_bf16 v[44:47], v[92:95], v[124:127], v[44:47]
    ds_read_b64_tr_b16 v[76:77], v19 offset:0
    s_waitcnt lgkmcnt(6)
    v_mfma_f32_16x16x32_bf16 v[48:51], v[96:99], v[116:119], v[48:51]
    ds_read_b64_tr_b16 v[78:79], v19 offset:4096
    v_mfma_f32_16x16x32_bf16 v[52:55], v[96:99], v[120:123], v[52:55]
    ds_read_b64_tr_b16 v[80:81], v20 offset:0
    v_mfma_f32_16x16x32_bf16 v[56:59], v[96:99], v[124:127], v[56:59]
    ds_read_b64_tr_b16 v[82:83], v20 offset:4096
    v_mfma_f32_16x16x32_bf16 v[60:63], v[100:103], v[116:119], v[60:63]
    ds_read_b64_tr_b16 v[84:85], v21 offset:0
    v_mfma_f32_16x16x32_bf16 v[64:67], v[100:103], v[120:123], v[64:67]
    ds_read_b64_tr_b16 v[86:87], v21 offset:4096
    v_mfma_f32_16x16x32_bf16 v[68:71], v[100:103], v[124:127], v[68:71]
    s_waitcnt lgkmcnt(4)
    v_mfma_f32_16x16x32_bf16 v[24:27], v[72:75], v[104:107], v[24:27]
    s_barrier
    ds_read_b128 v[116:119], v8 offset:14336
    v_mfma_f32_16x16x32_bf16 v[28:31], v[72:75], v[108:111], v[28:31]
    ds_read_b64_tr_b16 v[88:89], v18 offset:14336
    v_mfma_f32_16x16x32_bf16 v[32:35], v[72:75], v[112:115], v[32:35]
    ds_read_b64_tr_b16 v[90:91], v18 offset:18432
    v_mfma_f32_16x16x32_bf16 v[36:39], v[76:79], v[104:107], v[36:39]
    ds_read_b128 v[120:123], v8 offset:15360
    v_mfma_f32_16x16x32_bf16 v[40:43], v[76:79], v[108:111], v[40:43]
    ds_read_b128 v[124:127], v8 offset:16384
    v_mfma_f32_16x16x32_bf16 v[44:47], v[76:79], v[112:115], v[44:47]
    ds_read_b64_tr_b16 v[92:93], v19 offset:14336
    s_waitcnt lgkmcnt(6)
    v_mfma_f32_16x16x32_bf16 v[48:51], v[80:83], v[104:107], v[48:51]
    ds_read_b64_tr_b16 v[94:95], v19 offset:18432
    v_mfma_f32_16x16x32_bf16 v[52:55], v[80:83], v[108:111], v[52:55]
    ds_read_b64_tr_b16 v[96:97], v20 offset:14336
    v_mfma_f32_16x16x32_bf16 v[56:59], v[80:83], v[112:115], v[56:59]
    ds_read_b64_tr_b16 v[98:99], v20 offset:18432
    v_mfma_f32_16x16x32_bf16 v[60:63], v[84:87], v[104:107], v[60:63]
    ds_read_b64_tr_b16 v[100:101], v21 offset:14336
    v_mfma_f32_16x16x32_bf16 v[64:67], v[84:87], v[108:111], v[64:67]
    ds_read_b64_tr_b16 v[102:103], v21 offset:18432
    v_mfma_f32_16x16x32_bf16 v[68:71], v[84:87], v[112:115], v[68:71]
    s_waitcnt lgkmcnt(4)
    v_mfma_f32_16x16x32_bf16 v[24:27], v[88:91], v[116:119], v[24:27]
    ds_read_b128 v[104:107], v6 offset:0
    v_mfma_f32_16x16x32_bf16 v[28:31], v[88:91], v[120:123], v[28:31]
    ds_read_b64_tr_b16 v[72:73], v10 offset:0
    v_mfma_f32_16x16x32_bf16 v[32:35], v[88:91], v[124:127], v[32:35]
    ds_read_b64_tr_b16 v[74:75], v10 offset:4096
    v_mfma_f32_16x16x32_bf16 v[36:39], v[92:95], v[116:119], v[36:39]
    ds_read_b128 v[108:111], v6 offset:1024
    v_mfma_f32_16x16x32_bf16 v[40:43], v[92:95], v[120:123], v[40:43]
    ds_read_b128 v[112:115], v6 offset:2048
    v_mfma_f32_16x16x32_bf16 v[44:47], v[92:95], v[124:127], v[44:47]
    ds_read_b64_tr_b16 v[76:77], v11 offset:0
    s_waitcnt lgkmcnt(6)
    v_mfma_f32_16x16x32_bf16 v[48:51], v[96:99], v[116:119], v[48:51]
    ds_read_b64_tr_b16 v[78:79], v11 offset:4096
    v_mfma_f32_16x16x32_bf16 v[52:55], v[96:99], v[120:123], v[52:55]
    ds_read_b64_tr_b16 v[80:81], v12 offset:0
    v_mfma_f32_16x16x32_bf16 v[56:59], v[96:99], v[124:127], v[56:59]
    ds_read_b64_tr_b16 v[82:83], v12 offset:4096
    v_mfma_f32_16x16x32_bf16 v[60:63], v[100:103], v[116:119], v[60:63]
    ds_read_b64_tr_b16 v[84:85], v13 offset:0
    s_sub_u32 s21, s21, 10
    v_mfma_f32_16x16x32_bf16 v[64:67], v[100:103], v[120:123], v[64:67]
    ds_read_b64_tr_b16 v[86:87], v13 offset:4096
    s_cmp_lg_u32 s21, 0
    v_mfma_f32_16x16x32_bf16 v[68:71], v[100:103], v[124:127], v[68:71]
    s_cbranch_scc1 m_A_cl_49
    s_branch m_A_cd_50
m_A_hk_52:
    s_waitcnt vmcnt(0)
    v_cmp_ne_u32 vcc, s96, v1
    s_nop 0
    s_and_b64 exec, exec, vcc
    s_cbranch_scc0 m_A_ck_x
    s_mov_b32 s98, 0x80000
m_A_ck:
    v_mov_b32 v1, 0
    buffer_atomic_or v1, v2, s[12:15], s52 offen sc0 sc1
    s_sub_u32 s98, s98, 1
    s_cbranch_scc1 m_A_ck_x
    s_waitcnt vmcnt(0)
    v_cmp_ne_u32 vcc, s96, v1
    s_nop 0
    s_and_b64 exec, exec, vcc
    s_cbranch_scc1 m_A_ck
m_A_ck_x:
    s_mov_b64 exec, -1
    s_branch m_A_hk_52_back
m_A_cd_50:
    s_nop 6
    s_waitcnt lgkmcnt(0)
    s_barrier
    s_mov_b32 s42, 0xbdd2d3e8
    s_mov_b32 s43, 0xbdd2d3e8
    v_mov_b32 v124, 0xc0135761
    v_mov_b32 v125, 0xc0135761
    v_lshlrev_b32 v4, 4, v3
    v_pk_mul_f32 v[72:73], v[24:25], v[24:25]
    v_pk_mul_f32 v[74:75], v[26:27], v[26:27]
    v_pk_mul_f32 v[76:77], v[36:37], v[36:37]
    v_pk_mul_f32 v[78:79], v[38:39], v[38:39]
    v_pk_fma_f32 v[72:73], v[72:73], s[42:43], v[124:125]
    v_pk_fma_f32 v[74:75], v[74:75], s[42:43], v[124:125]
    v_pk_fma_f32 v[76:77], v[76:77], s[42:43], v[124:125]
    v_pk_fma_f32 v[78:79], v[78:79], s[42:43], v[124:125]
    v_pk_mul_f32 v[72:73], v[72:73], v[24:25]
    v_pk_mul_f32 v[74:75], v[74:75], v[26:27]
    v_pk_mul_f32 v[76:77], v[76:77], v[36:37]
    v_pk_mul_f32 v[78:79], v[78:79], v[38:39]
    v_exp_f32 v72, v72
    v_exp_f32 v73, v73
    v_exp_f32 v74, v74
    v_exp_f32 v75, v75
    v_exp_f32 v76, v76
    v_exp_f32 v77, v77
    v_exp_f32 v78, v78
    v_exp_f32 v79, v79
    v_pk_add_f32 v[72:73], v[72:73], 1.0 op_sel_hi:[1,0]
    v_pk_add_f32 v[74:75], v[74:75], 1.0 op_sel_hi:[1,0]
    v_pk_add_f32 v[76:77], v[76:77], 1.0 op_sel_hi:[1,0]
    v_pk_add_f32 v[78:79], v[78:79], 1.0 op_sel_hi:[1,0]
    v_rcp_f32 v72, v72
    v_rcp_f32 v73, v73
    v_rcp_f32 v74, v74
    v_rcp_f32 v75, v75
    v_rcp_f32 v76, v76
    v_rcp_f32 v77, v77
    v_rcp_f32 v78, v78
    v_rcp_f32 v79, v79
    v_pk_mul_f32 v[72:73], v[72:73], v[24:25]
    v_pk_mul_f32 v[74:75], v[74:75], v[26:27]
    v_pk_mul_f32 v[76:77], v[76:77], v[36:37]
    v_pk_mul_f32 v[78:79], v[78:79], v[38:39]
    v_cvt_pk_bf16_f32 v104, v72, v73
    v_cvt_pk_bf16_f32 v105, v74, v75
    v_cvt_pk_bf16_f32 v106, v76, v77
    v_cvt_pk_bf16_f32 v107, v78, v79
    buffer_store_dwordx4 v[104:107], v4, s[48:51], s38 offen offset:0 sc1
    v_pk_mul_f32 v[80:81], v[28:29], v[28:29]
    v_pk_mul_f32 v[82:83], v[30:31], v[30:31]
    v_pk_mul_f32 v[84:85], v[40:41], v[40:41]
    v_pk_mul_f32 v[86:87], v[42:43], v[42:43]
    v_pk_fma_f32 v[80:81], v[80:81], s[42:43], v[124:125]
    v_pk_fma_f32 v[82:83], v[82:83], s[42:43], v[124:125]
    v_pk_fma_f32 v[84:85], v[84:85], s[42:43], v[124:125]
    v_pk_fma_f32 v[86:87], v[86:87], s[42:43], v[124:125]
    v_pk_mul_f32 v[80:81], v[80:81], v[28:29]
    v_pk_mul_f32 v[82:83], v[82:83], v[30:31]
    v_pk_mul_f32 v[84:85], v[84:85], v[40:41]
    v_pk_mul_f32 v[86:87], v[86:87], v[42:43]
    v_exp_f32 v80, v80
    v_exp_f32 v81, v81
    v_exp_f32 v82, v82
    v_exp_f32 v83, v83
    v_exp_f32 v84, v84
    v_exp_f32 v85, v85
    v_exp_f32 v86, v86
    v_exp_f32 v87, v87
    v_pk_add_f32 v[80:81], v[80:81], 1.0 op_sel_hi:[1,0]
    v_pk_add_f32 v[82:83], v[82:83], 1.0 op_sel_hi:[1,0]
    v_pk_add_f32 v[84:85], v[84:85], 1.0 op_sel_hi:[1,0]
    v_pk_add_f32 v[86:87], v[86:87], 1.0 op_sel_hi:[1,0]
    v_rcp_f32 v80, v80
    v_rcp_f32 v81, v81
    v_rcp_f32 v82, v82
    v_rcp_f32 v83, v83
    v_rcp_f32 v84, v84
    v_rcp_f32 v85, v85
    v_rcp_f32 v86, v86
    v_rcp_f32 v87, v87
    v_pk_mul_f32 v[80:81], v[80:81], v[28:29]
    v_pk_mul_f32 v[82:83], v[82:83], v[30:31]
    v_pk_mul_f32 v[84:85], v[84:85], v[40:41]
    v_pk_mul_f32 v[86:87], v[86:87], v[42:43]
    v_cvt_pk_bf16_f32 v108, v80, v81
    v_cvt_pk_bf16_f32 v109, v82, v83
    v_cvt_pk_bf16_f32 v110, v84, v85
    v_cvt_pk_bf16_f32 v111, v86, v87
    buffer_store_dwordx4 v[108:111], v4, s[48:51], s38 offen offset:1024 sc1
    v_pk_mul_f32 v[88:89], v[32:33], v[32:33]
    v_pk_mul_f32 v[90:91], v[34:35], v[34:35]
    v_pk_mul_f32 v[92:93], v[44:45], v[44:45]
    v_pk_mul_f32 v[94:95], v[46:47], v[46:47]
    v_pk_fma_f32 v[88:89], v[88:89], s[42:43], v[124:125]
    v_pk_fma_f32 v[90:91], v[90:91], s[42:43], v[124:125]
    v_pk_fma_f32 v[92:93], v[92:93], s[42:43], v[124:125]
    v_pk_fma_f32 v[94:95], v[94:95], s[42:43], v[124:125]
    v_pk_mul_f32 v[88:89], v[88:89], v[32:33]
    v_pk_mul_f32 v[90:91], v[90:91], v[34:35]
    v_pk_mul_f32 v[92:93], v[92:93], v[44:45]
    v_pk_mul_f32 v[94:95], v[94:95], v[46:47]
    v_exp_f32 v88, v88
    v_exp_f32 v89, v89
    v_exp_f32 v90, v90
    v_exp_f32 v91, v91
    v_exp_f32 v92, v92
    v_exp_f32 v93, v93
    v_exp_f32 v94, v94
    v_exp_f32 v95, v95
    v_pk_add_f32 v[88:89], v[88:89], 1.0 op_sel_hi:[1,0]
    v_pk_add_f32 v[90:91], v[90:91], 1.0 op_sel_hi:[1,0]
    v_pk_add_f32 v[92:93], v[92:93], 1.0 op_sel_hi:[1,0]
    v_pk_add_f32 v[94:95], v[94:95], 1.0 op_sel_hi:[1,0]
    v_rcp_f32 v88, v88
    v_rcp_f32 v89, v89
    v_rcp_f32 v90, v90
    v_rcp_f32 v91, v91
    v_rcp_f32 v92, v92
    v_rcp_f32 v93, v93
    v_rcp_f32 v94, v94
    v_rcp_f32 v95, v95
    v_pk_mul_f32 v[88:89], v[88:89], v[32:33]
    v_pk_mul_f32 v[90:91], v[90:91], v[34:35]
    v_pk_mul_f32 v[92:93], v[92:93], v[44:45]
    v_pk_mul_f32 v[94:95], v[94:95], v[46:47]
    v_cvt_pk_bf16_f32 v112, v88, v89
    v_cvt_pk_bf16_f32 v113, v90, v91
    v_cvt_pk_bf16_f32 v114, v92, v93
    v_cvt_pk_bf16_f32 v115, v94, v95
    buffer_store_dwordx4 v[112:115], v4, s[48:51], s38 offen offset:2048 sc1
    v_pk_mul_f32 v[96:97], v[48:49], v[48:49]
    v_pk_mul_f32 v[98:99], v[50:51], v[50:51]
    v_pk_mul_f32 v[100:101], v[60:61], v[60:61]
    v_pk_mul_f32 v[102:103], v[62:63], v[62:63]
    v_pk_fma_f32 v[96:97], v[96:97], s[42:43], v[124:125]
    v_pk_fma_f32 v[98:99], v[98:99], s[42:43], v[124:125]
    v_pk_fma_f32 v[100:101], v[100:101], s[42:43], v[124:125]
    v_pk_fma_f32 v[102:103], v[102:103], s[42:43], v[124:125]
    v_pk_mul_f32 v[96:97], v[96:97], v[48:49]
    v_pk_mul_f32 v[98:99], v[98:99], v[50:51]
    v_pk_mul_f32 v[100:101], v[100:101], v[60:61]
    v_pk_mul_f32 v[102:103], v[102:103], v[62:63]
    v_exp_f32 v96, v96
    v_exp_f32 v97, v97
    v_exp_f32 v98, v98
    v_exp_f32 v99, v99
    v_exp_f32 v100, v100
    v_exp_f32 v101, v101
    v_exp_f32 v102, v102
    v_exp_f32 v103, v103
    v_pk_add_f32 v[96:97], v[96:97], 1.0 op_sel_hi:[1,0]
    v_pk_add_f32 v[98:99], v[98:99], 1.0 op_sel_hi:[1,0]
    v_pk_add_f32 v[100:101], v[100:101], 1.0 op_sel_hi:[1,0]
    v_pk_add_f32 v[102:103], v[102:103], 1.0 op_sel_hi:[1,0]
    v_rcp_f32 v96, v96
    v_rcp_f32 v97, v97
    v_rcp_f32 v98, v98
    v_rcp_f32 v99, v99
    v_rcp_f32 v100, v100
    v_rcp_f32 v101, v101
    v_rcp_f32 v102, v102
    v_rcp_f32 v103, v103
    v_pk_mul_f32 v[96:97], v[96:97], v[48:49]
    v_pk_mul_f32 v[98:99], v[98:99], v[50:51]
    v_pk_mul_f32 v[100:101], v[100:101], v[60:61]
    v_pk_mul_f32 v[102:103], v[102:103], v[62:63]
    v_cvt_pk_bf16_f32 v116, v96, v97
    v_cvt_pk_bf16_f32 v117, v98, v99
    v_cvt_pk_bf16_f32 v118, v100, v101
    v_cvt_pk_bf16_f32 v119, v102, v103
    buffer_store_dwordx4 v[116:119], v4, s[48:51], s39 offen offset:0 sc1
    v_pk_mul_f32 v[72:73], v[52:53], v[52:53]
    v_pk_mul_f32 v[74:75], v[54:55], v[54:55]
    v_pk_mul_f32 v[76:77], v[64:65], v[64:65]
    v_pk_mul_f32 v[78:79], v[66:67], v[66:67]
    v_pk_fma_f32 v[72:73], v[72:73], s[42:43], v[124:125]
    v_pk_fma_f32 v[74:75], v[74:75], s[42:43], v[124:125]
    v_pk_fma_f32 v[76:77], v[76:77], s[42:43], v[124:125]
    v_pk_fma_f32 v[78:79], v[78:79], s[42:43], v[124:125]
    v_pk_mul_f32 v[72:73], v[72:73], v[52:53]
    v_pk_mul_f32 v[74:75], v[74:75], v[54:55]
    v_pk_mul_f32 v[76:77], v[76:77], v[64:65]
    v_pk_mul_f32 v[78:79], v[78:79], v[66:67]
    v_exp_f32 v72, v72
    v_exp_f32 v73, v73
    v_exp_f32 v74, v74
    v_exp_f32 v75, v75
    v_exp_f32 v76, v76
    v_exp_f32 v77, v77
    v_exp_f32 v78, v78
    v_exp_f32 v79, v79
    v_pk_add_f32 v[72:73], v[72:73], 1.0 op_sel_hi:[1,0]
    v_pk_add_f32 v[74:75], v[74:75], 1.0 op_sel_hi:[1,0]
    v_pk_add_f32 v[76:77], v[76:77], 1.0 op_sel_hi:[1,0]
    v_pk_add_f32 v[78:79], v[78:79], 1.0 op_sel_hi:[1,0]
    v_rcp_f32 v72, v72
    v_rcp_f32 v73, v73
    v_rcp_f32 v74, v74
    v_rcp_f32 v75, v75
    v_rcp_f32 v76, v76
    v_rcp_f32 v77, v77
    v_rcp_f32 v78, v78
    v_rcp_f32 v79, v79
    v_pk_mul_f32 v[72:73], v[72:73], v[52:53]
    v_pk_mul_f32 v[74:75], v[74:75], v[54:55]
    v_pk_mul_f32 v[76:77], v[76:77], v[64:65]
    v_pk_mul_f32 v[78:79], v[78:79], v[66:67]
    v_cvt_pk_bf16_f32 v120, v72, v73
    v_cvt_pk_bf16_f32 v121, v74, v75
    v_cvt_pk_bf16_f32 v122, v76, v77
    v_cvt_pk_bf16_f32 v123, v78, v79
    buffer_store_dwordx4 v[120:123], v4, s[48:51], s39 offen offset:1024 sc1
    v_pk_mul_f32 v[80:81], v[56:57], v[56:57]
    v_pk_mul_f32 v[82:83], v[58:59], v[58:59]
    v_pk_mul_f32 v[84:85], v[68:69], v[68:69]
    v_pk_mul_f32 v[86:87], v[70:71], v[70:71]
    v_pk_fma_f32 v[80:81], v[80:81], s[42:43], v[124:125]
    v_pk_fma_f32 v[82:83], v[82:83], s[42:43], v[124:125]
    v_pk_fma_f32 v[84:85], v[84:85], s[42:43], v[124:125]
    v_pk_fma_f32 v[86:87], v[86:87], s[42:43], v[124:125]
    v_pk_mul_f32 v[80:81], v[80:81], v[56:57]
    v_pk_mul_f32 v[82:83], v[82:83], v[58:59]
    v_pk_mul_f32 v[84:85], v[84:85], v[68:69]
    v_pk_mul_f32 v[86:87], v[86:87], v[70:71]
    v_exp_f32 v80, v80
    v_exp_f32 v81, v81
    v_exp_f32 v82, v82
    v_exp_f32 v83, v83
    v_exp_f32 v84, v84
    v_exp_f32 v85, v85
    v_exp_f32 v86, v86
    v_exp_f32 v87, v87
    v_pk_add_f32 v[80:81], v[80:81], 1.0 op_sel_hi:[1,0]
    v_pk_add_f32 v[82:83], v[82:83], 1.0 op_sel_hi:[1,0]
    v_pk_add_f32 v[84:85], v[84:85], 1.0 op_sel_hi:[1,0]
    v_pk_add_f32 v[86:87], v[86:87], 1.0 op_sel_hi:[1,0]
    v_rcp_f32 v80, v80
    v_rcp_f32 v81, v81
    v_rcp_f32 v82, v82
    v_rcp_f32 v83, v83
    v_rcp_f32 v84, v84
    v_rcp_f32 v85, v85
    v_rcp_f32 v86, v86
    v_rcp_f32 v87, v87
    v_pk_mul_f32 v[80:81], v[80:81], v[56:57]
    v_pk_mul_f32 v[82:83], v[82:83], v[58:59]
    v_pk_mul_f32 v[84:85], v[84:85], v[68:69]
    v_pk_mul_f32 v[86:87], v[86:87], v[70:71]
    v_cvt_pk_bf16_f32 v104, v80, v81
    v_cvt_pk_bf16_f32 v105, v82, v83
    v_cvt_pk_bf16_f32 v106, v84, v85
    v_cvt_pk_bf16_f32 v107, v86, v87
    buffer_store_dwordx4 v[104:107], v4, s[48:51], s39 offen offset:2048 sc1
    s_branch m_B
m_fft:
    s_mul_i32 s35, s33, 5
    s_add_u32 s35, s35, s34
    s_sub_u32 s35, s35, 27
    s_load_dwordx2 s[8:9], s[0:1], 32
    s_load_dwordx2 s[12:13], s[0:1], 48
    s_load_dwordx2 s[52:53], s[0:1], 88
    v_and_b32 v72, 63, v0
    v_lshrrev_b32 v73, 4, v72
    v_and_b32 v74, 15, v72
    s_and_b32 s36, s19, 3
    s_lshl_b32 s36, s36, 2
    v_xor_b32 v75, s36, v72
    v_lshlrev_b32 v77, 4, v75
    v_xor_b32 v78, 16, v77
    v_xor_b32 v79, 32, v77
    v_xor_b32 v80, 48, v77
    s_lshr_b32 s37, s19, 2
    s_and_b32 s38, s19, 2
    s_lshl_b32 s38, s38, 4
    s_and_b32 s39, s19, 1
    s_lshl_b32 s39, s39, 2
    s_add_u32 s38, s38, s39
    s_lshl_b32 s37, s37, 4
    v_lshl_add_u32 v82, v73, 3, s38
    v_add_u32 v76, s37, v74
    s_cmp_eq_u32 s35, 36
    s_cselect_b32 s54, 3, s19
    s_lshl_b32 s55, s35, 16
    s_lshl_b32 s56, s19, 13
    s_add_u32 s55, s55, s56
    v_lshlrev_b32 v1, 4, v72
    s_sub_u32 s58, s34, 27
    s_lshl_b32 s59, s58, 9
    v_add_u32 v96, s59, v0
    v_mul_u32_u24 v97, 6554, v96
    v_lshrrev_b32 v97, 16, v97
    v_mul_u32_u24 v98, 10, v97
    v_sub_u32 v96, v96, v98
    v_and_b32 v98, 31, v97
    v_lshrrev_b32 v97, 5, v97
    v_lshl_add_u32 v97, v98, 6, v97
    v_mul_u32_u24 v97, 9216, v97
    v_lshl_add_u32 v96, v96, 7, v97
    s_mul_i32 s59, s33, 9
    s_lshr_b32 s59, s59, 1
    s_lshl_b32 s59, s59, 8
    s_add_u32 s59, s59, 119808
    s_lshr_b32 s39, s33, 1
    s_mov_b32 s57, 14
    s_cmp_eq_u32 s39, 1
    s_cselect_b32 s57, 50, s57
    s_cmp_eq_u32 s39, 2
    s_cselect_b32 s57, 86, s57
    s_cmp_eq_u32 s39, 3
    s_cselect_b32 s57, 122, s57
    s_add_u32 s58, s58, s57
    s_lshl_b32 s58, s58, 17
    s_lshl_b32 s57, s19, 14
    s_add_u32 s58, s58, s57
    s_and_b32 s57, s33, 1
    s_lshl_b32 s57, s57, 11
    s_add_u32 s58, s58, s57
    s_waitcnt lgkmcnt(0)
    s_add_u32 s44, s52, 0x310000
    s_addc_u32 s45, s53, 0
    s_mov_b32 s46, 0xa8000
    s_mov_b32 s47, 0x20000
    v_and_b32 v4, 63, v0
    v_lshlrev_b32 v5, 13, v4
    v_add_u32 v5, 122880, v5
    v_lshlrev_b32 v4, 15, v4
    v_min_u32 v4, v4, v5
    v_mov_b32 v5, s96
    s_and_b32 s60, s2, 63
    s_cmp_lt_u32 s60, 12
    s_cselect_b32 s61, 33, 1
    s_lshr_b32 s98, s2, 6
    s_lshl2_add_u32 s60, s60, s98
    s_add_u32 s60, s60, 2048
    s_lshl_b32 s60, s60, 7
    s_cmp_lg_u32 s19, 0
    s_waitcnt vmcnt(0)
    s_barrier
    s_cbranch_scc1 m_F_nf
    s_mov_b64 exec, 15
    buffer_store_dword v5, v4, s[44:47], s60 offen sc1
    s_mov_b64 exec, -1
m_F_nf:
    s_and_b32 s60, s35, 3
    s_lshl3_add_u32 s60, s60, s19
    s_lshl_b32 s60, s60, 12
    s_add_u32 s60, s60, 262144
    v_lshlrev_b32 v6, 7, v72
    v_lshlrev_b32 v0, 4, v73
    v_lshl_add_u32 v0, v74, 7, v0
    s_waitcnt lgkmcnt(0)
    s_mov_b32 s10, 0x1200000
    s_mov_b32 s11, 0x20000
    buffer_load_dword v3, v96, s[8:11], s59 offen
    s_add_u32 s59, s59, 73728
    s_mov_b32 s14, 0x1200000
    s_mov_b32 s15, 0x20000
    s_cmp_lt_u32 s35, 37
    s_cbranch_scc1 m_F_fgo
    s_mov_b32 exec_hi, 0
    s_mov_b32 s98, 0x80000
m_F_ppi:
    v_mov_b32 v7, 0
    buffer_atomic_or v7, v6, s[44:47], s60 offen sc0 sc1
    s_sub_u32 s98, s98, 1
    s_cbranch_scc1 m_F_ppi_x
    s_waitcnt vmcnt(0)
    v_cmp_ne_u32 vcc, s96, v7
    s_nop 0
    s_and_b64 exec, exec, vcc
    s_cbranch_scc1 m_F_ppi
m_F_ppi_x:
    s_mov_b64 exec, -1
    s_barrier
    s_branch m_F_fleave
m_F_fsur:
    s_waitcnt vmcnt(0)
    s_barrier
    s_waitcnt vmcnt(0)
    s_branch m_F_fleave
m_F_fgo:
    s_add_u32 s40, s52, 0x400000
    s_addc_u32 s41, s53, 0
    s_mov_b32 s42, 0x260000
    s_mov_b32 s43, 0x20000
    v_mov_b32 v4, v1
    s_add_u32 s48, s52, 0xe00000
    s_addc_u32 s49, s53, 0
    s_mov_b32 s50, 0x240000
    s_mov_b32 s51, 0x20000
    v_bfe_u32 v75, v72, 1, 3
    v_xor_b32 v75, s54, v75
    v_lshlrev_b32 v75, 4, v75
    v_lshl_add_u32 v75, v72, 7, v75
    v_add_u32 v2, 65536, v75
    s_lshl_b32 s56, s19, 10
    v_add_u32 v1, 131072, v1
    v_add_u32 v84, s56, v1
    v_add_u32 v85, s56, v84
    v_cvt_f32_u32 v76, v76
    v_mul_f32 v76, 0x3a000000, v76
    v_cvt_f32_u32 v75, v82
    v_mul_f32 v8, v75, v76
    v_add_f32 v9, v8, v76
    v_add_f32 v10, v9, v76
    v_add_f32 v11, v10, v76
    v_lshrrev_b32 v75, 2, v74
    v_lshlrev_b32 v75, 2, v75
    v_add_u32 v81, v75, v74
    v_add_u32 v75, s38, v81
    v_cvt_f32_u32 v75, v75
    v_mul_f32 v75, 0x3a000000, v75
    v_lshl_add_u32 v76, v73, 2, s37
    v_cvt_f32_u32 v76, v76
    v_mul_f32 v12, v75, v76
    v_add_f32 v13, v12, v75
    v_add_f32 v14, v13, v75
    v_add_f32 v15, v14, v75
    v_cos_f32 v16, v8
    v_sin_f32 v24, v8
    v_cos_f32 v17, v9
    v_sin_f32 v25, v9
    v_cos_f32 v18, v10
    v_sin_f32 v26, v10
    v_cos_f32 v19, v11
    v_sin_f32 v27, v11
    v_cos_f32 v20, v12
    v_sin_f32 v28, v12
    v_cos_f32 v21, v13
    v_sin_f32 v29, v13
    v_cos_f32 v22, v14
    v_sin_f32 v30, v14
    v_cos_f32 v23, v15
    v_sin_f32 v31, v15
    v_cvt_pk_f16_f32 v32, v16, v24
    v_cvt_pk_f16_f32 v33, v17, v25
    v_cvt_pk_f16_f32 v34, v18, v26
    v_cvt_pk_f16_f32 v35, v19, v27
    v_cvt_pk_f16_f32 v36, v20, v28
    v_cvt_pk_f16_f32 v37, v21, v29
    v_cvt_pk_f16_f32 v38, v22, v30
    v_cvt_pk_f16_f32 v39, v23, v31
    ds_write_b128 v84, v[32:35] offset:16384
    ds_write_b128 v84, v[36:39] offset:24576
    s_and_b32 s56, s19, 4
    s_lshl_b32 s56, s56, 3
    s_and_b32 s57, s19, 2
    s_lshl_b32 s57, s57, 1
    s_add_u32 s56, s56, s57
    s_and_b32 s57, s19, 1
    s_lshl_b32 s57, s57, 5
    v_add_u32 v75, s56, v81
    v_cvt_f32_u32 v75, v75
    v_mul_f32 v75, 0x3c800000, v75
    v_lshl_add_u32 v76, v73, 3, s57
    v_cvt_f32_u32 v76, v76
    v_mul_f32 v8, v75, v76
    v_add_f32 v9, v8, v75
    v_add_f32 v10, v9, v75
    v_add_f32 v11, v10, v75
    v_add_f32 v12, v11, v75
    v_add_f32 v13, v12, v75
    v_add_f32 v14, v13, v75
    v_add_f32 v15, v14, v75
    v_cos_f32 v16, v8
    v_sin_f32 v24, v8
    v_cos_f32 v17, v9
    v_sin_f32 v25, v9
    v_cos_f32 v18, v10
    v_sin_f32 v26, v10
    v_cos_f32 v19, v11
    v_sin_f32 v27, v11
    v_cos_f32 v20, v12
    v_sin_f32 v28, v12
    v_cos_f32 v21, v13
    v_sin_f32 v29, v13
    v_cos_f32 v22, v14
    v_sin_f32 v30, v14
    v_cos_f32 v23, v15
    v_sin_f32 v31, v15
    v_cvt_pk_bf16_f32 v152, v16, v17
    v_cvt_pk_bf16_f32 v156, v24, v25
    v_cvt_pk_bf16_f32 v153, v18, v19
    v_cvt_pk_bf16_f32 v157, v26, v27
    v_cvt_pk_bf16_f32 v154, v20, v21
    v_cvt_pk_bf16_f32 v158, v28, v29
    v_cvt_pk_bf16_f32 v155, v22, v23
    v_cvt_pk_bf16_f32 v159, v30, v31
    ds_write_b128 v85, v[152:155]
    ds_write_b128 v85, v[156:159] offset:1024
    v_cvt_f32_u32 v75, v74
    v_mul_f32 v75, 0x3d000000, v75
    v_lshlrev_b32 v76, 2, v73
    v_cvt_f32_u32 v76, v76
    v_mul_f32 v8, v75, v76
    v_add_f32 v9, v8, v75
    v_add_f32 v10, v9, v75
    v_add_f32 v11, v10, v75
    v_mul_f32 v75, 0x41800000, v75
    v_add_f32 v12, v8, v75
    v_add_f32 v13, v9, v75
    v_add_f32 v14, v10, v75
    v_add_f32 v15, v11, v75
    v_cos_f32 v16, v8
    v_sin_f32 v24, v8
    v_cos_f32 v17, v9
    v_sin_f32 v25, v9
    v_cos_f32 v18, v10
    v_sin_f32 v26, v10
    v_cos_f32 v19, v11
    v_sin_f32 v27, v11
    v_cos_f32 v20, v12
    v_sin_f32 v28, v12
    v_cos_f32 v21, v13
    v_sin_f32 v29, v13
    v_cos_f32 v22, v14
    v_sin_f32 v30, v14
    v_cos_f32 v23, v15
    v_sin_f32 v31, v15
    v_cvt_pk_bf16_f32 v232, v16, v17
    v_cvt_pk_bf16_f32 v236, v16, -v17
    v_cvt_pk_bf16_f32 v240, v24, v25
    v_cvt_pk_bf16_f32 v244, v24, -v25
    v_cvt_pk_bf16_f32 v248, -v24, -v25
    v_cvt_pk_bf16_f32 v252, -v24, v25
    v_cvt_pk_bf16_f32 v233, v18, v19
    v_cvt_pk_bf16_f32 v237, v18, -v19
    v_cvt_pk_bf16_f32 v241, v26, v27
    v_cvt_pk_bf16_f32 v245, v26, -v27
    v_cvt_pk_bf16_f32 v249, -v26, -v27
    v_cvt_pk_bf16_f32 v253, -v26, v27
    v_cvt_pk_bf16_f32 v234, v20, v21
    v_cvt_pk_bf16_f32 v238, v20, -v21
    v_cvt_pk_bf16_f32 v242, v28, v29
    v_cvt_pk_bf16_f32 v246, v28, -v29
    v_cvt_pk_bf16_f32 v250, -v28, -v29
    v_cvt_pk_bf16_f32 v254, -v28, v29
    v_cvt_pk_bf16_f32 v235, v22, v23
    v_cvt_pk_bf16_f32 v239, v22, -v23
    v_cvt_pk_bf16_f32 v243, v30, v31
    v_cvt_pk_bf16_f32 v247, v30, -v31
    v_cvt_pk_bf16_f32 v251, -v30, -v31
    v_cvt_pk_bf16_f32 v255, -v30, v31
    v_xor_b32 v75, s19, v74
    v_lshlrev_b32 v75, 4, v75
    v_lshl_add_u32 v75, v73, 8, v75
    v_lshl_add_u32 v75, v81, 10, v75
    v_xor_b32 v76, 128, v75
    s_lshl_b32 s56, s19, 13
    s_mov_b32 exec_hi, 0
    s_mov_b32 s98, 0x80000
m_F_pp:
    v_mov_b32 v7, 0
    buffer_atomic_or v7, v6, s[44:47], s60 offen sc0 sc1
    s_sub_u32 s98, s98, 1
    s_cbranch_scc1 m_F_pp_x
    s_waitcnt vmcnt(0)
    v_cmp_ne_u32 vcc, s96, v7
    s_nop 0
    s_and_b64 exec, exec, vcc
    s_cbranch_scc1 m_F_pp
m_F_pp_x:
    s_mov_b64 exec, -1
    s_barrier
    s_add_u32 s44, s52, 0x1b00000
    s_addc_u32 s45, s53, 0
    s_mov_b32 s46, 0x250000
    s_mov_b32 s47, 0x20000
    s_mov_b32 s57, s55
    s_add_u32 m0, s56, 0
    s_nop 0
    buffer_load_dwordx4 v77, s[40:43], s55 offen  lds
    s_add_u32 s55, s55, 1024
    s_add_u32 m0, s56, 1024
    s_nop 0
    buffer_load_dwordx4 v78, s[40:43], s55 offen  lds
    s_add_u32 s55, s55, 1024
    s_add_u32 m0, s56, 2048
    s_nop 0
    buffer_load_dwordx4 v79, s[40:43], s55 offen  lds
    s_add_u32 s55, s55, 1024
    s_add_u32 m0, s56, 3072
    s_nop 0
    buffer_load_dwordx4 v80, s[40:43], s55 offen  lds
    s_add_u32 s55, s55, 1024
    s_add_u32 m0, s56, 4096
    s_nop 0
    buffer_load_dwordx4 v77, s[40:43], s55 offen  lds
    s_add_u32 s55, s55, 1024
    s_add_u32 m0, s56, 5120
    s_nop 0
    buffer_load_dwordx4 v78, s[40:43], s55 offen  lds
    s_add_u32 s55, s55, 1024
    s_add_u32 m0, s56, 6144
    s_nop 0
    buffer_load_dwordx4 v79, s[40:43], s55 offen  lds
    s_add_u32 s55, s55, 1024
    s_add_u32 m0, s56, 7168
    s_nop 0
    buffer_load_dwordx4 v80, s[40:43], s55 offen  lds
    s_add_u32 s55, s55, 1024
    s_add_u32 m0, s56, 65536
    s_nop 0
    buffer_load_dwordx4 v4, s[44:47], s57 offen offset:0  lds
    buffer_load_dwordx4 v4, s[44:47], s57 offen offset:1024  lds
    buffer_load_dwordx4 v4, s[44:47], s57 offen offset:2048  lds
    buffer_load_dwordx4 v4, s[44:47], s57 offen offset:3072  lds
    s_add_u32 m0, s56, 69632
    s_add_u32 s57, s57, 4096
    buffer_load_dwordx4 v4, s[44:47], s57 offen offset:0  lds
    buffer_load_dwordx4 v4, s[44:47], s57 offen offset:1024  lds
    buffer_load_dwordx4 v4, s[44:47], s57 offen offset:2048  lds
    buffer_load_dwordx4 v4, s[44:47], s57 offen offset:3072  lds
    s_waitcnt vmcnt(8) lgkmcnt(0)
    s_barrier
    s_lshl_b32 s36, s35, 3
    s_add_u32 s36, s36, s19
    s_cmp_gt_u32 s36, 288
    s_cbranch_scc1 m_F_fsur
    ds_read_b128 v[120:123], v75 offset:0
    ds_read_b128 v[136:139], v76 offset:0
    ds_read_b128 v[124:127], v75 offset:4096
    ds_read_b128 v[140:143], v76 offset:4096
    ds_read_b128 v[128:131], v75 offset:32768
    ds_read_b128 v[144:147], v76 offset:32768
    ds_read_b128 v[132:135], v75 offset:36864
    ds_read_b128 v[148:151], v76 offset:36864
    ds_read_b128 v[152:155], v1 offset:16384
    ds_read_b128 v[156:159], v1 offset:17408
    ds_read_b128 v[160:163], v1 offset:18432
    ds_read_b128 v[164:167], v1 offset:19456
    s_waitcnt lgkmcnt(4)
    v_mfma_f32_16x16x32_bf16 v[8:11], v[120:123], v[232:235], 0
    ds_read_b128 v[168:171], v1 offset:0
    v_mfma_f32_16x16x32_bf16 v[24:27], v[136:139], v[232:235], 0
    ds_read_b128 v[200:203], v1 offset:1024
    v_mfma_f32_16x16x32_bf16 v[12:15], v[124:127], v[232:235], 0
    ds_read_b128 v[172:175], v1 offset:2048
    v_mfma_f32_16x16x32_bf16 v[28:31], v[140:143], v[232:235], 0
    ds_read_b128 v[204:207], v1 offset:3072
    v_mfma_f32_16x16x32_bf16 v[16:19], v[128:131], v[232:235], 0
    ds_read_b128 v[176:179], v1 offset:4096
    v_mfma_f32_16x16x32_bf16 v[32:35], v[144:147], v[232:235], 0
    ds_read_b128 v[208:211], v1 offset:5120
    v_mfma_f32_16x16x32_bf16 v[20:23], v[132:135], v[232:235], 0
    ds_read_b128 v[180:183], v1 offset:6144
    v_mfma_f32_16x16x32_bf16 v[36:39], v[148:151], v[232:235], 0
    ds_read_b128 v[212:215], v1 offset:7168
    s_waitcnt lgkmcnt(4)
    v_mfma_f32_16x16x32_bf16 v[8:11], v[136:139], v[240:243], v[8:11]
    ds_read_b128 v[184:187], v1 offset:8192
    v_mfma_f32_16x16x32_bf16 v[24:27], v[120:123], v[248:251], v[24:27]
    ds_read_b128 v[216:219], v1 offset:9216
    v_mfma_f32_16x16x32_bf16 v[12:15], v[140:143], v[240:243], v[12:15]
    ds_read_b128 v[188:191], v1 offset:10240
    v_mfma_f32_16x16x32_bf16 v[28:31], v[124:127], v[248:251], v[28:31]
    ds_read_b128 v[220:223], v1 offset:11264
    v_mfma_f32_16x16x32_bf16 v[16:19], v[144:147], v[240:243], v[16:19]
    ds_read_b128 v[192:195], v1 offset:12288
    v_mfma_f32_16x16x32_bf16 v[32:35], v[128:131], v[248:251], v[32:35]
    ds_read_b128 v[224:227], v1 offset:13312
    v_mfma_f32_16x16x32_bf16 v[20:23], v[148:151], v[240:243], v[20:23]
    ds_read_b128 v[196:199], v1 offset:14336
    v_mfma_f32_16x16x32_bf16 v[36:39], v[132:135], v[248:251], v[36:39]
    ds_read_b128 v[228:231], v1 offset:15360
    s_waitcnt lgkmcnt(0)
    v_mfma_f32_16x16x32_bf16 v[40:43], v[120:123], v[236:239], 0
    s_waitcnt lgkmcnt(15)
    v_fma_mix_f32 v4, v8, v152, 0 op_sel:[0,0,0] op_sel_hi:[0,1,0]
    v_fma_mix_f32 v5, v9, v153, 0 op_sel:[0,0,0] op_sel_hi:[0,1,0]
    v_fma_mix_f32 v4, v24, v152, v4 op_sel:[0,1,0] op_sel_hi:[0,1,0]
    v_fma_mix_f32 v5, v25, v153, v5 op_sel:[0,1,0] op_sel_hi:[0,1,0]
    v_fma_mix_f32 v24, v24, v152, 0 op_sel:[0,0,0] op_sel_hi:[0,1,0]
    v_mfma_f32_16x16x32_bf16 v[56:59], v[136:139], v[236:239], 0
    v_fma_mix_f32 v25, v25, v153, 0 op_sel:[0,0,0] op_sel_hi:[0,1,0]
    v_fma_mix_f32 v24, -v8, v152, v24 op_sel:[0,1,0] op_sel_hi:[0,1,0]
    v_fma_mix_f32 v25, -v9, v153, v25 op_sel:[0,1,0] op_sel_hi:[0,1,0]
    v_cvt_pk_bf16_f32 v72, v4, v5
    v_cvt_pk_bf16_f32 v88, -v4, -v5
    v_cvt_pk_bf16_f32 v80, v24, v25
    v_mfma_f32_16x16x32_bf16 v[44:47], v[124:127], v[236:239], 0
    v_fma_mix_f32 v6, v10, v154, 0 op_sel:[0,0,0] op_sel_hi:[0,1,0]
    v_fma_mix_f32 v7, v11, v155, 0 op_sel:[0,0,0] op_sel_hi:[0,1,0]
    v_fma_mix_f32 v6, v26, v154, v6 op_sel:[0,1,0] op_sel_hi:[0,1,0]
    v_fma_mix_f32 v7, v27, v155, v7 op_sel:[0,1,0] op_sel_hi:[0,1,0]
    v_fma_mix_f32 v26, v26, v154, 0 op_sel:[0,0,0] op_sel_hi:[0,1,0]
    v_fma_mix_f32 v27, v27, v155, 0 op_sel:[0,0,0] op_sel_hi:[0,1,0]
    v_mfma_f32_16x16x32_bf16 v[60:63], v[140:143], v[236:239], 0
    v_fma_mix_f32 v26, -v10, v154, v26 op_sel:[0,1,0] op_sel_hi:[0,1,0]
    v_fma_mix_f32 v27, -v11, v155, v27 op_sel:[0,1,0] op_sel_hi:[0,1,0]
    ds_read_b128 v[152:155], v1 offset:20480
    v_cvt_pk_bf16_f32 v73, v6, v7
    v_cvt_pk_bf16_f32 v89, -v6, -v7
    v_cvt_pk_bf16_f32 v81, v26, v27
    v_mfma_f32_16x16x32_bf16 v[48:51], v[128:131], v[236:239], 0
    s_waitcnt lgkmcnt(15)
    v_fma_mix_f32 v4, v12, v156, 0 op_sel:[0,0,0] op_sel_hi:[0,1,0]
    v_fma_mix_f32 v5, v13, v157, 0 op_sel:[0,0,0] op_sel_hi:[0,1,0]
    v_fma_mix_f32 v4, v28, v156, v4 op_sel:[0,1,0] op_sel_hi:[0,1,0]
    v_fma_mix_f32 v5, v29, v157, v5 op_sel:[0,1,0] op_sel_hi:[0,1,0]
    v_fma_mix_f32 v28, v28, v156, 0 op_sel:[0,0,0] op_sel_hi:[0,1,0]
    v_mfma_f32_16x16x32_bf16 v[64:67], v[144:147], v[236:239], 0
    v_fma_mix_f32 v29, v29, v157, 0 op_sel:[0,0,0] op_sel_hi:[0,1,0]
    v_fma_mix_f32 v28, -v12, v156, v28 op_sel:[0,1,0] op_sel_hi:[0,1,0]
    v_fma_mix_f32 v29, -v13, v157, v29 op_sel:[0,1,0] op_sel_hi:[0,1,0]
    v_cvt_pk_bf16_f32 v74, v4, v5
    v_cvt_pk_bf16_f32 v90, -v4, -v5
    v_cvt_pk_bf16_f32 v82, v28, v29
    v_mfma_f32_16x16x32_bf16 v[52:55], v[132:135], v[236:239], 0
    v_fma_mix_f32 v6, v14, v158, 0 op_sel:[0,0,0] op_sel_hi:[0,1,0]
    v_fma_mix_f32 v7, v15, v159, 0 op_sel:[0,0,0] op_sel_hi:[0,1,0]
    v_fma_mix_f32 v6, v30, v158, v6 op_sel:[0,1,0] op_sel_hi:[0,1,0]
    v_fma_mix_f32 v7, v31, v159, v7 op_sel:[0,1,0] op_sel_hi:[0,1,0]
    v_fma_mix_f32 v30, v30, v158, 0 op_sel:[0,0,0] op_sel_hi:[0,1,0]
    v_fma_mix_f32 v31, v31, v159, 0 op_sel:[0,0,0] op_sel_hi:[0,1,0]
    v_mfma_f32_16x16x32_bf16 v[68:71], v[148:151], v[236:239], 0
    v_fma_mix_f32 v30, -v14, v158, v30 op_sel:[0,1,0] op_sel_hi:[0,1,0]
    v_fma_mix_f32 v31, -v15, v159, v31 op_sel:[0,1,0] op_sel_hi:[0,1,0]
    ds_read_b128 v[156:159], v1 offset:21504
    v_cvt_pk_bf16_f32 v75, v6, v7
    v_cvt_pk_bf16_f32 v91, -v6, -v7
    v_cvt_pk_bf16_f32 v83, v30, v31
    v_mfma_f32_16x16x32_bf16 v[40:43], v[136:139], v[244:247], v[40:43]
    s_waitcnt lgkmcnt(15)
    v_fma_mix_f32 v4, v16, v160, 0 op_sel:[0,0,0] op_sel_hi:[0,1,0]
    v_fma_mix_f32 v5, v17, v161, 0 op_sel:[0,0,0] op_sel_hi:[0,1,0]
    v_fma_mix_f32 v4, v32, v160, v4 op_sel:[0,1,0] op_sel_hi:[0,1,0]
    v_fma_mix_f32 v5, v33, v161, v5 op_sel:[0,1,0] op_sel_hi:[0,1,0]
    v_fma_mix_f32 v32, v32, v160, 0 op_sel:[0,0,0] op_sel_hi:[0,1,0]
    v_mfma_f32_16x16x32_bf16 v[56:59], v[120:123], v[252:255], v[56:59]
    v_fma_mix_f32 v33, v33, v161, 0 op_sel:[0,0,0] op_sel_hi:[0,1,0]
    v_fma_mix_f32 v32, -v16, v160, v32 op_sel:[0,1,0] op_sel_hi:[0,1,0]
    v_fma_mix_f32 v33, -v17, v161, v33 op_sel:[0,1,0] op_sel_hi:[0,1,0]
    v_cvt_pk_bf16_f32 v76, v4, v5
    v_cvt_pk_bf16_f32 v92, -v4, -v5
    v_cvt_pk_bf16_f32 v84, v32, v33
    v_mfma_f32_16x16x32_bf16 v[44:47], v[140:143], v[244:247], v[44:47]
    v_fma_mix_f32 v6, v18, v162, 0 op_sel:[0,0,0] op_sel_hi:[0,1,0]
    v_fma_mix_f32 v7, v19, v163, 0 op_sel:[0,0,0] op_sel_hi:[0,1,0]
    v_fma_mix_f32 v6, v34, v162, v6 op_sel:[0,1,0] op_sel_hi:[0,1,0]
    v_fma_mix_f32 v7, v35, v163, v7 op_sel:[0,1,0] op_sel_hi:[0,1,0]
    v_fma_mix_f32 v34, v34, v162, 0 op_sel:[0,0,0] op_sel_hi:[0,1,0]
    v_fma_mix_f32 v35, v35, v163, 0 op_sel:[0,0,0] op_sel_hi:[0,1,0]
    v_mfma_f32_16x16x32_bf16 v[60:63], v[124:127], v[252:255], v[60:63]
    v_fma_mix_f32 v34, -v18, v162, v34 op_sel:[0,1,0] op_sel_hi:[0,1,0]
    v_fma_mix_f32 v35, -v19, v163, v35 op_sel:[0,1,0] op_sel_hi:[0,1,0]
    ds_read_b128 v[160:163], v1 offset:22528
    v_cvt_pk_bf16_f32 v77, v6, v7
    v_cvt_pk_bf16_f32 v93, -v6, -v7
    v_cvt_pk_bf16_f32 v85, v34, v35
    v_mfma_f32_16x16x32_bf16 v[48:51], v[144:147], v[244:247], v[48:51]
    s_waitcnt lgkmcnt(15)
    v_fma_mix_f32 v4, v20, v164, 0 op_sel:[0,0,0] op_sel_hi:[0,1,0]
    v_fma_mix_f32 v5, v21, v165, 0 op_sel:[0,0,0] op_sel_hi:[0,1,0]
    v_fma_mix_f32 v4, v36, v164, v4 op_sel:[0,1,0] op_sel_hi:[0,1,0]
    v_fma_mix_f32 v5, v37, v165, v5 op_sel:[0,1,0] op_sel_hi:[0,1,0]
    v_fma_mix_f32 v36, v36, v164, 0 op_sel:[0,0,0] op_sel_hi:[0,1,0]
    v_mfma_f32_16x16x32_bf16 v[64:67], v[128:131], v[252:255], v[64:67]
    v_fma_mix_f32 v37, v37, v165, 0 op_sel:[0,0,0] op_sel_hi:[0,1,0]
    v_fma_mix_f32 v36, -v20, v164, v36 op_sel:[0,1,0] op_sel_hi:[0,1,0]
    v_fma_mix_f32 v37, -v21, v165, v37 op_sel:[0,1,0] op_sel_hi:[0,1,0]
    v_cvt_pk_bf16_f32 v78, v4, v5
    v_cvt_pk_bf16_f32 v94, -v4, -v5
    v_cvt_pk_bf16_f32 v86, v36, v37
    v_mfma_f32_16x16x32_bf16 v[52:55], v[148:151], v[244:247], v[52:55]
    v_fma_mix_f32 v6, v22, v166, 0 op_sel:[0,0,0] op_sel_hi:[0,1,0]
    v_fma_mix_f32 v7, v23, v167, 0 op_sel:[0,0,0] op_sel_hi:[0,1,0]
    v_fma_mix_f32 v6, v38, v166, v6 op_sel:[0,1,0] op_sel_hi:[0,1,0]
    v_fma_mix_f32 v7, v39, v167, v7 op_sel:[0,1,0] op_sel_hi:[0,1,0]
    v_fma_mix_f32 v38, v38, v166, 0 op_sel:[0,0,0] op_sel_hi:[0,1,0]
    v_fma_mix_f32 v39, v39, v167, 0 op_sel:[0,0,0] op_sel_hi:[0,1,0]
    v_mfma_f32_16x16x32_bf16 v[68:71], v[132:135], v[252:255], v[68:71]
    v_fma_mix_f32 v38, -v22, v166, v38 op_sel:[0,1,0] op_sel_hi:[0,1,0]
    v_fma_mix_f32 v39, -v23, v167, v39 op_sel:[0,1,0] op_sel_hi:[0,1,0]
    ds_read_b128 v[164:167], v1 offset:23552
    v_cvt_pk_bf16_f32 v79, v6, v7
    v_cvt_pk_bf16_f32 v95, -v6, -v7
    v_cvt_pk_bf16_f32 v87, v38, v39
    s_waitcnt vmcnt(0)
    s_barrier
    v_mfma_f32_16x16x32_bf16 v[8:11], v[168:171], v[72:75], 0
    s_waitcnt lgkmcnt(3)
    v_fma_mix_f32 v4, v40, v152, 0 op_sel:[0,0,0] op_sel_hi:[0,1,0]
    v_fma_mix_f32 v5, v41, v153, 0 op_sel:[0,0,0] op_sel_hi:[0,1,0]
    v_mfma_f32_16x16x32_bf16 v[24:27], v[168:171], v[80:83], 0
    v_fma_mix_f32 v4, v56, v152, v4 op_sel:[0,1,0] op_sel_hi:[0,1,0]
    v_fma_mix_f32 v5, v57, v153, v5 op_sel:[0,1,0] op_sel_hi:[0,1,0]
    v_fma_mix_f32 v56, v56, v152, 0 op_sel:[0,0,0] op_sel_hi:[0,1,0]
    v_mfma_f32_16x16x32_bf16 v[12:15], v[176:179], v[72:75], 0
    v_fma_mix_f32 v57, v57, v153, 0 op_sel:[0,0,0] op_sel_hi:[0,1,0]
    v_fma_mix_f32 v56, -v40, v152, v56 op_sel:[0,1,0] op_sel_hi:[0,1,0]
    v_fma_mix_f32 v57, -v41, v153, v57 op_sel:[0,1,0] op_sel_hi:[0,1,0]
    v_mfma_f32_16x16x32_bf16 v[28:31], v[176:179], v[80:83], 0
    v_cvt_pk_bf16_f32 v96, v4, v5
    v_cvt_pk_bf16_f32 v112, -v4, -v5
    v_cvt_pk_bf16_f32 v104, v56, v57
    v_mfma_f32_16x16x32_bf16 v[16:19], v[184:187], v[72:75], 0
    v_fma_mix_f32 v6, v42, v154, 0 op_sel:[0,0,0] op_sel_hi:[0,1,0]
    v_fma_mix_f32 v7, v43, v155, 0 op_sel:[0,0,0] op_sel_hi:[0,1,0]
    v_fma_mix_f32 v6, v58, v154, v6 op_sel:[0,1,0] op_sel_hi:[0,1,0]
    v_mfma_f32_16x16x32_bf16 v[32:35], v[184:187], v[80:83], 0
    v_fma_mix_f32 v7, v59, v155, v7 op_sel:[0,1,0] op_sel_hi:[0,1,0]
    v_fma_mix_f32 v58, v58, v154, 0 op_sel:[0,0,0] op_sel_hi:[0,1,0]
    v_fma_mix_f32 v59, v59, v155, 0 op_sel:[0,0,0] op_sel_hi:[0,1,0]
    v_mfma_f32_16x16x32_bf16 v[20:23], v[192:195], v[72:75], 0
    v_fma_mix_f32 v58, -v42, v154, v58 op_sel:[0,1,0] op_sel_hi:[0,1,0]
    v_fma_mix_f32 v59, -v43, v155, v59 op_sel:[0,1,0] op_sel_hi:[0,1,0]
    ds_read_b128 v[152:155], v2 offset:0
    v_mfma_f32_16x16x32_bf16 v[36:39], v[192:195], v[80:83], 0
    v_cvt_pk_bf16_f32 v97, v6, v7
    v_cvt_pk_bf16_f32 v113, -v6, -v7
    v_cvt_pk_bf16_f32 v105, v58, v59
    v_mfma_f32_16x16x32_bf16 v[8:11], v[200:203], v[80:83], v[8:11]
    s_waitcnt lgkmcnt(3)
    v_fma_mix_f32 v4, v44, v156, 0 op_sel:[0,0,0] op_sel_hi:[0,1,0]
    v_fma_mix_f32 v5, v45, v157, 0 op_sel:[0,0,0] op_sel_hi:[0,1,0]
    v_mfma_f32_16x16x32_bf16 v[24:27], v[200:203], v[88:91], v[24:27]
    v_fma_mix_f32 v4, v60, v156, v4 op_sel:[0,1,0] op_sel_hi:[0,1,0]
    v_fma_mix_f32 v5, v61, v157, v5 op_sel:[0,1,0] op_sel_hi:[0,1,0]
    v_fma_mix_f32 v60, v60, v156, 0 op_sel:[0,0,0] op_sel_hi:[0,1,0]
    v_mfma_f32_16x16x32_bf16 v[12:15], v[208:211], v[80:83], v[12:15]
    v_fma_mix_f32 v61, v61, v157, 0 op_sel:[0,0,0] op_sel_hi:[0,1,0]
    v_fma_mix_f32 v60, -v44, v156, v60 op_sel:[0,1,0] op_sel_hi:[0,1,0]
    v_fma_mix_f32 v61, -v45, v157, v61 op_sel:[0,1,0] op_sel_hi:[0,1,0]
    v_mfma_f32_16x16x32_bf16 v[28:31], v[208:211], v[88:91], v[28:31]
    v_cvt_pk_bf16_f32 v98, v4, v5
    v_cvt_pk_bf16_f32 v114, -v4, -v5
    v_cvt_pk_bf16_f32 v106, v60, v61
    v_mfma_f32_16x16x32_bf16 v[16:19], v[216:219], v[80:83], v[16:19]
    v_fma_mix_f32 v6, v46, v158, 0 op_sel:[0,0,0] op_sel_hi:[0,1,0]
    v_fma_mix_f32 v7, v47, v159, 0 op_sel:[0,0,0] op_sel_hi:[0,1,0]
    v_fma_mix_f32 v6, v62, v158, v6 op_sel:[0,1,0] op_sel_hi:[0,1,0]
    v_mfma_f32_16x16x32_bf16 v[32:35], v[216:219], v[88:91], v[32:35]
    v_fma_mix_f32 v7, v63, v159, v7 op_sel:[0,1,0] op_sel_hi:[0,1,0]
    v_fma_mix_f32 v62, v62, v158, 0 op_sel:[0,0,0] op_sel_hi:[0,1,0]
    v_fma_mix_f32 v63, v63, v159, 0 op_sel:[0,0,0] op_sel_hi:[0,1,0]
    v_mfma_f32_16x16x32_bf16 v[20:23], v[224:227], v[80:83], v[20:23]
    v_fma_mix_f32 v62, -v46, v158, v62 op_sel:[0,1,0] op_sel_hi:[0,1,0]
    v_fma_mix_f32 v63, -v47, v159, v63 op_sel:[0,1,0] op_sel_hi:[0,1,0]
    ds_read_b128 v[156:159], v2 offset:8192
    v_mfma_f32_16x16x32_bf16 v[36:39], v[224:227], v[88:91], v[36:39]
    v_cvt_pk_bf16_f32 v99, v6, v7
    v_cvt_pk_bf16_f32 v115, -v6, -v7
    v_cvt_pk_bf16_f32 v107, v62, v63
    v_mfma_f32_16x16x32_bf16 v[8:11], v[172:175], v[76:79], v[8:11]
    s_waitcnt lgkmcnt(3)
    v_fma_mix_f32 v4, v48, v160, 0 op_sel:[0,0,0] op_sel_hi:[0,1,0]
    v_fma_mix_f32 v5, v49, v161, 0 op_sel:[0,0,0] op_sel_hi:[0,1,0]
    v_mfma_f32_16x16x32_bf16 v[24:27], v[172:175], v[84:87], v[24:27]
    v_fma_mix_f32 v4, v64, v160, v4 op_sel:[0,1,0] op_sel_hi:[0,1,0]
    v_fma_mix_f32 v5, v65, v161, v5 op_sel:[0,1,0] op_sel_hi:[0,1,0]
    v_fma_mix_f32 v64, v64, v160, 0 op_sel:[0,0,0] op_sel_hi:[0,1,0]
    v_mfma_f32_16x16x32_bf16 v[12:15], v[180:183], v[76:79], v[12:15]
    v_fma_mix_f32 v65, v65, v161, 0 op_sel:[0,0,0] op_sel_hi:[0,1,0]
    v_fma_mix_f32 v64, -v48, v160, v64 op_sel:[0,1,0] op_sel_hi:[0,1,0]
    v_fma_mix_f32 v65, -v49, v161, v65 op_sel:[0,1,0] op_sel_hi:[0,1,0]
    v_mfma_f32_16x16x32_bf16 v[28:31], v[180:183], v[84:87], v[28:31]
    v_cvt_pk_bf16_f32 v100, v4, v5
    v_cvt_pk_bf16_f32 v116, -v4, -v5
    v_cvt_pk_bf16_f32 v108, v64, v65
    v_mfma_f32_16x16x32_bf16 v[16:19], v[188:191], v[76:79], v[16:19]
    v_fma_mix_f32 v6, v50, v162, 0 op_sel:[0,0,0] op_sel_hi:[0,1,0]
    v_fma_mix_f32 v7, v51, v163, 0 op_sel:[0,0,0] op_sel_hi:[0,1,0]
    v_fma_mix_f32 v6, v66, v162, v6 op_sel:[0,1,0] op_sel_hi:[0,1,0]
    v_mfma_f32_16x16x32_bf16 v[32:35], v[188:191], v[84:87], v[32:35]
    v_fma_mix_f32 v7, v67, v163, v7 op_sel:[0,1,0] op_sel_hi:[0,1,0]
    v_fma_mix_f32 v66, v66, v162, 0 op_sel:[0,0,0] op_sel_hi:[0,1,0]
    v_fma_mix_f32 v67, v67, v163, 0 op_sel:[0,0,0] op_sel_hi:[0,1,0]
    v_mfma_f32_16x16x32_bf16 v[20:23], v[196:199], v[76:79], v[20:23]
    v_fma_mix_f32 v66, -v50, v162, v66 op_sel:[0,1,0] op_sel_hi:[0,1,0]
    v_fma_mix_f32 v67, -v51, v163, v67 op_sel:[0,1,0] op_sel_hi:[0,1,0]
    ds_read_b128 v[160:163], v2 offset:16384
    v_mfma_f32_16x16x32_bf16 v[36:39], v[196:199], v[84:87], v[36:39]
    v_cvt_pk_bf16_f32 v101, v6, v7
    v_cvt_pk_bf16_f32 v117, -v6, -v7
    v_cvt_pk_bf16_f32 v109, v66, v67
    v_mfma_f32_16x16x32_bf16 v[8:11], v[204:207], v[84:87], v[8:11]
    s_waitcnt lgkmcnt(3)
    v_fma_mix_f32 v4, v52, v164, 0 op_sel:[0,0,0] op_sel_hi:[0,1,0]
    v_fma_mix_f32 v5, v53, v165, 0 op_sel:[0,0,0] op_sel_hi:[0,1,0]
    v_mfma_f32_16x16x32_bf16 v[24:27], v[204:207], v[92:95], v[24:27]
    v_fma_mix_f32 v4, v68, v164, v4 op_sel:[0,1,0] op_sel_hi:[0,1,0]
    v_fma_mix_f32 v5, v69, v165, v5 op_sel:[0,1,0] op_sel_hi:[0,1,0]
    v_fma_mix_f32 v68, v68, v164, 0 op_sel:[0,0,0] op_sel_hi:[0,1,0]
    v_mfma_f32_16x16x32_bf16 v[12:15], v[212:215], v[84:87], v[12:15]
    v_fma_mix_f32 v69, v69, v165, 0 op_sel:[0,0,0] op_sel_hi:[0,1,0]
    v_fma_mix_f32 v68, -v52, v164, v68 op_sel:[0,1,0] op_sel_hi:[0,1,0]
    v_fma_mix_f32 v69, -v53, v165, v69 op_sel:[0,1,0] op_sel_hi:[0,1,0]
    v_mfma_f32_16x16x32_bf16 v[28:31], v[212:215], v[92:95], v[28:31]
    v_cvt_pk_bf16_f32 v102, v4, v5
    v_cvt_pk_bf16_f32 v118, -v4, -v5
    v_cvt_pk_bf16_f32 v110, v68, v69
    v_mfma_f32_16x16x32_bf16 v[16:19], v[220:223], v[84:87], v[16:19]
    v_fma_mix_f32 v6, v54, v166, 0 op_sel:[0,0,0] op_sel_hi:[0,1,0]
    v_fma_mix_f32 v7, v55, v167, 0 op_sel:[0,0,0] op_sel_hi:[0,1,0]
    v_fma_mix_f32 v6, v70, v166, v6 op_sel:[0,1,0] op_sel_hi:[0,1,0]
    v_mfma_f32_16x16x32_bf16 v[32:35], v[220:223], v[92:95], v[32:35]
    v_fma_mix_f32 v7, v71, v167, v7 op_sel:[0,1,0] op_sel_hi:[0,1,0]
    v_fma_mix_f32 v70, v70, v166, 0 op_sel:[0,0,0] op_sel_hi:[0,1,0]
    v_fma_mix_f32 v71, v71, v167, 0 op_sel:[0,0,0] op_sel_hi:[0,1,0]
    v_mfma_f32_16x16x32_bf16 v[20:23], v[228:231], v[84:87], v[20:23]
    v_fma_mix_f32 v70, -v54, v166, v70 op_sel:[0,1,0] op_sel_hi:[0,1,0]
    v_fma_mix_f32 v71, -v55, v167, v71 op_sel:[0,1,0] op_sel_hi:[0,1,0]
    ds_read_b128 v[164:167], v2 offset:24576
    v_mfma_f32_16x16x32_bf16 v[36:39], v[228:231], v[92:95], v[36:39]
    v_cvt_pk_bf16_f32 v103, v6, v7
    v_cvt_pk_bf16_f32 v119, -v6, -v7
    v_cvt_pk_bf16_f32 v111, v70, v71
    v_mfma_f32_16x16x32_bf16 v[40:43], v[168:171], v[96:99], 0
    s_waitcnt lgkmcnt(3)
    v_lshlrev_b32 v6, 16, v152
    v_lshlrev_b32 v7, 16, v153
    v_and_b32 v152, 0xffff0000, v152
    v_mfma_f32_16x16x32_bf16 v[56:59], v[168:171], v[104:107], 0
    v_and_b32 v153, 0xffff0000, v153
    v_mul_f32 v4, v8, v6
    v_mul_f32 v5, v9, v7
    v_fma_f32 v4, -v24, v152, v4
    v_mfma_f32_16x16x32_bf16 v[44:47], v[176:179], v[96:99], 0
    v_fma_f32 v5, -v25, v153, v5
    v_mul_f32 v24, v24, v6
    v_mul_f32 v25, v25, v7
    v_fmac_f32 v24, v8, v152
    v_mfma_f32_16x16x32_bf16 v[60:63], v[176:179], v[104:107], 0
    v_fmac_f32 v25, v9, v153
    v_cvt_pk_bf16_f32 v72, v4, v5
    v_cvt_pk_bf16_f32 v80, v24, v25
    v_cvt_pk_bf16_f32 v88, -v24, -v25
    v_mfma_f32_16x16x32_bf16 v[48:51], v[184:187], v[96:99], 0
    v_lshlrev_b32 v6, 16, v154
    v_lshlrev_b32 v7, 16, v155
    v_and_b32 v154, 0xffff0000, v154
    v_and_b32 v155, 0xffff0000, v155
    v_mfma_f32_16x16x32_bf16 v[64:67], v[184:187], v[104:107], 0
    v_mul_f32 v4, v10, v6
    v_mul_f32 v5, v11, v7
    v_fma_f32 v4, -v26, v154, v4
    v_fma_f32 v5, -v27, v155, v5
    v_mfma_f32_16x16x32_bf16 v[52:55], v[192:195], v[96:99], 0
    v_mul_f32 v26, v26, v6
    v_mul_f32 v27, v27, v7
    v_fmac_f32 v26, v10, v154
    v_fmac_f32 v27, v11, v155
    v_mfma_f32_16x16x32_bf16 v[68:71], v[192:195], v[104:107], 0
    ds_read_b128 v[152:155], v2 offset:32768
    v_cvt_pk_bf16_f32 v73, v4, v5
    v_cvt_pk_bf16_f32 v81, v26, v27
    v_cvt_pk_bf16_f32 v89, -v26, -v27
    v_mfma_f32_16x16x32_bf16 v[40:43], v[200:203], v[104:107], v[40:43]
    s_waitcnt lgkmcnt(3)
    v_lshlrev_b32 v6, 16, v156
    v_lshlrev_b32 v7, 16, v157
    v_and_b32 v156, 0xffff0000, v156
    v_mfma_f32_16x16x32_bf16 v[56:59], v[200:203], v[112:115], v[56:59]
    v_and_b32 v157, 0xffff0000, v157
    v_mul_f32 v4, v12, v6
    v_mul_f32 v5, v13, v7
    v_fma_f32 v4, -v28, v156, v4
    v_mfma_f32_16x16x32_bf16 v[44:47], v[208:211], v[104:107], v[44:47]
    v_fma_f32 v5, -v29, v157, v5
    v_mul_f32 v28, v28, v6
    v_mul_f32 v29, v29, v7
    v_fmac_f32 v28, v12, v156
    v_mfma_f32_16x16x32_bf16 v[60:63], v[208:211], v[112:115], v[60:63]
    v_fmac_f32 v29, v13, v157
    v_cvt_pk_bf16_f32 v74, v4, v5
    v_cvt_pk_bf16_f32 v82, v28, v29
    v_cvt_pk_bf16_f32 v90, -v28, -v29
    v_mfma_f32_16x16x32_bf16 v[48:51], v[216:219], v[104:107], v[48:51]
    v_lshlrev_b32 v6, 16, v158
    v_lshlrev_b32 v7, 16, v159
    v_and_b32 v158, 0xffff0000, v158
    v_and_b32 v159, 0xffff0000, v159
    v_mfma_f32_16x16x32_bf16 v[64:67], v[216:219], v[112:115], v[64:67]
    v_mul_f32 v4, v14, v6
    v_mul_f32 v5, v15, v7
    v_fma_f32 v4, -v30, v158, v4
    v_fma_f32 v5, -v31, v159, v5
    v_mfma_f32_16x16x32_bf16 v[52:55], v[224:227], v[104:107], v[52:55]
    v_mul_f32 v30, v30, v6
    v_mul_f32 v31, v31, v7
    v_fmac_f32 v30, v14, v158
    v_fmac_f32 v31, v15, v159
    v_mfma_f32_16x16x32_bf16 v[68:71], v[224:227], v[112:115], v[68:71]
    ds_read_b128 v[156:159], v2 offset:40960
    v_cvt_pk_bf16_f32 v75, v4, v5
    v_cvt_pk_bf16_f32 v83, v30, v31
    v_cvt_pk_bf16_f32 v91, -v30, -v31
    v_mfma_f32_16x16x32_bf16 v[40:43], v[172:175], v[100:103], v[40:43]
    s_waitcnt lgkmcnt(3)
    v_lshlrev_b32 v6, 16, v160
    v_lshlrev_b32 v7, 16, v161
    v_and_b32 v160, 0xffff0000, v160
    v_mfma_f32_16x16x32_bf16 v[56:59], v[172:175], v[108:111], v[56:59]
    v_and_b32 v161, 0xffff0000, v161
    v_mul_f32 v4, v16, v6
    v_mul_f32 v5, v17, v7
    v_fma_f32 v4, -v32, v160, v4
    v_mfma_f32_16x16x32_bf16 v[44:47], v[180:183], v[100:103], v[44:47]
    v_fma_f32 v5, -v33, v161, v5
    v_mul_f32 v32, v32, v6
    v_mul_f32 v33, v33, v7
    v_fmac_f32 v32, v16, v160
    v_mfma_f32_16x16x32_bf16 v[60:63], v[180:183], v[108:111], v[60:63]
    v_fmac_f32 v33, v17, v161
    v_cvt_pk_bf16_f32 v76, v4, v5
    v_cvt_pk_bf16_f32 v84, v32, v33
    v_cvt_pk_bf16_f32 v92, -v32, -v33
    v_mfma_f32_16x16x32_bf16 v[48:51], v[188:191], v[100:103], v[48:51]
    v_lshlrev_b32 v6, 16, v162
    v_lshlrev_b32 v7, 16, v163
    v_and_b32 v162, 0xffff0000, v162
    v_and_b32 v163, 0xffff0000, v163
    v_mfma_f32_16x16x32_bf16 v[64:67], v[188:191], v[108:111], v[64:67]
    v_mul_f32 v4, v18, v6
    v_mul_f32 v5, v19, v7
    v_fma_f32 v4, -v34, v162, v4
    v_fma_f32 v5, -v35, v163, v5
    v_mfma_f32_16x16x32_bf16 v[52:55], v[196:199], v[100:103], v[52:55]
    v_mul_f32 v34, v34, v6
    v_mul_f32 v35, v35, v7
    v_fmac_f32 v34, v18, v162
    v_fmac_f32 v35, v19, v163
    v_mfma_f32_16x16x32_bf16 v[68:71], v[196:199], v[108:111], v[68:71]
    ds_read_b128 v[160:163], v2 offset:49152
    v_cvt_pk_bf16_f32 v77, v4, v5
    v_cvt_pk_bf16_f32 v85, v34, v35
    v_cvt_pk_bf16_f32 v93, -v34, -v35
    v_mfma_f32_16x16x32_bf16 v[40:43], v[204:207], v[108:111], v[40:43]
    s_waitcnt lgkmcnt(3)
    v_lshlrev_b32 v6, 16, v164
    v_lshlrev_b32 v7, 16, v165
    v_and_b32 v164, 0xffff0000, v164
    v_mfma_f32_16x16x32_bf16 v[56:59], v[204:207], v[116:119], v[56:59]
    v_and_b32 v165, 0xffff0000, v165
    v_mul_f32 v4, v20, v6
    v_mul_f32 v5, v21, v7
    v_fma_f32 v4, -v36, v164, v4
    v_mfma_f32_16x16x32_bf16 v[44:47], v[212:215], v[108:111], v[44:47]
    v_fma_f32 v5, -v37, v165, v5
    v_mul_f32 v36, v36, v6
    v_mul_f32 v37, v37, v7
    v_fmac_f32 v36, v20, v164
    v_mfma_f32_16x16x32_bf16 v[60:63], v[212:215], v[116:119], v[60:63]
    v_fmac_f32 v37, v21, v165
    v_cvt_pk_bf16_f32 v78, v4, v5
    v_cvt_pk_bf16_f32 v86, v36, v37
    v_cvt_pk_bf16_f32 v94, -v36, -v37
    v_mfma_f32_16x16x32_bf16 v[48:51], v[220:223], v[108:111], v[48:51]
    v_lshlrev_b32 v6, 16, v166
    v_lshlrev_b32 v7, 16, v167
    v_and_b32 v166, 0xffff0000, v166
    v_and_b32 v167, 0xffff0000, v167
    v_mfma_f32_16x16x32_bf16 v[64:67], v[220:223], v[116:119], v[64:67]
    v_mul_f32 v4, v22, v6
    v_mul_f32 v5, v23, v7
    v_fma_f32 v4, -v38, v166, v4
    v_fma_f32 v5, -v39, v167, v5
    v_mfma_f32_16x16x32_bf16 v[52:55], v[228:231], v[108:111], v[52:55]
    v_mul_f32 v38, v38, v6
    v_mul_f32 v39, v39, v7
    v_fmac_f32 v38, v22, v166
    v_fmac_f32 v39, v23, v167
    v_mfma_f32_16x16x32_bf16 v[68:71], v[228:231], v[116:119], v[68:71]
    ds_read_b128 v[164:167], v2 offset:57344
    v_cvt_pk_bf16_f32 v79, v4, v5
    v_cvt_pk_bf16_f32 v87, v38, v39
    v_cvt_pk_bf16_f32 v95, -v38, -v39
    v_mfma_f32_16x16x32_bf16 v[8:11], v[72:75], v[168:171], 0
    s_waitcnt lgkmcnt(3)
    v_lshlrev_b32 v6, 16, v152
    v_lshlrev_b32 v7, 16, v153
    v_and_b32 v152, 0xffff0000, v152
    v_mfma_f32_16x16x32_bf16 v[24:27], v[80:83], v[168:171], 0
    v_and_b32 v153, 0xffff0000, v153
    v_mul_f32 v4, v40, v6
    v_mul_f32 v5, v41, v7
    v_fma_f32 v4, -v56, v152, v4
    v_mfma_f32_16x16x32_bf16 v[12:15], v[72:75], v[176:179], 0
    v_fma_f32 v5, -v57, v153, v5
    v_mul_f32 v56, v56, v6
    v_mul_f32 v57, v57, v7
    v_fmac_f32 v56, v40, v152
    v_mfma_f32_16x16x32_bf16 v[28:31], v[80:83], v[176:179], 0
    v_fmac_f32 v57, v41, v153
    v_cvt_pk_bf16_f32 v96, v4, v5
    v_cvt_pk_bf16_f32 v104, v56, v57
    v_cvt_pk_bf16_f32 v112, -v56, -v57
    v_mfma_f32_16x16x32_bf16 v[16:19], v[72:75], v[184:187], 0
    v_lshlrev_b32 v6, 16, v154
    v_lshlrev_b32 v7, 16, v155
    v_and_b32 v154, 0xffff0000, v154
    v_and_b32 v155, 0xffff0000, v155
    v_mfma_f32_16x16x32_bf16 v[32:35], v[80:83], v[184:187], 0
    v_mul_f32 v4, v42, v6
    v_mul_f32 v5, v43, v7
    v_fma_f32 v4, -v58, v154, v4
    v_fma_f32 v5, -v59, v155, v5
    v_mfma_f32_16x16x32_bf16 v[20:23], v[72:75], v[192:195], 0
    v_mul_f32 v58, v58, v6
    v_mul_f32 v59, v59, v7
    v_fmac_f32 v58, v42, v154
    v_fmac_f32 v59, v43, v155
    v_mfma_f32_16x16x32_bf16 v[36:39], v[80:83], v[192:195], 0
    ds_read_b128 v[152:155], v1 offset:24576
    v_cvt_pk_bf16_f32 v97, v4, v5
    v_cvt_pk_bf16_f32 v105, v58, v59
    v_cvt_pk_bf16_f32 v113, -v58, -v59
    v_mfma_f32_16x16x32_bf16 v[8:11], v[88:91], v[200:203], v[8:11]
    s_waitcnt lgkmcnt(3)
    v_lshlrev_b32 v6, 16, v156
    v_lshlrev_b32 v7, 16, v157
    v_and_b32 v156, 0xffff0000, v156
    v_mfma_f32_16x16x32_bf16 v[24:27], v[72:75], v[200:203], v[24:27]
    v_and_b32 v157, 0xffff0000, v157
    v_mul_f32 v4, v44, v6
    v_mul_f32 v5, v45, v7
    v_fma_f32 v4, -v60, v156, v4
    v_mfma_f32_16x16x32_bf16 v[12:15], v[88:91], v[208:211], v[12:15]
    v_fma_f32 v5, -v61, v157, v5
    v_mul_f32 v60, v60, v6
    v_mul_f32 v61, v61, v7
    v_fmac_f32 v60, v44, v156
    v_mfma_f32_16x16x32_bf16 v[28:31], v[72:75], v[208:211], v[28:31]
    v_fmac_f32 v61, v45, v157
    v_cvt_pk_bf16_f32 v98, v4, v5
    v_cvt_pk_bf16_f32 v106, v60, v61
    v_cvt_pk_bf16_f32 v114, -v60, -v61
    v_mfma_f32_16x16x32_bf16 v[16:19], v[88:91], v[216:219], v[16:19]
    v_lshlrev_b32 v6, 16, v158
    v_lshlrev_b32 v7, 16, v159
    v_and_b32 v158, 0xffff0000, v158
    v_and_b32 v159, 0xffff0000, v159
    v_mfma_f32_16x16x32_bf16 v[32:35], v[72:75], v[216:219], v[32:35]
    v_mul_f32 v4, v46, v6
    v_mul_f32 v5, v47, v7
    v_fma_f32 v4, -v62, v158, v4
    v_fma_f32 v5, -v63, v159, v5
    v_mfma_f32_16x16x32_bf16 v[20:23], v[88:91], v[224:227], v[20:23]
    v_mul_f32 v62, v62, v6
    v_mul_f32 v63, v63, v7
    v_fmac_f32 v62, v46, v158
    v_fmac_f32 v63, v47, v159
    v_mfma_f32_16x16x32_bf16 v[36:39], v[72:75], v[224:227], v[36:39]
    ds_read_b128 v[156:159], v1 offset:25600
    v_cvt_pk_bf16_f32 v99, v4, v5
    v_cvt_pk_bf16_f32 v107, v62, v63
    v_cvt_pk_bf16_f32 v115, -v62, -v63
    v_mfma_f32_16x16x32_bf16 v[8:11], v[76:79], v[172:175], v[8:11]
    s_waitcnt lgkmcnt(3)
    v_lshlrev_b32 v6, 16, v160
    v_lshlrev_b32 v7, 16, v161
    v_and_b32 v160, 0xffff0000, v160
    v_mfma_f32_16x16x32_bf16 v[24:27], v[84:87], v[172:175], v[24:27]
    v_and_b32 v161, 0xffff0000, v161
    v_mul_f32 v4, v48, v6
    v_mul_f32 v5, v49, v7
    v_fma_f32 v4, -v64, v160, v4
    v_mfma_f32_16x16x32_bf16 v[12:15], v[76:79], v[180:183], v[12:15]
    v_fma_f32 v5, -v65, v161, v5
    v_mul_f32 v64, v64, v6
    v_mul_f32 v65, v65, v7
    v_fmac_f32 v64, v48, v160
    v_mfma_f32_16x16x32_bf16 v[28:31], v[84:87], v[180:183], v[28:31]
    v_fmac_f32 v65, v49, v161
    v_cvt_pk_bf16_f32 v100, v4, v5
    v_cvt_pk_bf16_f32 v108, v64, v65
    v_cvt_pk_bf16_f32 v116, -v64, -v65
    v_mfma_f32_16x16x32_bf16 v[16:19], v[76:79], v[188:191], v[16:19]
    v_lshlrev_b32 v6, 16, v162
    v_lshlrev_b32 v7, 16, v163
    v_and_b32 v162, 0xffff0000, v162
    v_and_b32 v163, 0xffff0000, v163
    v_mfma_f32_16x16x32_bf16 v[32:35], v[84:87], v[188:191], v[32:35]
    v_mul_f32 v4, v50, v6
    v_mul_f32 v5, v51, v7
    v_fma_f32 v4, -v66, v162, v4
    v_fma_f32 v5, -v67, v163, v5
    v_mfma_f32_16x16x32_bf16 v[20:23], v[76:79], v[196:199], v[20:23]
    v_mul_f32 v66, v66, v6
    v_mul_f32 v67, v67, v7
    v_fmac_f32 v66, v50, v162
    v_fmac_f32 v67, v51, v163
    v_mfma_f32_16x16x32_bf16 v[36:39], v[84:87], v[196:199], v[36:39]
    ds_read_b128 v[160:163], v1 offset:26624
    v_cvt_pk_bf16_f32 v101, v4, v5
    v_cvt_pk_bf16_f32 v109, v66, v67
    v_cvt_pk_bf16_f32 v117, -v66, -v67
    v_mfma_f32_16x16x32_bf16 v[8:11], v[92:95], v[204:207], v[8:11]
    s_waitcnt lgkmcnt(3)
    v_lshlrev_b32 v6, 16, v164
    v_lshlrev_b32 v7, 16, v165
    v_and_b32 v164, 0xffff0000, v164
    v_mfma_f32_16x16x32_bf16 v[24:27], v[76:79], v[204:207], v[24:27]
    v_and_b32 v165, 0xffff0000, v165
    v_mul_f32 v4, v52, v6
    v_mul_f32 v5, v53, v7
    v_fma_f32 v4, -v68, v164, v4
    v_mfma_f32_16x16x32_bf16 v[12:15], v[92:95], v[212:215], v[12:15]
    v_fma_f32 v5, -v69, v165, v5
    v_mul_f32 v68, v68, v6
    v_mul_f32 v69, v69, v7
    v_fmac_f32 v68, v52, v164
    v_mfma_f32_16x16x32_bf16 v[28:31], v[76:79], v[212:215], v[28:31]
    v_fmac_f32 v69, v53, v165
    v_cvt_pk_bf16_f32 v102, v4, v5
    v_cvt_pk_bf16_f32 v110, v68, v69
    v_cvt_pk_bf16_f32 v118, -v68, -v69
    v_mfma_f32_16x16x32_bf16 v[16:19], v[92:95], v[220:223], v[16:19]
    v_lshlrev_b32 v6, 16, v166
    v_lshlrev_b32 v7, 16, v167
    v_and_b32 v166, 0xffff0000, v166
    v_and_b32 v167, 0xffff0000, v167
    v_mfma_f32_16x16x32_bf16 v[32:35], v[76:79], v[220:223], v[32:35]
    v_mul_f32 v4, v54, v6
    v_mul_f32 v5, v55, v7
    v_fma_f32 v4, -v70, v166, v4
    v_fma_f32 v5, -v71, v167, v5
    v_mfma_f32_16x16x32_bf16 v[20:23], v[92:95], v[228:231], v[20:23]
    v_mul_f32 v70, v70, v6
    v_mul_f32 v71, v71, v7
    v_fmac_f32 v70, v54, v166
    v_fmac_f32 v71, v55, v167
    v_mfma_f32_16x16x32_bf16 v[36:39], v[76:79], v[228:231], v[36:39]
    ds_read_b128 v[164:167], v1 offset:27648
    v_cvt_pk_bf16_f32 v103, v4, v5
    v_cvt_pk_bf16_f32 v111, v70, v71
    v_cvt_pk_bf16_f32 v119, -v70, -v71
    v_mfma_f32_16x16x32_bf16 v[40:43], v[96:99], v[168:171], 0
    s_waitcnt lgkmcnt(3)
    v_fma_mix_f32 v4, v8, v152, 0 op_sel:[0,0,0] op_sel_hi:[0,1,0]
    v_mfma_f32_16x16x32_bf16 v[56:59], v[104:107], v[168:171], 0
    v_fma_mix_f32 v5, v9, v153, 0 op_sel:[0,0,0] op_sel_hi:[0,1,0]
    v_fma_mix_f32 v4, -v24, v152, v4 op_sel:[0,1,0] op_sel_hi:[0,1,0]
    v_fma_mix_f32 v5, -v25, v153, v5 op_sel:[0,1,0] op_sel_hi:[0,1,0]
    v_mfma_f32_16x16x32_bf16 v[44:47], v[96:99], v[176:179], 0
    v_fma_mix_f32 v24, v24, v152, 0 op_sel:[0,0,0] op_sel_hi:[0,1,0]
    v_fma_mix_f32 v25, v25, v153, 0 op_sel:[0,0,0] op_sel_hi:[0,1,0]
    v_fma_mix_f32 v24, v8, v152, v24 op_sel:[0,1,0] op_sel_hi:[0,1,0]
    v_mfma_f32_16x16x32_bf16 v[60:63], v[104:107], v[176:179], 0
    v_fma_mix_f32 v25, v9, v153, v25 op_sel:[0,1,0] op_sel_hi:[0,1,0]
    v_cvt_pk_bf16_f32 v120, v4, v5
    v_cvt_pk_bf16_f32 v136, v24, v25
    v_mfma_f32_16x16x32_bf16 v[48:51], v[96:99], v[184:187], 0
    v_fma_mix_f32 v6, v10, v154, 0 op_sel:[0,0,0] op_sel_hi:[0,1,0]
    v_fma_mix_f32 v7, v11, v155, 0 op_sel:[0,0,0] op_sel_hi:[0,1,0]
    v_mfma_f32_16x16x32_bf16 v[64:67], v[104:107], v[184:187], 0
    v_fma_mix_f32 v6, -v26, v154, v6 op_sel:[0,1,0] op_sel_hi:[0,1,0]
    v_fma_mix_f32 v7, -v27, v155, v7 op_sel:[0,1,0] op_sel_hi:[0,1,0]
    v_fma_mix_f32 v26, v26, v154, 0 op_sel:[0,0,0] op_sel_hi:[0,1,0]
    v_mfma_f32_16x16x32_bf16 v[52:55], v[96:99], v[192:195], 0
    v_fma_mix_f32 v27, v27, v155, 0 op_sel:[0,0,0] op_sel_hi:[0,1,0]
    v_fma_mix_f32 v26, v10, v154, v26 op_sel:[0,1,0] op_sel_hi:[0,1,0]
    v_fma_mix_f32 v27, v11, v155, v27 op_sel:[0,1,0] op_sel_hi:[0,1,0]
    v_mfma_f32_16x16x32_bf16 v[68:71], v[104:107], v[192:195], 0
    ds_read_b128 v[152:155], v1 offset:28672
    v_cvt_pk_bf16_f32 v121, v6, v7
    v_cvt_pk_bf16_f32 v137, v26, v27
    v_mfma_f32_16x16x32_bf16 v[40:43], v[112:115], v[200:203], v[40:43]
    s_waitcnt lgkmcnt(3)
    v_fma_mix_f32 v4, v12, v156, 0 op_sel:[0,0,0] op_sel_hi:[0,1,0]
    v_mfma_f32_16x16x32_bf16 v[56:59], v[96:99], v[200:203], v[56:59]
    v_fma_mix_f32 v5, v13, v157, 0 op_sel:[0,0,0] op_sel_hi:[0,1,0]
    v_fma_mix_f32 v4, -v28, v156, v4 op_sel:[0,1,0] op_sel_hi:[0,1,0]
    v_fma_mix_f32 v5, -v29, v157, v5 op_sel:[0,1,0] op_sel_hi:[0,1,0]
    v_mfma_f32_16x16x32_bf16 v[44:47], v[112:115], v[208:211], v[44:47]
    v_fma_mix_f32 v28, v28, v156, 0 op_sel:[0,0,0] op_sel_hi:[0,1,0]
    v_fma_mix_f32 v29, v29, v157, 0 op_sel:[0,0,0] op_sel_hi:[0,1,0]
    v_fma_mix_f32 v28, v12, v156, v28 op_sel:[0,1,0] op_sel_hi:[0,1,0]
    v_mfma_f32_16x16x32_bf16 v[60:63], v[96:99], v[208:211], v[60:63]
    v_fma_mix_f32 v29, v13, v157, v29 op_sel:[0,1,0] op_sel_hi:[0,1,0]
    v_cvt_pk_bf16_f32 v124, v4, v5
    v_cvt_pk_bf16_f32 v140, v28, v29
    v_mfma_f32_16x16x32_bf16 v[48:51], v[112:115], v[216:219], v[48:51]
    v_fma_mix_f32 v6, v14, v158, 0 op_sel:[0,0,0] op_sel_hi:[0,1,0]
    v_fma_mix_f32 v7, v15, v159, 0 op_sel:[0,0,0] op_sel_hi:[0,1,0]
    v_mfma_f32_16x16x32_bf16 v[64:67], v[96:99], v[216:219], v[64:67]
    v_fma_mix_f32 v6, -v30, v158, v6 op_sel:[0,1,0] op_sel_hi:[0,1,0]
    v_fma_mix_f32 v7, -v31, v159, v7 op_sel:[0,1,0] op_sel_hi:[0,1,0]
    v_fma_mix_f32 v30, v30, v158, 0 op_sel:[0,0,0] op_sel_hi:[0,1,0]
    v_mfma_f32_16x16x32_bf16 v[52:55], v[112:115], v[224:227], v[52:55]
    v_fma_mix_f32 v31, v31, v159, 0 op_sel:[0,0,0] op_sel_hi:[0,1,0]
    v_fma_mix_f32 v30, v14, v158, v30 op_sel:[0,1,0] op_sel_hi:[0,1,0]
    v_fma_mix_f32 v31, v15, v159, v31 op_sel:[0,1,0] op_sel_hi:[0,1,0]
    v_mfma_f32_16x16x32_bf16 v[68:71], v[96:99], v[224:227], v[68:71]
    ds_read_b128 v[156:159], v1 offset:29696
    v_cvt_pk_bf16_f32 v125, v6, v7
    v_cvt_pk_bf16_f32 v141, v30, v31
    v_mfma_f32_16x16x32_bf16 v[40:43], v[100:103], v[172:175], v[40:43]
    s_waitcnt lgkmcnt(3)
    v_fma_mix_f32 v4, v16, v160, 0 op_sel:[0,0,0] op_sel_hi:[0,1,0]
    v_mfma_f32_16x16x32_bf16 v[56:59], v[108:111], v[172:175], v[56:59]
    v_fma_mix_f32 v5, v17, v161, 0 op_sel:[0,0,0] op_sel_hi:[0,1,0]
    v_fma_mix_f32 v4, -v32, v160, v4 op_sel:[0,1,0] op_sel_hi:[0,1,0]
    v_fma_mix_f32 v5, -v33, v161, v5 op_sel:[0,1,0] op_sel_hi:[0,1,0]
    v_mfma_f32_16x16x32_bf16 v[44:47], v[100:103], v[180:183], v[44:47]
    v_fma_mix_f32 v32, v32, v160, 0 op_sel:[0,0,0] op_sel_hi:[0,1,0]
    v_fma_mix_f32 v33, v33, v161, 0 op_sel:[0,0,0] op_sel_hi:[0,1,0]
    v_fma_mix_f32 v32, v16, v160, v32 op_sel:[0,1,0] op_sel_hi:[0,1,0]
    v_mfma_f32_16x16x32_bf16 v[60:63], v[108:111], v[180:183], v[60:63]
    v_fma_mix_f32 v33, v17, v161, v33 op_sel:[0,1,0] op_sel_hi:[0,1,0]
    v_cvt_pk_bf16_f32 v128, v4, v5
    v_cvt_pk_bf16_f32 v144, v32, v33
    v_mfma_f32_16x16x32_bf16 v[48:51], v[100:103], v[188:191], v[48:51]
    v_fma_mix_f32 v6, v18, v162, 0 op_sel:[0,0,0] op_sel_hi:[0,1,0]
    v_fma_mix_f32 v7, v19, v163, 0 op_sel:[0,0,0] op_sel_hi:[0,1,0]
    v_mfma_f32_16x16x32_bf16 v[64:67], v[108:111], v[188:191], v[64:67]
    v_fma_mix_f32 v6, -v34, v162, v6 op_sel:[0,1,0] op_sel_hi:[0,1,0]
    v_fma_mix_f32 v7, -v35, v163, v7 op_sel:[0,1,0] op_sel_hi:[0,1,0]
    v_fma_mix_f32 v34, v34, v162, 0 op_sel:[0,0,0] op_sel_hi:[0,1,0]
    v_mfma_f32_16x16x32_bf16 v[52:55], v[100:103], v[196:199], v[52:55]
    v_fma_mix_f32 v35, v35, v163, 0 op_sel:[0,0,0] op_sel_hi:[0,1,0]
    v_fma_mix_f32 v34, v18, v162, v34 op_sel:[0,1,0] op_sel_hi:[0,1,0]
    v_fma_mix_f32 v35, v19, v163, v35 op_sel:[0,1,0] op_sel_hi:[0,1,0]
    v_mfma_f32_16x16x32_bf16 v[68:71], v[108:111], v[196:199], v[68:71]
    ds_read_b128 v[160:163], v1 offset:30720
    v_cvt_pk_bf16_f32 v129, v6, v7
    v_cvt_pk_bf16_f32 v145, v34, v35
    v_mfma_f32_16x16x32_bf16 v[40:43], v[116:119], v[204:207], v[40:43]
    s_waitcnt lgkmcnt(3)
    v_fma_mix_f32 v4, v20, v164, 0 op_sel:[0,0,0] op_sel_hi:[0,1,0]
    v_mfma_f32_16x16x32_bf16 v[56:59], v[100:103], v[204:207], v[56:59]
    v_fma_mix_f32 v5, v21, v165, 0 op_sel:[0,0,0] op_sel_hi:[0,1,0]
    v_fma_mix_f32 v4, -v36, v164, v4 op_sel:[0,1,0] op_sel_hi:[0,1,0]
    v_fma_mix_f32 v5, -v37, v165, v5 op_sel:[0,1,0] op_sel_hi:[0,1,0]
    v_mfma_f32_16x16x32_bf16 v[44:47], v[116:119], v[212:215], v[44:47]
    v_fma_mix_f32 v36, v36, v164, 0 op_sel:[0,0,0] op_sel_hi:[0,1,0]
    v_fma_mix_f32 v37, v37, v165, 0 op_sel:[0,0,0] op_sel_hi:[0,1,0]
    v_fma_mix_f32 v36, v20, v164, v36 op_sel:[0,1,0] op_sel_hi:[0,1,0]
    v_mfma_f32_16x16x32_bf16 v[60:63], v[100:103], v[212:215], v[60:63]
    v_fma_mix_f32 v37, v21, v165, v37 op_sel:[0,1,0] op_sel_hi:[0,1,0]
    v_cvt_pk_bf16_f32 v132, v4, v5
    v_cvt_pk_bf16_f32 v148, v36, v37
    v_mfma_f32_16x16x32_bf16 v[48:51], v[116:119], v[220:223], v[48:51]
    v_fma_mix_f32 v6, v22, v166, 0 op_sel:[0,0,0] op_sel_hi:[0,1,0]
    v_fma_mix_f32 v7, v23, v167, 0 op_sel:[0,0,0] op_sel_hi:[0,1,0]
    v_mfma_f32_16x16x32_bf16 v[64:67], v[100:103], v[220:223], v[64:67]
    v_fma_mix_f32 v6, -v38, v166, v6 op_sel:[0,1,0] op_sel_hi:[0,1,0]
    v_fma_mix_f32 v7, -v39, v167, v7 op_sel:[0,1,0] op_sel_hi:[0,1,0]
    v_fma_mix_f32 v38, v38, v166, 0 op_sel:[0,0,0] op_sel_hi:[0,1,0]
    v_mfma_f32_16x16x32_bf16 v[52:55], v[116:119], v[228:231], v[52:55]
    v_fma_mix_f32 v39, v39, v167, 0 op_sel:[0,0,0] op_sel_hi:[0,1,0]
    v_fma_mix_f32 v38, v22, v166, v38 op_sel:[0,1,0] op_sel_hi:[0,1,0]
    v_fma_mix_f32 v39, v23, v167, v39 op_sel:[0,1,0] op_sel_hi:[0,1,0]
    v_mfma_f32_16x16x32_bf16 v[68:71], v[100:103], v[228:231], v[68:71]
    ds_read_b128 v[164:167], v1 offset:31744
    v_cvt_pk_bf16_f32 v133, v6, v7
    v_cvt_pk_bf16_f32 v149, v38, v39
    s_waitcnt lgkmcnt(3)
    v_fma_mix_f32 v4, v40, v152, 0 op_sel:[0,0,0] op_sel_hi:[0,1,0]
    v_fma_mix_f32 v5, v41, v153, 0 op_sel:[0,0,0] op_sel_hi:[0,1,0]
    v_fma_mix_f32 v4, -v56, v152, v4 op_sel:[0,1,0] op_sel_hi:[0,1,0]
    v_fma_mix_f32 v5, -v57, v153, v5 op_sel:[0,1,0] op_sel_hi:[0,1,0]
    v_fma_mix_f32 v56, v56, v152, 0 op_sel:[0,0,0] op_sel_hi:[0,1,0]
    v_fma_mix_f32 v57, v57, v153, 0 op_sel:[0,0,0] op_sel_hi:[0,1,0]
    v_fma_mix_f32 v56, v40, v152, v56 op_sel:[0,1,0] op_sel_hi:[0,1,0]
    v_fma_mix_f32 v57, v41, v153, v57 op_sel:[0,1,0] op_sel_hi:[0,1,0]
    v_cvt_pk_bf16_f32 v122, v4, v5
    v_cvt_pk_bf16_f32 v138, v56, v57
    v_fma_mix_f32 v6, v42, v154, 0 op_sel:[0,0,0] op_sel_hi:[0,1,0]
    v_fma_mix_f32 v7, v43, v155, 0 op_sel:[0,0,0] op_sel_hi:[0,1,0]
    v_fma_mix_f32 v6, -v58, v154, v6 op_sel:[0,1,0] op_sel_hi:[0,1,0]
    v_fma_mix_f32 v7, -v59, v155, v7 op_sel:[0,1,0] op_sel_hi:[0,1,0]
    v_fma_mix_f32 v58, v58, v154, 0 op_sel:[0,0,0] op_sel_hi:[0,1,0]
    v_fma_mix_f32 v59, v59, v155, 0 op_sel:[0,0,0] op_sel_hi:[0,1,0]
    v_fma_mix_f32 v58, v42, v154, v58 op_sel:[0,1,0] op_sel_hi:[0,1,0]
    v_fma_mix_f32 v59, v43, v155, v59 op_sel:[0,1,0] op_sel_hi:[0,1,0]
    v_cvt_pk_bf16_f32 v123, v6, v7
    v_cvt_pk_bf16_f32 v139, v58, v59
    s_waitcnt lgkmcnt(2)
    v_fma_mix_f32 v4, v44, v156, 0 op_sel:[0,0,0] op_sel_hi:[0,1,0]
    v_fma_mix_f32 v5, v45, v157, 0 op_sel:[0,0,0] op_sel_hi:[0,1,0]
    v_fma_mix_f32 v4, -v60, v156, v4 op_sel:[0,1,0] op_sel_hi:[0,1,0]
    v_fma_mix_f32 v5, -v61, v157, v5 op_sel:[0,1,0] op_sel_hi:[0,1,0]
    v_fma_mix_f32 v60, v60, v156, 0 op_sel:[0,0,0] op_sel_hi:[0,1,0]
    v_fma_mix_f32 v61, v61, v157, 0 op_sel:[0,0,0] op_sel_hi:[0,1,0]
    v_fma_mix_f32 v60, v44, v156, v60 op_sel:[0,1,0] op_sel_hi:[0,1,0]
    v_fma_mix_f32 v61, v45, v157, v61 op_sel:[0,1,0] op_sel_hi:[0,1,0]
    v_cvt_pk_bf16_f32 v126, v4, v5
    v_cvt_pk_bf16_f32 v142, v60, v61
    v_fma_mix_f32 v6, v46, v158, 0 op_sel:[0,0,0] op_sel_hi:[0,1,0]
    v_fma_mix_f32 v7, v47, v159, 0 op_sel:[0,0,0] op_sel_hi:[0,1,0]
    v_fma_mix_f32 v6, -v62, v158, v6 op_sel:[0,1,0] op_sel_hi:[0,1,0]
    v_fma_mix_f32 v7, -v63, v159, v7 op_sel:[0,1,0] op_sel_hi:[0,1,0]
    v_fma_mix_f32 v62, v62, v158, 0 op_sel:[0,0,0] op_sel_hi:[0,1,0]
    v_fma_mix_f32 v63, v63, v159, 0 op_sel:[0,0,0] op_sel_hi:[0,1,0]
    v_fma_mix_f32 v62, v46, v158, v62 op_sel:[0,1,0] op_sel_hi:[0,1,0]
    v_fma_mix_f32 v63, v47, v159, v63 op_sel:[0,1,0] op_sel_hi:[0,1,0]
    v_cvt_pk_bf16_f32 v127, v6, v7
    v_cvt_pk_bf16_f32 v143, v62, v63
    s_waitcnt lgkmcnt(1)
    v_fma_mix_f32 v4, v48, v160, 0 op_sel:[0,0,0] op_sel_hi:[0,1,0]
    v_fma_mix_f32 v5, v49, v161, 0 op_sel:[0,0,0] op_sel_hi:[0,1,0]
    v_fma_mix_f32 v4, -v64, v160, v4 op_sel:[0,1,0] op_sel_hi:[0,1,0]
    v_fma_mix_f32 v5, -v65, v161, v5 op_sel:[0,1,0] op_sel_hi:[0,1,0]
    v_fma_mix_f32 v64, v64, v160, 0 op_sel:[0,0,0] op_sel_hi:[0,1,0]
    v_fma_mix_f32 v65, v65, v161, 0 op_sel:[0,0,0] op_sel_hi:[0,1,0]
    v_fma_mix_f32 v64, v48, v160, v64 op_sel:[0,1,0] op_sel_hi:[0,1,0]
    v_fma_mix_f32 v65, v49, v161, v65 op_sel:[0,1,0] op_sel_hi:[0,1,0]
    v_cvt_pk_bf16_f32 v130, v4, v5
    v_cvt_pk_bf16_f32 v146, v64, v65
    v_fma_mix_f32 v6, v50, v162, 0 op_sel:[0,0,0] op_sel_hi:[0,1,0]
    v_fma_mix_f32 v7, v51, v163, 0 op_sel:[0,0,0] op_sel_hi:[0,1,0]
    v_fma_mix_f32 v6, -v66, v162, v6 op_sel:[0,1,0] op_sel_hi:[0,1,0]
    v_fma_mix_f32 v7, -v67, v163, v7 op_sel:[0,1,0] op_sel_hi:[0,1,0]
    v_fma_mix_f32 v66, v66, v162, 0 op_sel:[0,0,0] op_sel_hi:[0,1,0]
    v_fma_mix_f32 v67, v67, v163, 0 op_sel:[0,0,0] op_sel_hi:[0,1,0]
    v_fma_mix_f32 v66, v50, v162, v66 op_sel:[0,1,0] op_sel_hi:[0,1,0]
    v_fma_mix_f32 v67, v51, v163, v67 op_sel:[0,1,0] op_sel_hi:[0,1,0]
    v_cvt_pk_bf16_f32 v131, v6, v7
    v_cvt_pk_bf16_f32 v147, v66, v67
    s_waitcnt lgkmcnt(0)
    v_fma_mix_f32 v4, v52, v164, 0 op_sel:[0,0,0] op_sel_hi:[0,1,0]
    v_fma_mix_f32 v5, v53, v165, 0 op_sel:[0,0,0] op_sel_hi:[0,1,0]
    v_fma_mix_f32 v4, -v68, v164, v4 op_sel:[0,1,0] op_sel_hi:[0,1,0]
    v_fma_mix_f32 v5, -v69, v165, v5 op_sel:[0,1,0] op_sel_hi:[0,1,0]
    v_fma_mix_f32 v68, v68, v164, 0 op_sel:[0,0,0] op_sel_hi:[0,1,0]
    v_fma_mix_f32 v69, v69, v165, 0 op_sel:[0,0,0] op_sel_hi:[0,1,0]
    v_fma_mix_f32 v68, v52, v164, v68 op_sel:[0,1,0] op_sel_hi:[0,1,0]
    v_fma_mix_f32 v69, v53, v165, v69 op_sel:[0,1,0] op_sel_hi:[0,1,0]
    v_cvt_pk_bf16_f32 v134, v4, v5
    v_cvt_pk_bf16_f32 v150, v68, v69
    v_fma_mix_f32 v6, v54, v166, 0 op_sel:[0,0,0] op_sel_hi:[0,1,0]
    v_fma_mix_f32 v7, v55, v167, 0 op_sel:[0,0,0] op_sel_hi:[0,1,0]
    v_fma_mix_f32 v6, -v70, v166, v6 op_sel:[0,1,0] op_sel_hi:[0,1,0]
    v_fma_mix_f32 v7, -v71, v167, v7 op_sel:[0,1,0] op_sel_hi:[0,1,0]
    v_fma_mix_f32 v70, v70, v166, 0 op_sel:[0,0,0] op_sel_hi:[0,1,0]
    v_fma_mix_f32 v71, v71, v167, 0 op_sel:[0,0,0] op_sel_hi:[0,1,0]
    v_fma_mix_f32 v70, v54, v166, v70 op_sel:[0,1,0] op_sel_hi:[0,1,0]
    v_fma_mix_f32 v71, v55, v167, v71 op_sel:[0,1,0] op_sel_hi:[0,1,0]
    v_cvt_pk_bf16_f32 v135, v6, v7
    v_cvt_pk_bf16_f32 v151, v70, v71
    s_lshl_b32 s38, s36, 13
    s_cmp_eq_u32 s36, 288
    s_cselect_b32 s38, 4096, s38
    s_cselect_b32 s36, 0, s36
    s_add_u32 s39, s38, 4096
    s_cmp_eq_u32 s36, 0
    s_cselect_b32 s39, 0x240000, s39
    v_mfma_f32_16x16x32_bf16 v[8:11], v[120:123], v[232:235], 0
    v_mfma_f32_16x16x32_bf16 v[24:27], v[136:139], v[232:235], 0
    v_mfma_f32_16x16x32_bf16 v[12:15], v[124:127], v[232:235], 0
    v_mfma_f32_16x16x32_bf16 v[28:31], v[140:143], v[232:235], 0
    v_mfma_f32_16x16x32_bf16 v[16:19], v[128:131], v[232:235], 0
    v_mfma_f32_16x16x32_bf16 v[32:35], v[144:147], v[232:235], 0
    v_mfma_f32_16x16x32_bf16 v[20:23], v[132:135], v[232:235], 0
    v_mfma_f32_16x16x32_bf16 v[36:39], v[148:151], v[232:235], 0
    v_mfma_f32_16x16x32_bf16 v[8:11], v[136:139], v[248:251], v[8:11]
    v_mfma_f32_16x16x32_bf16 v[24:27], v[120:123], v[240:243], v[24:27]
    v_mfma_f32_16x16x32_bf16 v[12:15], v[140:143], v[248:251], v[12:15]
    v_mfma_f32_16x16x32_bf16 v[28:31], v[124:127], v[240:243], v[28:31]
    v_mfma_f32_16x16x32_bf16 v[16:19], v[144:147], v[248:251], v[16:19]
    v_mfma_f32_16x16x32_bf16 v[32:35], v[128:131], v[240:243], v[32:35]
    v_mfma_f32_16x16x32_bf16 v[20:23], v[148:151], v[248:251], v[20:23]
    v_mfma_f32_16x16x32_bf16 v[36:39], v[132:135], v[240:243], v[36:39]
    v_mfma_f32_16x16x32_bf16 v[40:43], v[120:123], v[236:239], 0
    v_cvt_pk_bf16_f32 v8, v8, v9
    v_mfma_f32_16x16x32_bf16 v[56:59], v[136:139], v[236:239], 0
    v_cvt_pk_bf16_f32 v9, v10, v11
    v_mfma_f32_16x16x32_bf16 v[44:47], v[124:127], v[236:239], 0
    v_cvt_pk_bf16_f32 v10, v12, v13
    v_mfma_f32_16x16x32_bf16 v[60:63], v[140:143], v[236:239], 0
    v_cvt_pk_bf16_f32 v11, v14, v15
    buffer_store_dwordx4 v[8:11], v0, s[48:51], s38 offen offset:0 sc1
    v_mfma_f32_16x16x32_bf16 v[48:51], v[128:131], v[236:239], 0
    v_cvt_pk_bf16_f32 v24, -v24, -v25
    v_mfma_f32_16x16x32_bf16 v[64:67], v[144:147], v[236:239], 0
    v_cvt_pk_bf16_f32 v25, -v26, -v27
    v_mfma_f32_16x16x32_bf16 v[52:55], v[132:135], v[236:239], 0
    v_cvt_pk_bf16_f32 v26, -v28, -v29
    v_mfma_f32_16x16x32_bf16 v[68:71], v[148:151], v[236:239], 0
    v_cvt_pk_bf16_f32 v27, -v30, -v31
    buffer_store_dwordx4 v[24:27], v0, s[48:51], s39 offen offset:0 sc1
    v_mfma_f32_16x16x32_bf16 v[40:43], v[136:139], v[252:255], v[40:43]
    v_cvt_pk_bf16_f32 v16, v16, v17
    v_mfma_f32_16x16x32_bf16 v[56:59], v[120:123], v[244:247], v[56:59]
    v_cvt_pk_bf16_f32 v17, v18, v19
    v_mfma_f32_16x16x32_bf16 v[44:47], v[140:143], v[252:255], v[44:47]
    v_cvt_pk_bf16_f32 v18, v20, v21
    v_mfma_f32_16x16x32_bf16 v[60:63], v[124:127], v[244:247], v[60:63]
    v_cvt_pk_bf16_f32 v19, v22, v23
    buffer_store_dwordx4 v[16:19], v0, s[48:51], s38 offen offset:64 sc1
    v_mfma_f32_16x16x32_bf16 v[48:51], v[144:147], v[252:255], v[48:51]
    v_cvt_pk_bf16_f32 v32, -v32, -v33
    v_mfma_f32_16x16x32_bf16 v[64:67], v[128:131], v[244:247], v[64:67]
    v_cvt_pk_bf16_f32 v33, -v34, -v35
    v_mfma_f32_16x16x32_bf16 v[52:55], v[148:151], v[252:255], v[52:55]
    v_cvt_pk_bf16_f32 v34, -v36, -v37
    v_mfma_f32_16x16x32_bf16 v[68:71], v[132:135], v[244:247], v[68:71]
    v_cvt_pk_bf16_f32 v35, -v38, -v39
    buffer_store_dwordx4 v[32:35], v0, s[48:51], s39 offen offset:64 sc1
    v_cvt_pk_bf16_f32 v40, v40, v41
    v_cvt_pk_bf16_f32 v41, v42, v43
    v_cvt_pk_bf16_f32 v42, v44, v45
    v_cvt_pk_bf16_f32 v43, v46, v47
    buffer_store_dwordx4 v[40:43], v0, s[48:51], s38 offen offset:2048 sc1
    v_cvt_pk_bf16_f32 v56, -v56, -v57
    v_cvt_pk_bf16_f32 v57, -v58, -v59
    v_cvt_pk_bf16_f32 v58, -v60, -v61
    v_cvt_pk_bf16_f32 v59, -v62, -v63
    buffer_store_dwordx4 v[56:59], v0, s[48:51], s39 offen offset:2048 sc1
    v_cvt_pk_bf16_f32 v48, v48, v49
    v_cvt_pk_bf16_f32 v49, v50, v51
    v_cvt_pk_bf16_f32 v50, v52, v53
    v_cvt_pk_bf16_f32 v51, v54, v55
    buffer_store_dwordx4 v[48:51], v0, s[48:51], s38 offen offset:2112 sc1
    v_cvt_pk_bf16_f32 v64, -v64, -v65
    v_cvt_pk_bf16_f32 v65, -v66, -v67
    v_cvt_pk_bf16_f32 v66, -v68, -v69
    v_cvt_pk_bf16_f32 v67, -v70, -v71
    buffer_store_dwordx4 v[64:67], v0, s[48:51], s39 offen offset:2112 sc1
m_F_fleave:
    s_lshl_b32 s97, s35, 7
    s_add_u32 s97, s97, 241664
    s_cmp_eq_u32 s19, 0
    s_waitcnt vmcnt(0)
    s_barrier
    s_cbranch_scc0 m_F_nz
    s_add_u32 s44, s52, 0x310000
    s_addc_u32 s45, s53, 0
    s_mov_b32 s46, 0xa8000
    s_mov_b32 s47, 0x20000
    v_mov_b32 v5, s96
    s_mov_b64 exec, 1
    buffer_store_dword v5, off, s[44:47], s97 sc1
    s_mov_b64 exec, -1
m_F_nz:
    s_mov_b32 s97, 262016
    v_and_b32 v4, 0x30, v0
    v_lshl_add_u32 v4, v4, 8, v0
    buffer_load_dword v3, v4, s[12:15], s58 offen
    s_add_u32 s58, s58, 655360
    s_min_u32 s58, s58, 18857984
    v_mbcnt_lo_u32_b32 v1, -1, 0
    s_waitcnt vmcnt(0)
    v_mbcnt_hi_u32_b32 v0, -1, v1
    s_cmp_ge_u32 s19, 4
    s_cbranch_scc1 m_B
    s_barrier
    s_branch m_B
m_B:
    s_load_dwordx2 s[8:9], s[0:1], 48
    s_load_dwordx2 s[40:41], s[0:1], 88
    s_load_dwordx2 s[44:45], s[0:1], 56
    s_load_dwordx2 s[56:57], s[0:1], 72
    s_bfe_u32 s33, s2, 0x20001
    s_and_b32 s34, s2, 1
    s_lshl_b32 s34, s34, 3
    s_lshr_b32 s35, s2, 5
    s_add_u32 s34, s34, s35
    s_bfe_u32 s35, s2, 0x20003
    s_mov_b32 s36, 0
    s_mov_b32 s18, 36
    s_cmp_eq_u32 s33, 1
    s_cselect_b32 s36, 36, s36
    s_cselect_b32 s18, 36, s18
    s_cmp_eq_u32 s33, 2
    s_cselect_b32 s36, 72, s36
    s_cselect_b32 s18, 36, s18
    s_cmp_eq_u32 s33, 3
    s_cselect_b32 s36, 108, s36
    s_cselect_b32 s18, 36, s18
    s_cselect_b32 s26, 36, 1000
    s_lshl_b32 s32, s34, 8
    s_lshl_b32 s16, s36, 17
    s_add_u32 s16, s16, s32
    s_mul_i32 s17, s36, 36
    s_mul_i32 s37, s35, 9
    s_add_u32 s17, s17, s37
    s_lshl_b32 s17, s17, 10
    s_mul_i32 s3, s33, 5
    s_sub_u32 s3, s3, 2
    s_lshl_b32 s53, s33, 2
    s_max_i32 s3, s3, s53
    s_lshl_b32 s53, s3, 1
    s_lshl_b32 s26, s3, 17
    s_add_u32 s32, s32, s26
    s_mul_i32 s3, s3, 36
    s_add_u32 s3, s3, s37
    s_add_u32 s3, s3, 5184
    s_lshl_b32 s26, s3, 10
    s_and_b32 s3, s35, 1
    s_cmp_lt_u32 s19, 4
    s_cbranch_scc1 m_B_comp
    v_and_b32 v3, 63, v0
    s_sub_u32 s22, s19, 4
    s_mul_i32 s23, s22, 32768
    s_mov_b32 s24, 4096
    v_lshrrev_b32 v4, 4, v3
    v_add_u32 v4, 0, v4
    v_bfe_u32 v5, v3, 1, 3
    v_xor_b32 v5, v5, v4
    v_mul_lo_u32 v4, v4, s24
    v_lshl_add_u32 v4, v5, 5, v4
    v_and_b32 v5, 1, v3
    v_lshl_add_u32 v4, v5, 4, v4
    v_add_u32 v6, s23, v4
    v_lshrrev_b32 v4, 4, v3
    v_add_u32 v4, 4, v4
    v_bfe_u32 v5, v3, 1, 3
    v_xor_b32 v5, v5, v4
    v_mul_lo_u32 v4, v4, s24
    v_lshl_add_u32 v4, v5, 5, v4
    v_and_b32 v5, 1, v3
    v_lshl_add_u32 v4, v5, 4, v4
    v_add_u32 v7, s23, v4
    v_subrev_u32 v7, 1024, v7
    v_lshlrev_b32 v8, 4, v3
    s_cmp_eq_u32 s22, 1
    s_cbranch_scc1 m_B_ld1
    s_cmp_eq_u32 s22, 2
    s_cbranch_scc1 m_B_ld2
    s_cmp_eq_u32 s22, 3
    s_cbranch_scc1 m_B_ld3
m_B_ld0:
    s_add_u32 s20, s17, 36864
    s_add_u32 s23, s33, 0
    s_and_b32 s23, s23, 3
    s_lshl1_add_u32 s23, s23, s3
    s_add_u32 s23, s23, 2
    s_lshl_b32 s23, s23, 10
    v_add_u32 v9, s23, v8
    s_add_u32 s23, s33, 0
    s_and_b32 s23, s23, 3
    s_lshl1_add_u32 s23, s23, s3
    s_add_u32 s23, s23, 2
    s_lshl_b32 s23, s23, 10
    v_add_u32 v10, s23, v8
    s_add_u32 s23, s33, 1
    s_and_b32 s23, s23, 3
    s_lshl1_add_u32 s23, s23, s3
    s_add_u32 s23, s23, 0
    s_lshl_b32 s23, s23, 10
    v_add_u32 v11, s23, v8
    s_lshr_b32 s38, s2, 3
    s_lshl_b32 s38, s38, 1
    s_and_b32 s39, s2, 1
    s_add_u32 s38, s38, s39
    s_lshl_b32 s38, s38, 11
    s_add_u32 s38, s38, 0
    s_add_u32 s39, s36, s18
    s_min_u32 s39, s39, 144
    s_sub_u32 s39, s39, 1
    s_lshl_b32 s39, s39, 17
    s_add_u32 s39, s39, s38
    s_add_u32 s42, s36, 19
    s_lshl_b32 s42, s42, 17
    s_add_u32 s38, s38, s42
    s_min_u32 s38, s38, s39
    s_mov_b32 m0, 0
    v_mov_b32 v1, 163824
    v_mov_b32 v2, 0
    s_waitcnt lgkmcnt(0)
    s_mov_b32 s10, 0x1200000
    s_mov_b32 s11, 0x20000
    s_add_u32 s12, s40, 0x7ff800
    s_addc_u32 s13, s41, 0
    s_mov_b32 s14, 0x5b2800
    s_mov_b32 s15, 0x20000
    s_add_u32 s28, s40, 0xe00000
    s_addc_u32 s29, s41, 0
    s_mov_b32 s30, 0x240000
    s_mov_b32 s31, 0x20000
    s_barrier
    ds_write_b32 v1, v2
    s_cmp_lt_u32 s2, 216
    s_cbranch_scc1 m_B_zs0
    s_mov_b32 m0, 77824
    s_nop 0
    buffer_load_dwordx4 v9, s[12:15], s26 offen offset:0 lds
    buffer_load_dwordx4 v10, s[12:15], s26 offen offset:1024 lds
    buffer_load_dwordx4 v11, s[12:15], s26 offen offset:2048 lds
    s_add_u32 s26, s26, 36864
    s_mov_b32 m0, 95232
    s_nop 0
    buffer_load_dwordx4 v9, s[12:15], s26 offen offset:0 lds
    buffer_load_dwordx4 v10, s[12:15], s26 offen offset:1024 lds
    s_add_u32 s26, s26, 36864
    s_mov_b32 m0, 112640
    s_nop 0
    buffer_load_dwordx4 v9, s[12:15], s26 offen offset:0 lds
    buffer_load_dwordx4 v10, s[12:15], s26 offen offset:1024 lds
    buffer_load_dwordx4 v11, s[12:15], s26 offen offset:2048 lds
    s_add_u32 s26, s26, 36864
    s_mov_b32 m0, 130048
    s_nop 0
    buffer_load_dwordx4 v9, s[12:15], s26 offen offset:0 lds
    buffer_load_dwordx4 v10, s[12:15], s26 offen offset:1024 lds
    s_add_u32 s26, s26, 36864
    s_cmp_lt_u32 s33, 2
    s_cbranch_scc1 m_B_zs0
    s_mov_b32 m0, 147456
    s_nop 0
    buffer_load_dwordx4 v9, s[12:15], s26 offen offset:0 lds
    buffer_load_dwordx4 v10, s[12:15], s26 offen offset:1024 lds
    buffer_load_dwordx4 v11, s[12:15], s26 offen offset:2048 lds
    s_add_u32 s26, s26, 36864
m_B_zs0:
    s_mov_b32 m0, 0
    s_nop 0
    buffer_load_dwordx4 v6, s[8:11], s16 offen lds
    buffer_load_dwordx4 v7, s[8:11], s16 offen offset:1024 lds
    s_add_u32 s16, s16, 131072
    s_mov_b32 m0, 17408
    s_nop 0
    buffer_load_dwordx4 v6, s[8:11], s16 offen lds
    buffer_load_dwordx4 v7, s[8:11], s16 offen offset:1024 lds
    s_add_u32 s16, s16, 131072
    s_mov_b32 m0, 34816
    s_nop 0
    buffer_load_dwordx4 v6, s[8:11], s16 offen lds
    buffer_load_dwordx4 v7, s[8:11], s16 offen offset:1024 lds
    s_add_u32 s16, s16, 131072
    s_mov_b32 m0, 52224
    s_nop 0
    buffer_load_dwordx4 v6, s[8:11], s16 offen lds
    buffer_load_dwordx4 v7, s[8:11], s16 offen offset:1024 lds
    s_add_u32 s16, s16, 131072
    s_mov_b32 m0, 8192
    s_waitcnt lgkmcnt(0)
    s_barrier
    s_mov_b32 m0, 69632
    s_nop 0
    buffer_load_dwordx4 v6, s[28:31], s32 offen lds
    buffer_load_dwordx4 v7, s[28:31], s32 offen offset:1024 lds
    s_add_u32 s32, s32, 131072
    s_mov_b32 m0, 87040
    s_nop 0
    buffer_load_dwordx4 v6, s[28:31], s32 offen lds
    buffer_load_dwordx4 v7, s[28:31], s32 offen offset:1024 lds
    s_add_u32 s32, s32, 131072
    s_mov_b32 m0, 104448
    s_nop 0
    buffer_load_dwordx4 v6, s[28:31], s32 offen lds
    buffer_load_dwordx4 v7, s[28:31], s32 offen offset:1024 lds
    s_add_u32 s32, s32, 131072
    s_mov_b32 m0, 121856
    s_nop 0
    buffer_load_dwordx4 v6, s[28:31], s32 offen lds
    buffer_load_dwordx4 v7, s[28:31], s32 offen offset:1024 lds
    s_add_u32 s32, s32, 131072
    s_cmp_lt_u32 s33, 2
    s_cbranch_scc1 m_B_zt0
    s_mov_b32 m0, 139264
    s_nop 0
    buffer_load_dwordx4 v6, s[28:31], s32 offen lds
    buffer_load_dwordx4 v7, s[28:31], s32 offen offset:1024 lds
    s_add_u32 s32, s32, 131072
m_B_zt0:
    s_mov_b32 m0, 8192
    s_mov_b32 s44, s8
    s_mov_b32 s45, s9
    s_mov_b32 s46, 0x1200000
    s_mov_b32 s47, 0x20000
    s_buffer_load_dwordx2 s[42:43], s[44:47], s38 offset:60
    s_buffer_load_dwordx2 s[42:43], s[44:47], s38 offset:188
    s_buffer_load_dwordx2 s[42:43], s[44:47], s38 offset:316
    s_buffer_load_dwordx2 s[42:43], s[44:47], s38 offset:444
    s_add_u32 s38, s38, 0x20000
    s_min_u32 s38, s38, s39
    s_add_u32 s48, s40, 0x310000
    s_addc_u32 s49, s41, 0
    s_mov_b32 s50, 0xa8000
    s_mov_b32 s51, 0x20000
    v_mul_u32_u24 v4, 21846, v3
    v_lshrrev_b32 v4, 16, v4
    v_mad_u32_u24 v4, v4, 9, v3
    v_lshlrev_b32 v4, 7, v4
    s_lshr_b32 s52, s36, 1
    s_add_u32 s53, s36, s18
    s_min_u32 s53, s53, 144
    s_add_u32 s53, s53, 1
    s_lshr_b32 s53, s53, 1
    s_sub_u32 s53, s53, s52
    s_mul_i32 s53, s53, 3
    s_lshl2_add_u32 s52, s52, s35
    s_mul_i32 s52, s52, 384
    s_add_u32 s52, s52, 131072
    s_bfm_b64 exec, s53, 0
    v_mov_b32 v5, 0
    buffer_atomic_or v5, v4, s[48:51], s52 offen sc0 sc1
    s_waitcnt vmcnt(1)
    s_barrier
    s_waitcnt vmcnt(0)
    v_cmp_ne_u32 vcc, s96, v5
    s_nop 0
    s_and_b64 exec, exec, vcc
    s_cbranch_scc0 m_B_pu_x
    s_mov_b32 s98, 0x80000
m_B_pu:
    v_mov_b32 v5, 0
    buffer_atomic_or v5, v4, s[48:51], s52 offen sc0 sc1
    s_sub_u32 s98, s98, 1
    s_cbranch_scc1 m_B_pu_x
    s_waitcnt vmcnt(0)
    v_cmp_ne_u32 vcc, s96, v5
    s_nop 0
    s_and_b64 exec, exec, vcc
    s_cbranch_scc1 m_B_pu
m_B_pu_x:
    s_mov_b64 exec, -1
    v_mov_b32 v2, 2
    ds_write_b32 v1, v2
    buffer_load_dwordx4 v9, s[12:15], s17 offen offset:0 lds
    buffer_load_dwordx4 v10, s[12:15], s17 offen offset:1024 lds
    buffer_load_dwordx4 v11, s[12:15], s17 offen offset:2048 lds
    s_mov_b32 m0, 25600
    s_add_u32 s17, s17, 73728
    buffer_load_dwordx4 v9, s[12:15], s20 offen offset:0 lds
    buffer_load_dwordx4 v10, s[12:15], s20 offen offset:1024 lds
    s_mov_b32 m0, 43008
    s_add_u32 s20, s20, 73728
    buffer_load_dwordx4 v9, s[12:15], s17 offen offset:0 lds
    buffer_load_dwordx4 v10, s[12:15], s17 offen offset:1024 lds
    buffer_load_dwordx4 v11, s[12:15], s17 offen offset:2048 lds
    s_mov_b32 m0, 60416
    s_add_u32 s17, s17, 73728
    buffer_load_dwordx4 v9, s[12:15], s20 offen offset:0 lds
    buffer_load_dwordx4 v10, s[12:15], s20 offen offset:1024 lds
    s_mov_b32 m0, 69632
    s_mov_b32 s44, s8
    s_mov_b32 s45, s9
    s_mov_b32 s46, 0x1200000
    s_mov_b32 s47, 0x20000
    s_buffer_load_dwordx2 s[42:43], s[44:47], s38 offset:60
    s_buffer_load_dwordx2 s[42:43], s[44:47], s38 offset:188
    s_buffer_load_dwordx2 s[42:43], s[44:47], s38 offset:316
    s_buffer_load_dwordx2 s[42:43], s[44:47], s38 offset:444
    s_add_u32 s38, s38, 0x20000
    s_min_u32 s38, s38, s39
    s_waitcnt vmcnt(5)
    s_barrier
    buffer_load_dwordx4 v6, s[8:11], s16 offen lds
    buffer_load_dwordx4 v7, s[8:11], s16 offen offset:1024 lds
    s_mov_b32 m0, 77824
    s_add_u32 s16, s16, 131072
    s_add_u32 s20, s20, 73728
    buffer_load_dwordx4 v9, s[12:15], s17 offen offset:0 lds
    buffer_load_dwordx4 v10, s[12:15], s17 offen offset:1024 lds
    buffer_load_dwordx4 v11, s[12:15], s17 offen offset:2048 lds
    s_mov_b32 m0, 87040
    s_nop 0
    buffer_load_dwordx4 v6, s[8:11], s16 offen lds
    buffer_load_dwordx4 v7, s[8:11], s16 offen offset:1024 lds
    s_mov_b32 m0, 95232
    s_add_u32 s16, s16, 131072
    s_add_u32 s17, s17, 73728
    buffer_load_dwordx4 v9, s[12:15], s20 offen offset:0 lds
    buffer_load_dwordx4 v10, s[12:15], s20 offen offset:1024 lds
    s_mov_b32 m0, 104448
    s_buffer_load_dwordx2 s[42:43], s[44:47], s38 offset:60
    s_buffer_load_dwordx2 s[42:43], s[44:47], s38 offset:188
    s_waitcnt vmcnt(11)
    s_barrier
    buffer_load_dwordx4 v6, s[8:11], s16 offen lds
    buffer_load_dwordx4 v7, s[8:11], s16 offen offset:1024 lds
    s_mov_b32 m0, 112640
    s_add_u32 s16, s16, 131072
    s_add_u32 s20, s20, 73728
    buffer_load_dwordx4 v9, s[12:15], s17 offen offset:0 lds
    buffer_load_dwordx4 v10, s[12:15], s17 offen offset:1024 lds
    buffer_load_dwordx4 v11, s[12:15], s17 offen offset:2048 lds
    s_mov_b32 m0, 121856
    s_nop 0
    buffer_load_dwordx4 v6, s[8:11], s16 offen lds
    buffer_load_dwordx4 v7, s[8:11], s16 offen offset:1024 lds
    s_mov_b32 m0, 130048
    s_add_u32 s16, s16, 131072
    s_add_u32 s17, s17, 73728
    buffer_load_dwordx4 v9, s[12:15], s20 offen offset:0 lds
    buffer_load_dwordx4 v10, s[12:15], s20 offen offset:1024 lds
    s_mov_b32 m0, 0
    s_buffer_load_dwordx2 s[42:43], s[44:47], s38 offset:316
    s_buffer_load_dwordx2 s[42:43], s[44:47], s38 offset:444
    s_add_u32 s38, s38, 0x20000
    s_min_u32 s38, s38, s39
    s_waitcnt vmcnt(18)
    s_barrier
    buffer_load_dwordx4 v6, s[8:11], s16 offen lds
    buffer_load_dwordx4 v7, s[8:11], s16 offen offset:1024 lds
    s_mov_b32 m0, 8192
    s_add_u32 s16, s16, 131072
    s_add_u32 s20, s20, 73728
    buffer_load_dwordx4 v9, s[12:15], s17 offen offset:0 lds
    buffer_load_dwordx4 v10, s[12:15], s17 offen offset:1024 lds
    buffer_load_dwordx4 v11, s[12:15], s17 offen offset:2048 lds
    s_mov_b32 m0, 17408
    s_nop 0
    buffer_load_dwordx4 v6, s[8:11], s16 offen lds
    buffer_load_dwordx4 v7, s[8:11], s16 offen offset:1024 lds
    s_mov_b32 m0, 25600
    s_add_u32 s16, s16, 131072
    s_add_u32 s17, s17, 73728
    buffer_load_dwordx4 v9, s[12:15], s20 offen offset:0 lds
    buffer_load_dwordx4 v10, s[12:15], s20 offen offset:1024 lds
    s_mov_b32 m0, 34816
    s_buffer_load_dwordx2 s[42:43], s[44:47], s38 offset:60
    s_buffer_load_dwordx2 s[42:43], s[44:47], s38 offset:188
    s_mov_b32 s21, 3
m_B_main_53:
    s_waitcnt vmcnt(22)
    s_barrier
    buffer_load_dwordx4 v6, s[8:11], s16 offen lds
    buffer_load_dwordx4 v7, s[8:11], s16 offen offset:1024 lds
    s_mov_b32 m0, 43008
    s_add_u32 s16, s16, 131072
    s_add_u32 s20, s20, 73728
    buffer_load_dwordx4 v9, s[12:15], s17 offen offset:0 lds
    buffer_load_dwordx4 v10, s[12:15], s17 offen offset:1024 lds
    buffer_load_dwordx4 v11, s[12:15], s17 offen offset:2048 lds
    s_mov_b32 m0, 52224
    s_buffer_load_dwordx2 s[42:43], s[44:47], s38 offset:316
    s_buffer_load_dwordx2 s[42:43], s[44:47], s38 offset:444
    s_add_u32 s38, s38, 0x20000
    s_min_u32 s38, s38, s39
    s_waitcnt vmcnt(23)
    s_barrier
    buffer_load_dwordx4 v6, s[8:11], s16 offen lds
    buffer_load_dwordx4 v7, s[8:11], s16 offen offset:1024 lds
    s_mov_b32 m0, 60416
    s_add_u32 s16, s16, 131072
    s_add_u32 s17, s17, 73728
    buffer_load_dwordx4 v9, s[12:15], s20 offen offset:0 lds
    buffer_load_dwordx4 v10, s[12:15], s20 offen offset:1024 lds
    s_mov_b32 m0, 69632
    s_buffer_load_dwordx2 s[42:43], s[44:47], s38 offset:60
    s_buffer_load_dwordx2 s[42:43], s[44:47], s38 offset:188
    s_waitcnt vmcnt(22)
    s_barrier
    buffer_load_dwordx4 v6, s[8:11], s16 offen lds
    buffer_load_dwordx4 v7, s[8:11], s16 offen offset:1024 lds
    s_mov_b32 m0, 77824
    s_add_u32 s16, s16, 131072
    s_add_u32 s20, s20, 73728
    buffer_load_dwordx4 v9, s[12:15], s17 offen offset:0 lds
    buffer_load_dwordx4 v10, s[12:15], s17 offen offset:1024 lds
    buffer_load_dwordx4 v11, s[12:15], s17 offen offset:2048 lds
    s_mov_b32 m0, 87040
    s_buffer_load_dwordx2 s[42:43], s[44:47], s38 offset:316
    s_buffer_load_dwordx2 s[42:43], s[44:47], s38 offset:444
    s_add_u32 s38, s38, 0x20000
    s_min_u32 s38, s38, s39
    s_waitcnt vmcnt(23)
    s_barrier
    buffer_load_dwordx4 v6, s[8:11], s16 offen lds
    buffer_load_dwordx4 v7, s[8:11], s16 offen offset:1024 lds
    s_mov_b32 m0, 95232
    s_add_u32 s16, s16, 131072
    s_add_u32 s17, s17, 73728
    buffer_load_dwordx4 v9, s[12:15], s20 offen offset:0 lds
    buffer_load_dwordx4 v10, s[12:15], s20 offen offset:1024 lds
    s_mov_b32 m0, 104448
    s_buffer_load_dwordx2 s[42:43], s[44:47], s38 offset:60
    s_buffer_load_dwordx2 s[42:43], s[44:47], s38 offset:188
    s_waitcnt vmcnt(22)
    s_barrier
    buffer_load_dwordx4 v6, s[8:11], s16 offen lds
    buffer_load_dwordx4 v7, s[8:11], s16 offen offset:1024 lds
    s_mov_b32 m0, 112640
    s_add_u32 s16, s16, 131072
    s_add_u32 s20, s20, 73728
    buffer_load_dwordx4 v9, s[12:15], s17 offen offset:0 lds
    buffer_load_dwordx4 v10, s[12:15], s17 offen offset:1024 lds
    buffer_load_dwordx4 v11, s[12:15], s17 offen offset:2048 lds
    s_mov_b32 m0, 121856
    s_buffer_load_dwordx2 s[42:43], s[44:47], s38 offset:316
    s_buffer_load_dwordx2 s[42:43], s[44:47], s38 offset:444
    s_add_u32 s38, s38, 0x20000
    s_min_u32 s38, s38, s39
    s_waitcnt vmcnt(23)
    s_barrier
    buffer_load_dwordx4 v6, s[8:11], s16 offen lds
    buffer_load_dwordx4 v7, s[8:11], s16 offen offset:1024 lds
    s_mov_b32 m0, 130048
    s_add_u32 s16, s16, 131072
    s_add_u32 s17, s17, 73728
    buffer_load_dwordx4 v9, s[12:15], s20 offen offset:0 lds
    buffer_load_dwordx4 v10, s[12:15], s20 offen offset:1024 lds
    s_mov_b32 m0, 0
    s_buffer_load_dwordx2 s[42:43], s[44:47], s38 offset:60
    s_buffer_load_dwordx2 s[42:43], s[44:47], s38 offset:188
    s_waitcnt vmcnt(22)
    s_barrier
    buffer_load_dwordx4 v6, s[8:11], s16 offen lds
    buffer_load_dwordx4 v7, s[8:11], s16 offen offset:1024 lds
    s_mov_b32 m0, 8192
    s_add_u32 s16, s16, 131072
    s_add_u32 s20, s20, 73728
    buffer_load_dwordx4 v9, s[12:15], s17 offen offset:0 lds
    buffer_load_dwordx4 v10, s[12:15], s17 offen offset:1024 lds
    buffer_load_dwordx4 v11, s[12:15], s17 offen offset:2048 lds
    s_mov_b32 m0, 17408
    s_buffer_load_dwordx2 s[42:43], s[44:47], s38 offset:316
    s_buffer_load_dwordx2 s[42:43], s[44:47], s38 offset:444
    s_add_u32 s38, s38, 0x20000
    s_min_u32 s38, s38, s39
    s_waitcnt vmcnt(23)
    s_barrier
    buffer_load_dwordx4 v6, s[8:11], s16 offen lds
    buffer_load_dwordx4 v7, s[8:11], s16 offen offset:1024 lds
    s_mov_b32 m0, 25600
    s_add_u32 s16, s16, 131072
    s_add_u32 s17, s17, 73728
    buffer_load_dwordx4 v9, s[12:15], s20 offen offset:0 lds
    buffer_load_dwordx4 v10, s[12:15], s20 offen offset:1024 lds
    s_mov_b32 m0, 34816
    s_buffer_load_dwordx2 s[42:43], s[44:47], s38 offset:60
    s_buffer_load_dwordx2 s[42:43], s[44:47], s38 offset:188
    s_sub_u32 s21, s21, 1
    s_cmp_lg_u32 s21, 0
    s_cbranch_scc1 m_B_main_53
    s_waitcnt vmcnt(22)
    s_barrier
    buffer_load_dwordx4 v6, s[8:11], s16 offen lds
    buffer_load_dwordx4 v7, s[8:11], s16 offen offset:1024 lds
    s_mov_b32 m0, 43008
    s_add_u32 s16, s16, 131072
    s_add_u32 s20, s20, 73728
    buffer_load_dwordx4 v9, s[12:15], s17 offen offset:0 lds
    buffer_load_dwordx4 v10, s[12:15], s17 offen offset:1024 lds
    buffer_load_dwordx4 v11, s[12:15], s17 offen offset:2048 lds
    s_mov_b32 m0, 52224
m_B_lt_55:
    s_waitcnt vmcnt(23)
    s_barrier
    buffer_load_dwordx4 v6, s[8:11], s16 offen lds
    buffer_load_dwordx4 v7, s[8:11], s16 offen offset:1024 lds
    s_mov_b32 m0, 60416
    s_add_u32 s16, s16, 131072
    s_add_u32 s17, s17, 73728
    buffer_load_dwordx4 v9, s[12:15], s20 offen offset:0 lds
    buffer_load_dwordx4 v10, s[12:15], s20 offen offset:1024 lds
    s_mov_b32 m0, 69632
    s_waitcnt vmcnt(22)
    s_barrier
    s_waitcnt vmcnt(18)
    s_barrier
    s_waitcnt vmcnt(13)
    s_barrier
    s_waitcnt vmcnt(9)
    s_barrier
    s_waitcnt vmcnt(4)
    s_barrier
    s_waitcnt vmcnt(0)
    s_barrier
    s_waitcnt vmcnt(0)
    s_barrier
m_B_le_54:
    s_waitcnt lgkmcnt(0)
    s_endpgm
m_B_ld1:
    s_add_u32 s20, s17, 36864
    s_add_u32 s23, s33, 1
    s_and_b32 s23, s23, 3
    s_lshl1_add_u32 s23, s23, s3
    s_add_u32 s23, s23, 3
    s_lshl_b32 s23, s23, 10
    v_add_u32 v9, s23, v8
    s_add_u32 s23, s33, 2
    s_and_b32 s23, s23, 3
    s_lshl1_add_u32 s23, s23, s3
    s_add_u32 s23, s23, 1
    s_lshl_b32 s23, s23, 10
    v_add_u32 v10, s23, v8
    s_add_u32 s23, s33, 1
    s_and_b32 s23, s23, 3
    s_lshl1_add_u32 s23, s23, s3
    s_add_u32 s23, s23, 2
    s_lshl_b32 s23, s23, 10
    v_add_u32 v11, s23, v8
    s_add_u32 s23, s33, 1
    s_and_b32 s23, s23, 3
    s_lshl1_add_u32 s23, s23, s3
    s_add_u32 s23, s23, 2
    s_lshl_b32 s23, s23, 10
    v_add_u32 v12, s23, v8
    s_lshr_b32 s38, s2, 3
    s_lshl_b32 s38, s38, 1
    s_and_b32 s39, s2, 1
    s_add_u32 s38, s38, s39
    s_lshl_b32 s38, s38, 11
    s_add_u32 s38, s38, 512
    s_add_u32 s39, s36, s18
    s_min_u32 s39, s39, 144
    s_sub_u32 s39, s39, 1
    s_lshl_b32 s39, s39, 17
    s_add_u32 s39, s39, s38
    s_add_u32 s42, s36, 19
    s_lshl_b32 s42, s42, 17
    s_add_u32 s38, s38, s42
    s_min_u32 s38, s38, s39
    s_mov_b32 m0, 2048
    v_mov_b32 v1, 163824
    s_waitcnt lgkmcnt(0)
    s_mov_b32 s10, 0x1200000
    s_mov_b32 s11, 0x20000
    s_add_u32 s12, s40, 0x7ff800
    s_addc_u32 s13, s41, 0
    s_mov_b32 s14, 0x5b2800
    s_mov_b32 s15, 0x20000
    s_add_u32 s28, s40, 0xe00000
    s_addc_u32 s29, s41, 0
    s_mov_b32 s30, 0x240000
    s_mov_b32 s31, 0x20000
    s_barrier
    s_cmp_lt_u32 s2, 216
    s_cbranch_scc1 m_B_zs1
    s_mov_b32 m0, 80896
    s_nop 0
    buffer_load_dwordx4 v9, s[12:15], s26 offen offset:0 lds
    buffer_load_dwordx4 v10, s[12:15], s26 offen offset:1024 lds
    s_add_u32 s26, s26, 36864
    s_mov_b32 m0, 97280
    s_nop 0
    buffer_load_dwordx4 v11, s[12:15], s26 offen offset:0 lds
    buffer_load_dwordx4 v12, s[12:15], s26 offen offset:1024 lds
    s_add_u32 s26, s26, 36864
    s_mov_b32 m0, 115712
    s_nop 0
    buffer_load_dwordx4 v9, s[12:15], s26 offen offset:0 lds
    buffer_load_dwordx4 v10, s[12:15], s26 offen offset:1024 lds
    s_add_u32 s26, s26, 36864
    s_mov_b32 m0, 132096
    s_nop 0
    buffer_load_dwordx4 v11, s[12:15], s26 offen offset:0 lds
    buffer_load_dwordx4 v12, s[12:15], s26 offen offset:1024 lds
    s_add_u32 s26, s26, 36864
    s_cmp_lt_u32 s33, 2
    s_cbranch_scc1 m_B_zs1
    s_mov_b32 m0, 150528
    s_nop 0
    buffer_load_dwordx4 v9, s[12:15], s26 offen offset:0 lds
    buffer_load_dwordx4 v10, s[12:15], s26 offen offset:1024 lds
    s_add_u32 s26, s26, 36864
m_B_zs1:
    s_mov_b32 m0, 2048
    s_nop 0
    buffer_load_dwordx4 v6, s[8:11], s16 offen lds
    buffer_load_dwordx4 v7, s[8:11], s16 offen offset:1024 lds
    s_add_u32 s16, s16, 131072
    s_mov_b32 m0, 19456
    s_nop 0
    buffer_load_dwordx4 v6, s[8:11], s16 offen lds
    buffer_load_dwordx4 v7, s[8:11], s16 offen offset:1024 lds
    s_add_u32 s16, s16, 131072
    s_mov_b32 m0, 36864
    s_nop 0
    buffer_load_dwordx4 v6, s[8:11], s16 offen lds
    buffer_load_dwordx4 v7, s[8:11], s16 offen offset:1024 lds
    s_add_u32 s16, s16, 131072
    s_mov_b32 m0, 54272
    s_nop 0
    buffer_load_dwordx4 v6, s[8:11], s16 offen lds
    buffer_load_dwordx4 v7, s[8:11], s16 offen offset:1024 lds
    s_add_u32 s16, s16, 131072
    s_mov_b32 m0, 11264
    s_add_u32 s48, s40, 0x310000
    s_addc_u32 s49, s41, 0
    s_mov_b32 s50, 0xa8000
    s_mov_b32 s51, 0x20000
    v_and_b32 v126, 63, v0
    v_lshlrev_b32 v126, 7, v126
    s_cmp_lt_u32 s33, 2
    s_cselect_b32 s52, 8, 10
    s_bfm_b64 exec, s52, s53
    s_cmp_eq_u32 s33, 0
    s_cselect_b32 exec_hi, 16, exec_hi
    s_mov_b32 s52, 241664
    s_mov_b32 s98, 0x80000
m_B_pz:
    v_mov_b32 v2, 0
    buffer_atomic_or v2, v126, s[48:51], s52 offen sc0 sc1
    s_sub_u32 s98, s98, 1
    s_cbranch_scc1 m_B_pz_x
    s_waitcnt vmcnt(0)
    v_cmp_ne_u32 vcc, s96, v2
    s_nop 0
    s_and_b64 exec, exec, vcc
    s_cbranch_scc1 m_B_pz
m_B_pz_x:
    s_mov_b64 exec, -1
    s_waitcnt lgkmcnt(0)
    s_barrier
    s_mov_b32 m0, 71680
    s_nop 0
    buffer_load_dwordx4 v6, s[28:31], s32 offen lds
    buffer_load_dwordx4 v7, s[28:31], s32 offen offset:1024 lds
    s_add_u32 s32, s32, 131072
    s_mov_b32 m0, 89088
    s_nop 0
    buffer_load_dwordx4 v6, s[28:31], s32 offen lds
    buffer_load_dwordx4 v7, s[28:31], s32 offen offset:1024 lds
    s_add_u32 s32, s32, 131072
    s_mov_b32 m0, 106496
    s_nop 0
    buffer_load_dwordx4 v6, s[28:31], s32 offen lds
    buffer_load_dwordx4 v7, s[28:31], s32 offen offset:1024 lds
    s_add_u32 s32, s32, 131072
    s_mov_b32 m0, 123904
    s_nop 0
    buffer_load_dwordx4 v6, s[28:31], s32 offen lds
    buffer_load_dwordx4 v7, s[28:31], s32 offen offset:1024 lds
    s_add_u32 s32, s32, 131072
    s_cmp_lt_u32 s33, 2
    s_cbranch_scc1 m_B_zt1
    s_mov_b32 m0, 141312
    s_nop 0
    buffer_load_dwordx4 v6, s[28:31], s32 offen lds
    buffer_load_dwordx4 v7, s[28:31], s32 offen offset:1024 lds
    s_add_u32 s32, s32, 131072
m_B_zt1:
    s_mov_b32 m0, 11264
    s_mov_b32 s44, s8
    s_mov_b32 s45, s9
    s_mov_b32 s46, 0x1200000
    s_mov_b32 s47, 0x20000
    s_buffer_load_dwordx2 s[42:43], s[44:47], s38 offset:60
    s_buffer_load_dwordx2 s[42:43], s[44:47], s38 offset:188
    s_buffer_load_dwordx2 s[42:43], s[44:47], s38 offset:316
    s_buffer_load_dwordx2 s[42:43], s[44:47], s38 offset:444
    s_add_u32 s38, s38, 0x20000
    s_min_u32 s38, s38, s39
    s_waitcnt vmcnt(0)
    s_barrier
    s_mov_b32 s98, 0x800000
m_B_sp1:
    ds_read_b32 v2, v1 offset:0
    s_sub_u32 s98, s98, 1
    s_cbranch_scc1 m_B_sp1_x
    s_waitcnt lgkmcnt(0)
    v_cmp_ne_u32 vcc, 2, v2
    s_cbranch_vccnz m_B_sp1
m_B_sp1_x:
    buffer_load_dwordx4 v9, s[12:15], s17 offen offset:0 lds
    buffer_load_dwordx4 v10, s[12:15], s17 offen offset:1024 lds
    s_mov_b32 m0, 27648
    s_add_u32 s17, s17, 73728
    buffer_load_dwordx4 v11, s[12:15], s20 offen offset:0 lds
    buffer_load_dwordx4 v12, s[12:15], s20 offen offset:1024 lds
    s_mov_b32 m0, 46080
    s_add_u32 s20, s20, 73728
    buffer_load_dwordx4 v9, s[12:15], s17 offen offset:0 lds
    buffer_load_dwordx4 v10, s[12:15], s17 offen offset:1024 lds
    s_mov_b32 m0, 62464
    s_add_u32 s17, s17, 73728
    buffer_load_dwordx4 v11, s[12:15], s20 offen offset:0 lds
    buffer_load_dwordx4 v12, s[12:15], s20 offen offset:1024 lds
    s_mov_b32 m0, 71680
    s_mov_b32 s44, s8
    s_mov_b32 s45, s9
    s_mov_b32 s46, 0x1200000
    s_mov_b32 s47, 0x20000
    s_buffer_load_dwordx2 s[42:43], s[44:47], s38 offset:60
    s_buffer_load_dwordx2 s[42:43], s[44:47], s38 offset:188
    s_buffer_load_dwordx2 s[42:43], s[44:47], s38 offset:316
    s_buffer_load_dwordx2 s[42:43], s[44:47], s38 offset:444
    s_add_u32 s38, s38, 0x20000
    s_min_u32 s38, s38, s39
    s_waitcnt vmcnt(4)
    s_barrier
    buffer_load_dwordx4 v6, s[8:11], s16 offen lds
    buffer_load_dwordx4 v7, s[8:11], s16 offen offset:1024 lds
    s_mov_b32 m0, 80896
    s_add_u32 s16, s16, 131072
    s_add_u32 s20, s20, 73728
    buffer_load_dwordx4 v9, s[12:15], s17 offen offset:0 lds
    buffer_load_dwordx4 v10, s[12:15], s17 offen offset:1024 lds
    s_mov_b32 m0, 89088
    s_nop 0
    buffer_load_dwordx4 v6, s[8:11], s16 offen lds
    buffer_load_dwordx4 v7, s[8:11], s16 offen offset:1024 lds
    s_mov_b32 m0, 97280
    s_add_u32 s16, s16, 131072
    s_add_u32 s17, s17, 73728
    buffer_load_dwordx4 v11, s[12:15], s20 offen offset:0 lds
    buffer_load_dwordx4 v12, s[12:15], s20 offen offset:1024 lds
    s_mov_b32 m0, 106496
    s_buffer_load_dwordx2 s[42:43], s[44:47], s38 offset:60
    s_buffer_load_dwordx2 s[42:43], s[44:47], s38 offset:188
    s_waitcnt vmcnt(10)
    s_barrier
    buffer_load_dwordx4 v6, s[8:11], s16 offen lds
    buffer_load_dwordx4 v7, s[8:11], s16 offen offset:1024 lds
    s_mov_b32 m0, 115712
    s_add_u32 s16, s16, 131072
    s_add_u32 s20, s20, 73728
    buffer_load_dwordx4 v9, s[12:15], s17 offen offset:0 lds
    buffer_load_dwordx4 v10, s[12:15], s17 offen offset:1024 lds
    s_mov_b32 m0, 123904
    s_nop 0
    buffer_load_dwordx4 v6, s[8:11], s16 offen lds
    buffer_load_dwordx4 v7, s[8:11], s16 offen offset:1024 lds
    s_mov_b32 m0, 132096
    s_add_u32 s16, s16, 131072
    s_add_u32 s17, s17, 73728
    buffer_load_dwordx4 v11, s[12:15], s20 offen offset:0 lds
    buffer_load_dwordx4 v12, s[12:15], s20 offen offset:1024 lds
    s_mov_b32 m0, 2048
    s_buffer_load_dwordx2 s[42:43], s[44:47], s38 offset:316
    s_buffer_load_dwordx2 s[42:43], s[44:47], s38 offset:444
    s_add_u32 s38, s38, 0x20000
    s_min_u32 s38, s38, s39
    s_waitcnt vmcnt(16)
    s_barrier
    buffer_load_dwordx4 v6, s[8:11], s16 offen lds
    buffer_load_dwordx4 v7, s[8:11], s16 offen offset:1024 lds
    s_mov_b32 m0, 11264
    s_add_u32 s16, s16, 131072
    s_add_u32 s20, s20, 73728
    buffer_load_dwordx4 v9, s[12:15], s17 offen offset:0 lds
    buffer_load_dwordx4 v10, s[12:15], s17 offen offset:1024 lds
    s_mov_b32 m0, 19456
    s_nop 0
    buffer_load_dwordx4 v6, s[8:11], s16 offen lds
    buffer_load_dwordx4 v7, s[8:11], s16 offen offset:1024 lds
    s_mov_b32 m0, 27648
    s_add_u32 s16, s16, 131072
    s_add_u32 s17, s17, 73728
    buffer_load_dwordx4 v11, s[12:15], s20 offen offset:0 lds
    buffer_load_dwordx4 v12, s[12:15], s20 offen offset:1024 lds
    s_mov_b32 m0, 36864
    s_buffer_load_dwordx2 s[42:43], s[44:47], s38 offset:60
    s_buffer_load_dwordx2 s[42:43], s[44:47], s38 offset:188
    s_mov_b32 s21, 3
m_B_main_56:
    s_waitcnt vmcnt(20)
    s_barrier
    buffer_load_dwordx4 v6, s[8:11], s16 offen lds
    buffer_load_dwordx4 v7, s[8:11], s16 offen offset:1024 lds
    s_mov_b32 m0, 46080
    s_add_u32 s16, s16, 131072
    s_add_u32 s20, s20, 73728
    buffer_load_dwordx4 v9, s[12:15], s17 offen offset:0 lds
    buffer_load_dwordx4 v10, s[12:15], s17 offen offset:1024 lds
    s_mov_b32 m0, 54272
    s_buffer_load_dwordx2 s[42:43], s[44:47], s38 offset:316
    s_buffer_load_dwordx2 s[42:43], s[44:47], s38 offset:444
    s_add_u32 s38, s38, 0x20000
    s_min_u32 s38, s38, s39
    s_waitcnt vmcnt(20)
    s_barrier
    buffer_load_dwordx4 v6, s[8:11], s16 offen lds
    buffer_load_dwordx4 v7, s[8:11], s16 offen offset:1024 lds
    s_mov_b32 m0, 62464
    s_add_u32 s16, s16, 131072
    s_add_u32 s17, s17, 73728
    buffer_load_dwordx4 v11, s[12:15], s20 offen offset:0 lds
    buffer_load_dwordx4 v12, s[12:15], s20 offen offset:1024 lds
    s_mov_b32 m0, 71680
    s_buffer_load_dwordx2 s[42:43], s[44:47], s38 offset:60
    s_buffer_load_dwordx2 s[42:43], s[44:47], s38 offset:188
    s_waitcnt vmcnt(20)
    s_barrier
    buffer_load_dwordx4 v6, s[8:11], s16 offen lds
    buffer_load_dwordx4 v7, s[8:11], s16 offen offset:1024 lds
    s_mov_b32 m0, 80896
    s_add_u32 s16, s16, 131072
    s_add_u32 s20, s20, 73728
    buffer_load_dwordx4 v9, s[12:15], s17 offen offset:0 lds
    buffer_load_dwordx4 v10, s[12:15], s17 offen offset:1024 lds
    s_mov_b32 m0, 89088
    s_buffer_load_dwordx2 s[42:43], s[44:47], s38 offset:316
    s_buffer_load_dwordx2 s[42:43], s[44:47], s38 offset:444
    s_add_u32 s38, s38, 0x20000
    s_min_u32 s38, s38, s39
    s_waitcnt vmcnt(20)
    s_barrier
    buffer_load_dwordx4 v6, s[8:11], s16 offen lds
    buffer_load_dwordx4 v7, s[8:11], s16 offen offset:1024 lds
    s_mov_b32 m0, 97280
    s_add_u32 s16, s16, 131072
    s_add_u32 s17, s17, 73728
    buffer_load_dwordx4 v11, s[12:15], s20 offen offset:0 lds
    buffer_load_dwordx4 v12, s[12:15], s20 offen offset:1024 lds
    s_mov_b32 m0, 106496
    s_buffer_load_dwordx2 s[42:43], s[44:47], s38 offset:60
    s_buffer_load_dwordx2 s[42:43], s[44:47], s38 offset:188
    s_waitcnt vmcnt(20)
    s_barrier
    buffer_load_dwordx4 v6, s[8:11], s16 offen lds
    buffer_load_dwordx4 v7, s[8:11], s16 offen offset:1024 lds
    s_mov_b32 m0, 115712
    s_add_u32 s16, s16, 131072
    s_add_u32 s20, s20, 73728
    buffer_load_dwordx4 v9, s[12:15], s17 offen offset:0 lds
    buffer_load_dwordx4 v10, s[12:15], s17 offen offset:1024 lds
    s_mov_b32 m0, 123904
    s_buffer_load_dwordx2 s[42:43], s[44:47], s38 offset:316
    s_buffer_load_dwordx2 s[42:43], s[44:47], s38 offset:444
    s_add_u32 s38, s38, 0x20000
    s_min_u32 s38, s38, s39
    s_waitcnt vmcnt(20)
    s_barrier
    buffer_load_dwordx4 v6, s[8:11], s16 offen lds
    buffer_load_dwordx4 v7, s[8:11], s16 offen offset:1024 lds
    s_mov_b32 m0, 132096
    s_add_u32 s16, s16, 131072
    s_add_u32 s17, s17, 73728
    buffer_load_dwordx4 v11, s[12:15], s20 offen offset:0 lds
    buffer_load_dwordx4 v12, s[12:15], s20 offen offset:1024 lds
    s_mov_b32 m0, 2048
    s_buffer_load_dwordx2 s[42:43], s[44:47], s38 offset:60
    s_buffer_load_dwordx2 s[42:43], s[44:47], s38 offset:188
    s_waitcnt vmcnt(20)
    s_barrier
    buffer_load_dwordx4 v6, s[8:11], s16 offen lds
    buffer_load_dwordx4 v7, s[8:11], s16 offen offset:1024 lds
    s_mov_b32 m0, 11264
    s_add_u32 s16, s16, 131072
    s_add_u32 s20, s20, 73728
    buffer_load_dwordx4 v9, s[12:15], s17 offen offset:0 lds
    buffer_load_dwordx4 v10, s[12:15], s17 offen offset:1024 lds
    s_mov_b32 m0, 19456
    s_buffer_load_dwordx2 s[42:43], s[44:47], s38 offset:316
    s_buffer_load_dwordx2 s[42:43], s[44:47], s38 offset:444
    s_add_u32 s38, s38, 0x20000
    s_min_u32 s38, s38, s39
    s_waitcnt vmcnt(20)
    s_barrier
    buffer_load_dwordx4 v6, s[8:11], s16 offen lds
    buffer_load_dwordx4 v7, s[8:11], s16 offen offset:1024 lds
    s_mov_b32 m0, 27648
    s_add_u32 s16, s16, 131072
    s_add_u32 s17, s17, 73728
    buffer_load_dwordx4 v11, s[12:15], s20 offen offset:0 lds
    buffer_load_dwordx4 v12, s[12:15], s20 offen offset:1024 lds
    s_mov_b32 m0, 36864
    s_buffer_load_dwordx2 s[42:43], s[44:47], s38 offset:60
    s_buffer_load_dwordx2 s[42:43], s[44:47], s38 offset:188
    s_sub_u32 s21, s21, 1
    s_cmp_lg_u32 s21, 0
    s_cbranch_scc1 m_B_main_56
    s_waitcnt vmcnt(20)
    s_barrier
    buffer_load_dwordx4 v6, s[8:11], s16 offen lds
    buffer_load_dwordx4 v7, s[8:11], s16 offen offset:1024 lds
    s_mov_b32 m0, 46080
    s_add_u32 s16, s16, 131072
    s_add_u32 s20, s20, 73728
    buffer_load_dwordx4 v9, s[12:15], s17 offen offset:0 lds
    buffer_load_dwordx4 v10, s[12:15], s17 offen offset:1024 lds
    s_mov_b32 m0, 54272
m_B_lt_58:
    s_waitcnt vmcnt(20)
    s_barrier
    buffer_load_dwordx4 v6, s[8:11], s16 offen lds
    buffer_load_dwordx4 v7, s[8:11], s16 offen offset:1024 lds
    s_mov_b32 m0, 62464
    s_add_u32 s16, s16, 131072
    s_add_u32 s17, s17, 73728
    buffer_load_dwordx4 v11, s[12:15], s20 offen offset:0 lds
    buffer_load_dwordx4 v12, s[12:15], s20 offen offset:1024 lds
    s_mov_b32 m0, 71680
    s_waitcnt vmcnt(20)
    s_barrier
    s_waitcnt vmcnt(16)
    s_barrier
    s_waitcnt vmcnt(12)
    s_barrier
    s_waitcnt vmcnt(8)
    s_barrier
    s_waitcnt vmcnt(4)
    s_barrier
    s_waitcnt vmcnt(0)
    s_barrier
    s_waitcnt vmcnt(0)
    s_barrier
m_B_le_57:
    s_waitcnt lgkmcnt(0)
    s_endpgm
m_B_ld2:
    s_add_u32 s20, s17, 36864
    s_add_u32 s23, s33, 2
    s_and_b32 s23, s23, 3
    s_lshl1_add_u32 s23, s23, s3
    s_add_u32 s23, s23, 3
    s_lshl_b32 s23, s23, 10
    v_add_u32 v9, s23, v8
    s_add_u32 s23, s33, 3
    s_and_b32 s23, s23, 3
    s_lshl1_add_u32 s23, s23, s3
    s_add_u32 s23, s23, 1
    s_lshl_b32 s23, s23, 10
    v_add_u32 v10, s23, v8
    s_add_u32 s23, s33, 2
    s_and_b32 s23, s23, 3
    s_lshl1_add_u32 s23, s23, s3
    s_add_u32 s23, s23, 2
    s_lshl_b32 s23, s23, 10
    v_add_u32 v11, s23, v8
    s_add_u32 s23, s33, 2
    s_and_b32 s23, s23, 3
    s_lshl1_add_u32 s23, s23, s3
    s_add_u32 s23, s23, 2
    s_lshl_b32 s23, s23, 10
    v_add_u32 v12, s23, v8
    s_add_u32 s23, s33, 3
    s_and_b32 s23, s23, 3
    s_lshl1_add_u32 s23, s23, s3
    s_add_u32 s23, s23, 0
    s_lshl_b32 s23, s23, 10
    v_add_u32 v13, s23, v8
    s_lshr_b32 s38, s2, 3
    s_lshl_b32 s38, s38, 1
    s_and_b32 s39, s2, 1
    s_add_u32 s38, s38, s39
    s_lshl_b32 s38, s38, 11
    s_add_u32 s38, s38, 1024
    s_add_u32 s39, s36, s18
    s_min_u32 s39, s39, 144
    s_sub_u32 s39, s39, 1
    s_lshl_b32 s39, s39, 17
    s_add_u32 s39, s39, s38
    s_add_u32 s42, s36, 19
    s_lshl_b32 s42, s42, 17
    s_add_u32 s38, s38, s42
    s_min_u32 s38, s38, s39
    s_mov_b32 m0, 4096
    v_mov_b32 v1, 163824
    s_waitcnt lgkmcnt(0)
    s_mov_b32 s10, 0x1200000
    s_mov_b32 s11, 0x20000
    s_add_u32 s12, s40, 0x7ff800
    s_addc_u32 s13, s41, 0
    s_mov_b32 s14, 0x5b2800
    s_mov_b32 s15, 0x20000
    s_add_u32 s28, s40, 0xe00000
    s_addc_u32 s29, s41, 0
    s_mov_b32 s30, 0x240000
    s_mov_b32 s31, 0x20000
    s_barrier
    s_cmp_lt_u32 s2, 216
    s_cbranch_scc1 m_B_zs2
    s_mov_b32 m0, 82944
    s_nop 0
    buffer_load_dwordx4 v9, s[12:15], s26 offen offset:0 lds
    buffer_load_dwordx4 v10, s[12:15], s26 offen offset:1024 lds
    s_add_u32 s26, s26, 36864
    s_mov_b32 m0, 99328
    s_nop 0
    buffer_load_dwordx4 v11, s[12:15], s26 offen offset:0 lds
    buffer_load_dwordx4 v12, s[12:15], s26 offen offset:1024 lds
    buffer_load_dwordx4 v13, s[12:15], s26 offen offset:2048 lds
    s_add_u32 s26, s26, 36864
    s_mov_b32 m0, 117760
    s_nop 0
    buffer_load_dwordx4 v9, s[12:15], s26 offen offset:0 lds
    buffer_load_dwordx4 v10, s[12:15], s26 offen offset:1024 lds
    s_add_u32 s26, s26, 36864
    s_mov_b32 m0, 134144
    s_nop 0
    buffer_load_dwordx4 v11, s[12:15], s26 offen offset:0 lds
    buffer_load_dwordx4 v12, s[12:15], s26 offen offset:1024 lds
    buffer_load_dwordx4 v13, s[12:15], s26 offen offset:2048 lds
    s_add_u32 s26, s26, 36864
    s_cmp_lt_u32 s33, 2
    s_cbranch_scc1 m_B_zs2
    s_mov_b32 m0, 152576
    s_nop 0
    buffer_load_dwordx4 v9, s[12:15], s26 offen offset:0 lds
    buffer_load_dwordx4 v10, s[12:15], s26 offen offset:1024 lds
    s_add_u32 s26, s26, 36864
m_B_zs2:
    s_mov_b32 m0, 4096
    s_nop 0
    buffer_load_dwordx4 v6, s[8:11], s16 offen lds
    buffer_load_dwordx4 v7, s[8:11], s16 offen offset:1024 lds
    s_add_u32 s16, s16, 131072
    s_mov_b32 m0, 21504
    s_nop 0
    buffer_load_dwordx4 v6, s[8:11], s16 offen lds
    buffer_load_dwordx4 v7, s[8:11], s16 offen offset:1024 lds
    s_add_u32 s16, s16, 131072
    s_mov_b32 m0, 38912
    s_nop 0
    buffer_load_dwordx4 v6, s[8:11], s16 offen lds
    buffer_load_dwordx4 v7, s[8:11], s16 offen offset:1024 lds
    s_add_u32 s16, s16, 131072
    s_mov_b32 m0, 56320
    s_nop 0
    buffer_load_dwordx4 v6, s[8:11], s16 offen lds
    buffer_load_dwordx4 v7, s[8:11], s16 offen offset:1024 lds
    s_add_u32 s16, s16, 131072
    s_mov_b32 m0, 13312
    s_waitcnt lgkmcnt(0)
    s_barrier
    s_mov_b32 m0, 73728
    s_nop 0
    buffer_load_dwordx4 v6, s[28:31], s32 offen lds
    buffer_load_dwordx4 v7, s[28:31], s32 offen offset:1024 lds
    s_add_u32 s32, s32, 131072
    s_mov_b32 m0, 91136
    s_nop 0
    buffer_load_dwordx4 v6, s[28:31], s32 offen lds
    buffer_load_dwordx4 v7, s[28:31], s32 offen offset:1024 lds
    s_add_u32 s32, s32, 131072
    s_mov_b32 m0, 108544
    s_nop 0
    buffer_load_dwordx4 v6, s[28:31], s32 offen lds
    buffer_load_dwordx4 v7, s[28:31], s32 offen offset:1024 lds
    s_add_u32 s32, s32, 131072
    s_mov_b32 m0, 125952
    s_nop 0
    buffer_load_dwordx4 v6, s[28:31], s32 offen lds
    buffer_load_dwordx4 v7, s[28:31], s32 offen offset:1024 lds
    s_add_u32 s32, s32, 131072
    s_cmp_lt_u32 s33, 2
    s_cbranch_scc1 m_B_zt2
    s_mov_b32 m0, 143360
    s_nop 0
    buffer_load_dwordx4 v6, s[28:31], s32 offen lds
    buffer_load_dwordx4 v7, s[28:31], s32 offen offset:1024 lds
    s_add_u32 s32, s32, 131072
m_B_zt2:
    s_mov_b32 m0, 13312
    s_mov_b32 s44, s8
    s_mov_b32 s45, s9
    s_mov_b32 s46, 0x1200000
    s_mov_b32 s47, 0x20000
    s_buffer_load_dwordx2 s[42:43], s[44:47], s38 offset:60
    s_buffer_load_dwordx2 s[42:43], s[44:47], s38 offset:188
    s_buffer_load_dwordx2 s[42:43], s[44:47], s38 offset:316
    s_buffer_load_dwordx2 s[42:43], s[44:47], s38 offset:444
    s_add_u32 s38, s38, 0x20000
    s_min_u32 s38, s38, s39
    s_waitcnt vmcnt(0)
    s_barrier
    s_mov_b32 s98, 0x800000
m_B_sp2:
    ds_read_b32 v2, v1 offset:0
    s_sub_u32 s98, s98, 1
    s_cbranch_scc1 m_B_sp2_x
    s_waitcnt lgkmcnt(0)
    v_cmp_ne_u32 vcc, 2, v2
    s_cbranch_vccnz m_B_sp2
m_B_sp2_x:
    buffer_load_dwordx4 v9, s[12:15], s17 offen offset:0 lds
    buffer_load_dwordx4 v10, s[12:15], s17 offen offset:1024 lds
    s_mov_b32 m0, 29696
    s_add_u32 s17, s17, 73728
    buffer_load_dwordx4 v11, s[12:15], s20 offen offset:0 lds
    buffer_load_dwordx4 v12, s[12:15], s20 offen offset:1024 lds
    buffer_load_dwordx4 v13, s[12:15], s20 offen offset:2048 lds
    s_mov_b32 m0, 48128
    s_add_u32 s20, s20, 73728
    buffer_load_dwordx4 v9, s[12:15], s17 offen offset:0 lds
    buffer_load_dwordx4 v10, s[12:15], s17 offen offset:1024 lds
    s_mov_b32 m0, 64512
    s_add_u32 s17, s17, 73728
    buffer_load_dwordx4 v11, s[12:15], s20 offen offset:0 lds
    buffer_load_dwordx4 v12, s[12:15], s20 offen offset:1024 lds
    buffer_load_dwordx4 v13, s[12:15], s20 offen offset:2048 lds
    s_mov_b32 m0, 73728
    s_mov_b32 s44, s8
    s_mov_b32 s45, s9
    s_mov_b32 s46, 0x1200000
    s_mov_b32 s47, 0x20000
    s_buffer_load_dwordx2 s[42:43], s[44:47], s38 offset:60
    s_buffer_load_dwordx2 s[42:43], s[44:47], s38 offset:188
    s_buffer_load_dwordx2 s[42:43], s[44:47], s38 offset:316
    s_buffer_load_dwordx2 s[42:43], s[44:47], s38 offset:444
    s_add_u32 s38, s38, 0x20000
    s_min_u32 s38, s38, s39
    s_waitcnt vmcnt(5)
    s_barrier
    buffer_load_dwordx4 v6, s[8:11], s16 offen lds
    buffer_load_dwordx4 v7, s[8:11], s16 offen offset:1024 lds
    s_mov_b32 m0, 82944
    s_add_u32 s16, s16, 131072
    s_add_u32 s20, s20, 73728
    buffer_load_dwordx4 v9, s[12:15], s17 offen offset:0 lds
    buffer_load_dwordx4 v10, s[12:15], s17 offen offset:1024 lds
    s_mov_b32 m0, 91136
    s_nop 0
    buffer_load_dwordx4 v6, s[8:11], s16 offen lds
    buffer_load_dwordx4 v7, s[8:11], s16 offen offset:1024 lds
    s_mov_b32 m0, 99328
    s_add_u32 s16, s16, 131072
    s_add_u32 s17, s17, 73728
    buffer_load_dwordx4 v11, s[12:15], s20 offen offset:0 lds
    buffer_load_dwordx4 v12, s[12:15], s20 offen offset:1024 lds
    buffer_load_dwordx4 v13, s[12:15], s20 offen offset:2048 lds
    s_mov_b32 m0, 108544
    s_buffer_load_dwordx2 s[42:43], s[44:47], s38 offset:60
    s_buffer_load_dwordx2 s[42:43], s[44:47], s38 offset:188
    s_waitcnt vmcnt(12)
    s_barrier
    buffer_load_dwordx4 v6, s[8:11], s16 offen lds
    buffer_load_dwordx4 v7, s[8:11], s16 offen offset:1024 lds
    s_mov_b32 m0, 117760
    s_add_u32 s16, s16, 131072
    s_add_u32 s20, s20, 73728
    buffer_load_dwordx4 v9, s[12:15], s17 offen offset:0 lds
    buffer_load_dwordx4 v10, s[12:15], s17 offen offset:1024 lds
    s_mov_b32 m0, 125952
    s_nop 0
    buffer_load_dwordx4 v6, s[8:11], s16 offen lds
    buffer_load_dwordx4 v7, s[8:11], s16 offen offset:1024 lds
    s_mov_b32 m0, 134144
    s_add_u32 s16, s16, 131072
    s_add_u32 s17, s17, 73728
    buffer_load_dwordx4 v11, s[12:15], s20 offen offset:0 lds
    buffer_load_dwordx4 v12, s[12:15], s20 offen offset:1024 lds
    buffer_load_dwordx4 v13, s[12:15], s20 offen offset:2048 lds
    s_mov_b32 m0, 4096
    s_buffer_load_dwordx2 s[42:43], s[44:47], s38 offset:316
    s_buffer_load_dwordx2 s[42:43], s[44:47], s38 offset:444
    s_add_u32 s38, s38, 0x20000
    s_min_u32 s38, s38, s39
    s_waitcnt vmcnt(18)
    s_barrier
    buffer_load_dwordx4 v6, s[8:11], s16 offen lds
    buffer_load_dwordx4 v7, s[8:11], s16 offen offset:1024 lds
    s_mov_b32 m0, 13312
    s_add_u32 s16, s16, 131072
    s_add_u32 s20, s20, 73728
    buffer_load_dwordx4 v9, s[12:15], s17 offen offset:0 lds
    buffer_load_dwordx4 v10, s[12:15], s17 offen offset:1024 lds
    s_mov_b32 m0, 21504
    s_nop 0
    buffer_load_dwordx4 v6, s[8:11], s16 offen lds
    buffer_load_dwordx4 v7, s[8:11], s16 offen offset:1024 lds
    s_mov_b32 m0, 29696
    s_add_u32 s16, s16, 131072
    s_add_u32 s17, s17, 73728
    buffer_load_dwordx4 v11, s[12:15], s20 offen offset:0 lds
    buffer_load_dwordx4 v12, s[12:15], s20 offen offset:1024 lds
    buffer_load_dwordx4 v13, s[12:15], s20 offen offset:2048 lds
    s_mov_b32 m0, 38912
    s_buffer_load_dwordx2 s[42:43], s[44:47], s38 offset:60
    s_buffer_load_dwordx2 s[42:43], s[44:47], s38 offset:188
    s_mov_b32 s21, 3
m_B_main_59:
    s_waitcnt vmcnt(23)
    s_barrier
    buffer_load_dwordx4 v6, s[8:11], s16 offen lds
    buffer_load_dwordx4 v7, s[8:11], s16 offen offset:1024 lds
    s_mov_b32 m0, 48128
    s_add_u32 s16, s16, 131072
    s_add_u32 s20, s20, 73728
    buffer_load_dwordx4 v9, s[12:15], s17 offen offset:0 lds
    buffer_load_dwordx4 v10, s[12:15], s17 offen offset:1024 lds
    s_mov_b32 m0, 56320
    s_buffer_load_dwordx2 s[42:43], s[44:47], s38 offset:316
    s_buffer_load_dwordx2 s[42:43], s[44:47], s38 offset:444
    s_add_u32 s38, s38, 0x20000
    s_min_u32 s38, s38, s39
    s_waitcnt vmcnt(22)
    s_barrier
    buffer_load_dwordx4 v6, s[8:11], s16 offen lds
    buffer_load_dwordx4 v7, s[8:11], s16 offen offset:1024 lds
    s_mov_b32 m0, 64512
    s_add_u32 s16, s16, 131072
    s_add_u32 s17, s17, 73728
    buffer_load_dwordx4 v11, s[12:15], s20 offen offset:0 lds
    buffer_load_dwordx4 v12, s[12:15], s20 offen offset:1024 lds
    buffer_load_dwordx4 v13, s[12:15], s20 offen offset:2048 lds
    s_mov_b32 m0, 73728
    s_buffer_load_dwordx2 s[42:43], s[44:47], s38 offset:60
    s_buffer_load_dwordx2 s[42:43], s[44:47], s38 offset:188
    s_waitcnt vmcnt(23)
    s_barrier
    buffer_load_dwordx4 v6, s[8:11], s16 offen lds
    buffer_load_dwordx4 v7, s[8:11], s16 offen offset:1024 lds
    s_mov_b32 m0, 82944
    s_add_u32 s16, s16, 131072
    s_add_u32 s20, s20, 73728
    buffer_load_dwordx4 v9, s[12:15], s17 offen offset:0 lds
    buffer_load_dwordx4 v10, s[12:15], s17 offen offset:1024 lds
    s_mov_b32 m0, 91136
    s_buffer_load_dwordx2 s[42:43], s[44:47], s38 offset:316
    s_buffer_load_dwordx2 s[42:43], s[44:47], s38 offset:444
    s_add_u32 s38, s38, 0x20000
    s_min_u32 s38, s38, s39
    s_waitcnt vmcnt(22)
    s_barrier
    buffer_load_dwordx4 v6, s[8:11], s16 offen lds
    buffer_load_dwordx4 v7, s[8:11], s16 offen offset:1024 lds
    s_mov_b32 m0, 99328
    s_add_u32 s16, s16, 131072
    s_add_u32 s17, s17, 73728
    buffer_load_dwordx4 v11, s[12:15], s20 offen offset:0 lds
    buffer_load_dwordx4 v12, s[12:15], s20 offen offset:1024 lds
    buffer_load_dwordx4 v13, s[12:15], s20 offen offset:2048 lds
    s_mov_b32 m0, 108544
    s_buffer_load_dwordx2 s[42:43], s[44:47], s38 offset:60
    s_buffer_load_dwordx2 s[42:43], s[44:47], s38 offset:188
    s_waitcnt vmcnt(23)
    s_barrier
    buffer_load_dwordx4 v6, s[8:11], s16 offen lds
    buffer_load_dwordx4 v7, s[8:11], s16 offen offset:1024 lds
    s_mov_b32 m0, 117760
    s_add_u32 s16, s16, 131072
    s_add_u32 s20, s20, 73728
    buffer_load_dwordx4 v9, s[12:15], s17 offen offset:0 lds
    buffer_load_dwordx4 v10, s[12:15], s17 offen offset:1024 lds
    s_mov_b32 m0, 125952
    s_buffer_load_dwordx2 s[42:43], s[44:47], s38 offset:316
    s_buffer_load_dwordx2 s[42:43], s[44:47], s38 offset:444
    s_add_u32 s38, s38, 0x20000
    s_min_u32 s38, s38, s39
    s_waitcnt vmcnt(22)
    s_barrier
    buffer_load_dwordx4 v6, s[8:11], s16 offen lds
    buffer_load_dwordx4 v7, s[8:11], s16 offen offset:1024 lds
    s_mov_b32 m0, 134144
    s_add_u32 s16, s16, 131072
    s_add_u32 s17, s17, 73728
    buffer_load_dwordx4 v11, s[12:15], s20 offen offset:0 lds
    buffer_load_dwordx4 v12, s[12:15], s20 offen offset:1024 lds
    buffer_load_dwordx4 v13, s[12:15], s20 offen offset:2048 lds
    s_mov_b32 m0, 4096
    s_buffer_load_dwordx2 s[42:43], s[44:47], s38 offset:60
    s_buffer_load_dwordx2 s[42:43], s[44:47], s38 offset:188
    s_waitcnt vmcnt(23)
    s_barrier
    buffer_load_dwordx4 v6, s[8:11], s16 offen lds
    buffer_load_dwordx4 v7, s[8:11], s16 offen offset:1024 lds
    s_mov_b32 m0, 13312
    s_add_u32 s16, s16, 131072
    s_add_u32 s20, s20, 73728
    buffer_load_dwordx4 v9, s[12:15], s17 offen offset:0 lds
    buffer_load_dwordx4 v10, s[12:15], s17 offen offset:1024 lds
    s_mov_b32 m0, 21504
    s_buffer_load_dwordx2 s[42:43], s[44:47], s38 offset:316
    s_buffer_load_dwordx2 s[42:43], s[44:47], s38 offset:444
    s_add_u32 s38, s38, 0x20000
    s_min_u32 s38, s38, s39
    s_waitcnt vmcnt(22)
    s_barrier
    buffer_load_dwordx4 v6, s[8:11], s16 offen lds
    buffer_load_dwordx4 v7, s[8:11], s16 offen offset:1024 lds
    s_mov_b32 m0, 29696
    s_add_u32 s16, s16, 131072
    s_add_u32 s17, s17, 73728
    buffer_load_dwordx4 v11, s[12:15], s20 offen offset:0 lds
    buffer_load_dwordx4 v12, s[12:15], s20 offen offset:1024 lds
    buffer_load_dwordx4 v13, s[12:15], s20 offen offset:2048 lds
    s_mov_b32 m0, 38912
    s_buffer_load_dwordx2 s[42:43], s[44:47], s38 offset:60
    s_buffer_load_dwordx2 s[42:43], s[44:47], s38 offset:188
    s_sub_u32 s21, s21, 1
    s_cmp_lg_u32 s21, 0
    s_cbranch_scc1 m_B_main_59
    s_waitcnt vmcnt(23)
    s_barrier
    buffer_load_dwordx4 v6, s[8:11], s16 offen lds
    buffer_load_dwordx4 v7, s[8:11], s16 offen offset:1024 lds
    s_mov_b32 m0, 48128
    s_add_u32 s16, s16, 131072
    s_add_u32 s20, s20, 73728
    buffer_load_dwordx4 v9, s[12:15], s17 offen offset:0 lds
    buffer_load_dwordx4 v10, s[12:15], s17 offen offset:1024 lds
    s_mov_b32 m0, 56320
m_B_lt_61:
    s_waitcnt vmcnt(22)
    s_barrier
    buffer_load_dwordx4 v6, s[8:11], s16 offen lds
    buffer_load_dwordx4 v7, s[8:11], s16 offen offset:1024 lds
    s_mov_b32 m0, 64512
    s_add_u32 s16, s16, 131072
    s_add_u32 s17, s17, 73728
    buffer_load_dwordx4 v11, s[12:15], s20 offen offset:0 lds
    buffer_load_dwordx4 v12, s[12:15], s20 offen offset:1024 lds
    buffer_load_dwordx4 v13, s[12:15], s20 offen offset:2048 lds
    s_mov_b32 m0, 73728
    s_waitcnt vmcnt(23)
    s_barrier
    s_waitcnt vmcnt(18)
    s_barrier
    s_waitcnt vmcnt(14)
    s_barrier
    s_waitcnt vmcnt(9)
    s_barrier
    s_waitcnt vmcnt(5)
    s_barrier
    s_waitcnt vmcnt(0)
    s_barrier
    s_waitcnt vmcnt(0)
    s_barrier
m_B_le_60:
    s_waitcnt lgkmcnt(0)
    s_endpgm
m_B_ld3:
    s_add_u32 s20, s17, 36864
    s_add_u32 s23, s33, 3
    s_and_b32 s23, s23, 3
    s_lshl1_add_u32 s23, s23, s3
    s_add_u32 s23, s23, 3
    s_lshl_b32 s23, s23, 10
    v_add_u32 v9, s23, v8
    s_cmp_eq_u32 s3, 0
    s_cselect_b32 s23, 9216, 0
    s_max_u32 s23, s23, 1024
    v_add_u32 v10, s23, v8
    s_lshr_b32 s38, s2, 3
    s_lshl_b32 s38, s38, 1
    s_and_b32 s39, s2, 1
    s_add_u32 s38, s38, s39
    s_lshl_b32 s38, s38, 11
    s_add_u32 s38, s38, 1536
    s_add_u32 s39, s36, s18
    s_min_u32 s39, s39, 144
    s_sub_u32 s39, s39, 1
    s_lshl_b32 s39, s39, 17
    s_add_u32 s39, s39, s38
    s_add_u32 s42, s36, 19
    s_lshl_b32 s42, s42, 17
    s_add_u32 s38, s38, s42
    s_min_u32 s38, s38, s39
    s_mov_b32 m0, 6144
    v_mov_b32 v1, 163824
    s_waitcnt lgkmcnt(0)
    s_mov_b32 s10, 0x1200000
    s_mov_b32 s11, 0x20000
    s_add_u32 s12, s40, 0x7ff800
    s_addc_u32 s13, s41, 0
    s_mov_b32 s14, 0x5b2800
    s_mov_b32 s15, 0x20000
    s_add_u32 s28, s40, 0xe00000
    s_addc_u32 s29, s41, 0
    s_mov_b32 s30, 0x240000
    s_mov_b32 s31, 0x20000
    s_barrier
    s_cmp_lt_u32 s2, 216
    s_cbranch_scc1 m_B_zs3
    s_mov_b32 m0, 84992
    s_nop 0
    buffer_load_dwordx4 v9, s[12:15], s26 offen offset:0 lds
    buffer_load_dwordx4 v10, s[12:15], s26 offen offset:1024 lds
    s_add_u32 s26, s26, 36864
    s_mov_b32 m0, 102400
    s_nop 0
    buffer_load_dwordx4 v9, s[12:15], s26 offen offset:0 lds
    buffer_load_dwordx4 v10, s[12:15], s26 offen offset:1024 lds
    s_add_u32 s26, s26, 36864
    s_mov_b32 m0, 119808
    s_nop 0
    buffer_load_dwordx4 v9, s[12:15], s26 offen offset:0 lds
    buffer_load_dwordx4 v10, s[12:15], s26 offen offset:1024 lds
    s_add_u32 s26, s26, 36864
    s_mov_b32 m0, 137216
    s_nop 0
    buffer_load_dwordx4 v9, s[12:15], s26 offen offset:0 lds
    buffer_load_dwordx4 v10, s[12:15], s26 offen offset:1024 lds
    s_add_u32 s26, s26, 36864
    s_cmp_lt_u32 s33, 2
    s_cbranch_scc1 m_B_zs3
    s_mov_b32 m0, 154624
    s_nop 0
    buffer_load_dwordx4 v9, s[12:15], s26 offen offset:0 lds
    buffer_load_dwordx4 v10, s[12:15], s26 offen offset:1024 lds
    s_add_u32 s26, s26, 36864
m_B_zs3:
    s_mov_b32 m0, 6144
    s_nop 0
    buffer_load_dwordx4 v6, s[8:11], s16 offen lds
    buffer_load_dwordx4 v7, s[8:11], s16 offen offset:1024 lds
    s_add_u32 s16, s16, 131072
    s_mov_b32 m0, 23552
    s_nop 0
    buffer_load_dwordx4 v6, s[8:11], s16 offen lds
    buffer_load_dwordx4 v7, s[8:11], s16 offen offset:1024 lds
    s_add_u32 s16, s16, 131072
    s_mov_b32 m0, 40960
    s_nop 0
    buffer_load_dwordx4 v6, s[8:11], s16 offen lds
    buffer_load_dwordx4 v7, s[8:11], s16 offen offset:1024 lds
    s_add_u32 s16, s16, 131072
    s_mov_b32 m0, 58368
    s_nop 0
    buffer_load_dwordx4 v6, s[8:11], s16 offen lds
    buffer_load_dwordx4 v7, s[8:11], s16 offen offset:1024 lds
    s_add_u32 s16, s16, 131072
    s_mov_b32 m0, 15360
    s_waitcnt lgkmcnt(0)
    s_barrier
    s_mov_b32 m0, 75776
    s_nop 0
    buffer_load_dwordx4 v6, s[28:31], s32 offen lds
    buffer_load_dwordx4 v7, s[28:31], s32 offen offset:1024 lds
    s_add_u32 s32, s32, 131072
    s_mov_b32 m0, 93184
    s_nop 0
    buffer_load_dwordx4 v6, s[28:31], s32 offen lds
    buffer_load_dwordx4 v7, s[28:31], s32 offen offset:1024 lds
    s_add_u32 s32, s32, 131072
    s_mov_b32 m0, 110592
    s_nop 0
    buffer_load_dwordx4 v6, s[28:31], s32 offen lds
    buffer_load_dwordx4 v7, s[28:31], s32 offen offset:1024 lds
    s_add_u32 s32, s32, 131072
    s_mov_b32 m0, 128000
    s_nop 0
    buffer_load_dwordx4 v6, s[28:31], s32 offen lds
    buffer_load_dwordx4 v7, s[28:31], s32 offen offset:1024 lds
    s_add_u32 s32, s32, 131072
    s_cmp_lt_u32 s33, 2
    s_cbranch_scc1 m_B_zt3
    s_mov_b32 m0, 145408
    s_nop 0
    buffer_load_dwordx4 v6, s[28:31], s32 offen lds
    buffer_load_dwordx4 v7, s[28:31], s32 offen offset:1024 lds
    s_add_u32 s32, s32, 131072
m_B_zt3:
    s_mov_b32 m0, 15360
    s_mov_b32 s44, s8
    s_mov_b32 s45, s9
    s_mov_b32 s46, 0x1200000
    s_mov_b32 s47, 0x20000
    s_buffer_load_dwordx2 s[42:43], s[44:47], s38 offset:60
    s_buffer_load_dwordx2 s[42:43], s[44:47], s38 offset:188
    s_buffer_load_dwordx2 s[42:43], s[44:47], s38 offset:316
    s_buffer_load_dwordx2 s[42:43], s[44:47], s38 offset:444
    s_add_u32 s38, s38, 0x20000
    s_min_u32 s38, s38, s39
    s_waitcnt vmcnt(0)
    s_barrier
    s_mov_b32 s98, 0x800000
m_B_sp3:
    ds_read_b32 v2, v1 offset:0
    s_sub_u32 s98, s98, 1
    s_cbranch_scc1 m_B_sp3_x
    s_waitcnt lgkmcnt(0)
    v_cmp_ne_u32 vcc, 2, v2
    s_cbranch_vccnz m_B_sp3
m_B_sp3_x:
    buffer_load_dwordx4 v9, s[12:15], s17 offen offset:0 lds
    buffer_load_dwordx4 v10, s[12:15], s17 offen offset:1024 lds
    s_mov_b32 m0, 32768
    s_add_u32 s17, s17, 73728
    buffer_load_dwordx4 v9, s[12:15], s20 offen offset:0 lds
    buffer_load_dwordx4 v10, s[12:15], s20 offen offset:1024 lds
    s_mov_b32 m0, 50176
    s_add_u32 s20, s20, 73728
    buffer_load_dwordx4 v9, s[12:15], s17 offen offset:0 lds
    buffer_load_dwordx4 v10, s[12:15], s17 offen offset:1024 lds
    s_mov_b32 m0, 67584
    s_add_u32 s17, s17, 73728
    buffer_load_dwordx4 v9, s[12:15], s20 offen offset:0 lds
    buffer_load_dwordx4 v10, s[12:15], s20 offen offset:1024 lds
    s_mov_b32 m0, 75776
    s_mov_b32 s44, s8
    s_mov_b32 s45, s9
    s_mov_b32 s46, 0x1200000
    s_mov_b32 s47, 0x20000
    s_buffer_load_dwordx2 s[42:43], s[44:47], s38 offset:60
    s_buffer_load_dwordx2 s[42:43], s[44:47], s38 offset:188
    s_buffer_load_dwordx2 s[42:43], s[44:47], s38 offset:316
    s_buffer_load_dwordx2 s[42:43], s[44:47], s38 offset:444
    s_add_u32 s38, s38, 0x20000
    s_min_u32 s38, s38, s39
    s_waitcnt vmcnt(4)
    s_barrier
    buffer_load_dwordx4 v6, s[8:11], s16 offen lds
    buffer_load_dwordx4 v7, s[8:11], s16 offen offset:1024 lds
    s_mov_b32 m0, 84992
    s_add_u32 s16, s16, 131072
    s_add_u32 s20, s20, 73728
    buffer_load_dwordx4 v9, s[12:15], s17 offen offset:0 lds
    buffer_load_dwordx4 v10, s[12:15], s17 offen offset:1024 lds
    s_mov_b32 m0, 93184
    s_nop 0
    buffer_load_dwordx4 v6, s[8:11], s16 offen lds
    buffer_load_dwordx4 v7, s[8:11], s16 offen offset:1024 lds
    s_mov_b32 m0, 102400
    s_add_u32 s16, s16, 131072
    s_add_u32 s17, s17, 73728
    buffer_load_dwordx4 v9, s[12:15], s20 offen offset:0 lds
    buffer_load_dwordx4 v10, s[12:15], s20 offen offset:1024 lds
    s_mov_b32 m0, 110592
    s_buffer_load_dwordx2 s[42:43], s[44:47], s38 offset:60
    s_buffer_load_dwordx2 s[42:43], s[44:47], s38 offset:188
    s_waitcnt vmcnt(10)
    s_barrier
    buffer_load_dwordx4 v6, s[8:11], s16 offen lds
    buffer_load_dwordx4 v7, s[8:11], s16 offen offset:1024 lds
    s_mov_b32 m0, 119808
    s_add_u32 s16, s16, 131072
    s_add_u32 s20, s20, 73728
    buffer_load_dwordx4 v9, s[12:15], s17 offen offset:0 lds
    buffer_load_dwordx4 v10, s[12:15], s17 offen offset:1024 lds
    s_mov_b32 m0, 128000
    s_nop 0
    buffer_load_dwordx4 v6, s[8:11], s16 offen lds
    buffer_load_dwordx4 v7, s[8:11], s16 offen offset:1024 lds
    s_mov_b32 m0, 137216
    s_add_u32 s16, s16, 131072
    s_add_u32 s17, s17, 73728
    buffer_load_dwordx4 v9, s[12:15], s20 offen offset:0 lds
    buffer_load_dwordx4 v10, s[12:15], s20 offen offset:1024 lds
    s_mov_b32 m0, 6144
    s_buffer_load_dwordx2 s[42:43], s[44:47], s38 offset:316
    s_buffer_load_dwordx2 s[42:43], s[44:47], s38 offset:444
    s_add_u32 s38, s38, 0x20000
    s_min_u32 s38, s38, s39
    s_waitcnt vmcnt(16)
    s_barrier
    buffer_load_dwordx4 v6, s[8:11], s16 offen lds
    buffer_load_dwordx4 v7, s[8:11], s16 offen offset:1024 lds
    s_mov_b32 m0, 15360
    s_add_u32 s16, s16, 131072
    s_add_u32 s20, s20, 73728
    buffer_load_dwordx4 v9, s[12:15], s17 offen offset:0 lds
    buffer_load_dwordx4 v10, s[12:15], s17 offen offset:1024 lds
    s_mov_b32 m0, 23552
    s_nop 0
    buffer_load_dwordx4 v6, s[8:11], s16 offen lds
    buffer_load_dwordx4 v7, s[8:11], s16 offen offset:1024 lds
    s_mov_b32 m0, 32768
    s_add_u32 s16, s16, 131072
    s_add_u32 s17, s17, 73728
    buffer_load_dwordx4 v9, s[12:15], s20 offen offset:0 lds
    buffer_load_dwordx4 v10, s[12:15], s20 offen offset:1024 lds
    s_mov_b32 m0, 40960
    s_buffer_load_dwordx2 s[42:43], s[44:47], s38 offset:60
    s_buffer_load_dwordx2 s[42:43], s[44:47], s38 offset:188
    s_mov_b32 s21, 3
m_B_main_62:
    s_waitcnt vmcnt(20)
    s_barrier
    buffer_load_dwordx4 v6, s[8:11], s16 offen lds
    buffer_load_dwordx4 v7, s[8:11], s16 offen offset:1024 lds
    s_mov_b32 m0, 50176
    s_add_u32 s16, s16, 131072
    s_add_u32 s20, s20, 73728
    buffer_load_dwordx4 v9, s[12:15], s17 offen offset:0 lds
    buffer_load_dwordx4 v10, s[12:15], s17 offen offset:1024 lds
    s_mov_b32 m0, 58368
    s_buffer_load_dwordx2 s[42:43], s[44:47], s38 offset:316
    s_buffer_load_dwordx2 s[42:43], s[44:47], s38 offset:444
    s_add_u32 s38, s38, 0x20000
    s_min_u32 s38, s38, s39
    s_waitcnt vmcnt(20)
    s_barrier
    buffer_load_dwordx4 v6, s[8:11], s16 offen lds
    buffer_load_dwordx4 v7, s[8:11], s16 offen offset:1024 lds
    s_mov_b32 m0, 67584
    s_add_u32 s16, s16, 131072
    s_add_u32 s17, s17, 73728
    buffer_load_dwordx4 v9, s[12:15], s20 offen offset:0 lds
    buffer_load_dwordx4 v10, s[12:15], s20 offen offset:1024 lds
    s_mov_b32 m0, 75776
    s_buffer_load_dwordx2 s[42:43], s[44:47], s38 offset:60
    s_buffer_load_dwordx2 s[42:43], s[44:47], s38 offset:188
    s_waitcnt vmcnt(20)
    s_barrier
    buffer_load_dwordx4 v6, s[8:11], s16 offen lds
    buffer_load_dwordx4 v7, s[8:11], s16 offen offset:1024 lds
    s_mov_b32 m0, 84992
    s_add_u32 s16, s16, 131072
    s_add_u32 s20, s20, 73728
    buffer_load_dwordx4 v9, s[12:15], s17 offen offset:0 lds
    buffer_load_dwordx4 v10, s[12:15], s17 offen offset:1024 lds
    s_mov_b32 m0, 93184
    s_buffer_load_dwordx2 s[42:43], s[44:47], s38 offset:316
    s_buffer_load_dwordx2 s[42:43], s[44:47], s38 offset:444
    s_add_u32 s38, s38, 0x20000
    s_min_u32 s38, s38, s39
    s_waitcnt vmcnt(20)
    s_barrier
    buffer_load_dwordx4 v6, s[8:11], s16 offen lds
    buffer_load_dwordx4 v7, s[8:11], s16 offen offset:1024 lds
    s_mov_b32 m0, 102400
    s_add_u32 s16, s16, 131072
    s_add_u32 s17, s17, 73728
    buffer_load_dwordx4 v9, s[12:15], s20 offen offset:0 lds
    buffer_load_dwordx4 v10, s[12:15], s20 offen offset:1024 lds
    s_mov_b32 m0, 110592
    s_buffer_load_dwordx2 s[42:43], s[44:47], s38 offset:60
    s_buffer_load_dwordx2 s[42:43], s[44:47], s38 offset:188
    s_waitcnt vmcnt(20)
    s_barrier
    buffer_load_dwordx4 v6, s[8:11], s16 offen lds
    buffer_load_dwordx4 v7, s[8:11], s16 offen offset:1024 lds
    s_mov_b32 m0, 119808
    s_add_u32 s16, s16, 131072
    s_add_u32 s20, s20, 73728
    buffer_load_dwordx4 v9, s[12:15], s17 offen offset:0 lds
    buffer_load_dwordx4 v10, s[12:15], s17 offen offset:1024 lds
    s_mov_b32 m0, 128000
    s_buffer_load_dwordx2 s[42:43], s[44:47], s38 offset:316
    s_buffer_load_dwordx2 s[42:43], s[44:47], s38 offset:444
    s_add_u32 s38, s38, 0x20000
    s_min_u32 s38, s38, s39
    s_waitcnt vmcnt(20)
    s_barrier
    buffer_load_dwordx4 v6, s[8:11], s16 offen lds
    buffer_load_dwordx4 v7, s[8:11], s16 offen offset:1024 lds
    s_mov_b32 m0, 137216
    s_add_u32 s16, s16, 131072
    s_add_u32 s17, s17, 73728
    buffer_load_dwordx4 v9, s[12:15], s20 offen offset:0 lds
    buffer_load_dwordx4 v10, s[12:15], s20 offen offset:1024 lds
    s_mov_b32 m0, 6144
    s_buffer_load_dwordx2 s[42:43], s[44:47], s38 offset:60
    s_buffer_load_dwordx2 s[42:43], s[44:47], s38 offset:188
    s_waitcnt vmcnt(20)
    s_barrier
    buffer_load_dwordx4 v6, s[8:11], s16 offen lds
    buffer_load_dwordx4 v7, s[8:11], s16 offen offset:1024 lds
    s_mov_b32 m0, 15360
    s_add_u32 s16, s16, 131072
    s_add_u32 s20, s20, 73728
    buffer_load_dwordx4 v9, s[12:15], s17 offen offset:0 lds
    buffer_load_dwordx4 v10, s[12:15], s17 offen offset:1024 lds
    s_mov_b32 m0, 23552
    s_buffer_load_dwordx2 s[42:43], s[44:47], s38 offset:316
    s_buffer_load_dwordx2 s[42:43], s[44:47], s38 offset:444
    s_add_u32 s38, s38, 0x20000
    s_min_u32 s38, s38, s39
    s_waitcnt vmcnt(20)
    s_barrier
    buffer_load_dwordx4 v6, s[8:11], s16 offen lds
    buffer_load_dwordx4 v7, s[8:11], s16 offen offset:1024 lds
    s_mov_b32 m0, 32768
    s_add_u32 s16, s16, 131072
    s_add_u32 s17, s17, 73728
    buffer_load_dwordx4 v9, s[12:15], s20 offen offset:0 lds
    buffer_load_dwordx4 v10, s[12:15], s20 offen offset:1024 lds
    s_mov_b32 m0, 40960
    s_buffer_load_dwordx2 s[42:43], s[44:47], s38 offset:60
    s_buffer_load_dwordx2 s[42:43], s[44:47], s38 offset:188
    s_sub_u32 s21, s21, 1
    s_cmp_lg_u32 s21, 0
    s_cbranch_scc1 m_B_main_62
    s_waitcnt vmcnt(20)
    s_barrier
    buffer_load_dwordx4 v6, s[8:11], s16 offen lds
    buffer_load_dwordx4 v7, s[8:11], s16 offen offset:1024 lds
    s_mov_b32 m0, 50176
    s_add_u32 s16, s16, 131072
    s_add_u32 s20, s20, 73728
    buffer_load_dwordx4 v9, s[12:15], s17 offen offset:0 lds
    buffer_load_dwordx4 v10, s[12:15], s17 offen offset:1024 lds
    s_mov_b32 m0, 58368
m_B_lt_64:
    s_waitcnt vmcnt(20)
    s_barrier
    buffer_load_dwordx4 v6, s[8:11], s16 offen lds
    buffer_load_dwordx4 v7, s[8:11], s16 offen offset:1024 lds
    s_mov_b32 m0, 67584
    s_add_u32 s16, s16, 131072
    s_add_u32 s17, s17, 73728
    buffer_load_dwordx4 v9, s[12:15], s20 offen offset:0 lds
    buffer_load_dwordx4 v10, s[12:15], s20 offen offset:1024 lds
    s_mov_b32 m0, 75776
    s_waitcnt vmcnt(20)
    s_barrier
    s_waitcnt vmcnt(16)
    s_barrier
    s_waitcnt vmcnt(12)
    s_barrier
    s_waitcnt vmcnt(8)
    s_barrier
    s_waitcnt vmcnt(4)
    s_barrier
    s_waitcnt vmcnt(0)
    s_barrier
    s_waitcnt vmcnt(0)
    s_barrier
m_B_le_63:
    s_waitcnt lgkmcnt(0)
    s_endpgm
m_B_comp:
    s_cmp_eq_u32 s33, 3
    s_cselect_b32 s26, 4, 0
    s_and_b32 s22, s19, 3
    s_lshr_b32 s23, s19, 2
    v_and_b32 v10, 63, v0
    v_lshrrev_b32 v11, 2, v10
    v_and_b32 v12, 7, v11
    s_mul_i32 s24, s22, 2
    v_xor_b32 v12, s24, v12
    v_lshlrev_b32 v12, 5, v12
    v_lshl_add_u32 v11, v11, 8, v12
    v_and_b32 v12, 3, v10
    v_lshl_add_u32 v16, v12, 3, v11
    v_xor_b32 v17, 32, v16
    s_mul_i32 s24, s23, 9216
    s_add_u32 s24, s24, 8192
    v_lshl_add_u32 v13, v10, 4, s24
    v_add_u32 v18, 52224, v16
    v_add_u32 v19, 52224, v17
    v_add_u32 v14, 52224, v13
    v_add_u32 v20, 104448, v16
    v_add_u32 v21, 104448, v17
    v_add_u32 v15, 104448, v13
    s_lshl_b32 s38, s34, 2
    s_add_u32 s38, s38, s22
    s_lshl_b32 s39, s38, 5
    v_and_b32 v11, 15, v10
    v_add_u32 v12, s39, v11
    v_lshlrev_b32 v12, 1, v12
    v_lshlrev_b32 v11, 7, v11
    s_bfe_u32 s39, s38, 0x20003
    s_and_b32 s52, s38, 1
    s_lshl1_add_u32 s39, s39, s52
    s_lshl_b32 s39, s39, 12
    s_and_b32 s52, s38, 32
    s_add_u32 s39, s39, s52
    s_and_b32 s52, s38, 6
    s_lshl2_add_u32 s39, s52, s39
    s_waitcnt lgkmcnt(0)
    s_mov_b32 s46, 0x1000
    s_mov_b32 s47, 0x20000
    s_add_u32 s52, s40, 0x300000
    s_addc_u32 s53, s41, 0
    s_mov_b32 s54, 0x8000
    s_mov_b32 s55, 0x20000
    s_cmp_eq_u32 s33, 0
    s_cselect_b32 s46, s46, 0
    buffer_load_ushort v8, v12, s[44:47], 0 offen offset:0
    buffer_load_dwordx2 v[2:3], v11, s[52:55], s39 offen offset:0 sc1
    buffer_load_ushort v9, v12, s[44:47], 0 offen offset:32
    buffer_load_dwordx2 v[4:5], v11, s[52:55], s39 offen offset:2048 sc1
    s_add_u32 s12, s40, 0x310000
    s_addc_u32 s13, s41, 0
    s_mov_b32 s14, 0xa8000
    s_mov_b32 s15, 0x20000
    v_mov_b32 v12, s96
    s_mov_b64 exec, 1
    s_cmp_lt_u32 s97, 241664
    s_waitcnt vmcnt(4)
    s_cbranch_scc1 m_B_y1
    s_waitcnt vmcnt(0)
    s_barrier
    s_cmp_lg_u32 s19, 0
    s_cbranch_scc1 m_B_y2
m_B_y1:
    buffer_store_dword v12, off, s[12:15], s97 sc1
    s_cbranch_scc0 m_B_y2
    s_barrier
m_B_y2:
    s_mov_b64 exec, -1
    s_add_u32 s48, s40, 0x1100000
    s_addc_u32 s49, s41, 0
    s_mov_b32 s50, 0x900000
    s_mov_b32 s51, 0x20000
    s_mov_b32 s58, 0x240000
    s_mov_b32 s59, 0x20000
    s_mul_i32 s28, s38, 36864
    s_add_u32 s29, s37, s3
    s_lshl_b32 s29, s29, 5
    s_lshl_b32 s30, s33, 6
    s_add_u32 s29, s29, s30
    s_lshr_b32 s30, s35, 1
    s_mul_i32 s30, s30, 576
    s_lshl3_add_u32 s30, s3, s30
    s_add_u32 s30, s30, 256
    s_add_u32 s30, s30, s28
    s_add_u32 s28, s28, s29
    s_add_u32 s29, s28, 18432
    s_add_u32 s31, s30, 18432
    s_lshr_b32 s38, s2, 3
    s_and_b32 s39, s2, 1
    s_lshl1_add_u32 s38, s38, s39
    s_lshl2_add_u32 s16, s38, s22
    s_lshl_b32 s16, s16, 9
    s_lshl_b32 s17, s33, 7
    s_add_u32 s17, s17, s16
    s_mul_i32 s38, s38, 147456
    s_mul_i32 s39, s22, 9216
    s_add_u32 s38, s38, s39
    s_add_u32 s39, s33, 1
    s_and_b32 s39, s39, 3
    s_mul_i32 s39, s39, 36864
    s_add_u32 s39, s39, 0
    s_add_u32 s4, s38, s39
    s_add_u32 s39, s33, 2
    s_and_b32 s39, s39, 3
    s_mul_i32 s39, s39, 36864
    s_add_u32 s39, s39, 3072
    s_add_u32 s5, s38, s39
    s_add_u32 s39, s33, 3
    s_and_b32 s39, s39, 3
    s_mul_i32 s39, s39, 36864
    s_add_u32 s39, s39, 6144
    s_add_u32 s6, s38, s39
    s_sub_u32 s39, s22, s33
    s_and_b32 s39, s39, 3
    s_mul_i32 s39, s39, 3072
    s_mul_i32 s7, s22, 36864
    s_add_u32 s7, s7, s39
    s_add_u32 s7, s7, s38
    s_mul_i32 s39, s33, 36864
    s_add_u32 s8, s38, s39
    s_add_u32 s9, s8, 3072
    s_add_u32 s10, s8, 6144
    s_lshl_b32 s11, 1, s33
    s_xor_b32 s11, s11, 15
    s_waitcnt vmcnt(1)
    v_mov_b32 v6, v3
    v_mov_b32 v3, v2
    v_lshlrev_b32 v24, 16, v8
    v_lshlrev_b32 v25, 16, v8
    v_lshlrev_b32 v26, 16, v8
    v_lshlrev_b32 v27, 16, v8
    v_lshlrev_b32 v28, 16, v8
    v_lshlrev_b32 v29, 16, v8
    v_lshlrev_b32 v30, 16, v8
    v_lshlrev_b32 v31, 16, v8
    v_lshlrev_b32 v32, 16, v8
    v_lshlrev_b32 v33, 16, v8
    v_lshlrev_b32 v34, 16, v8
    v_lshlrev_b32 v35, 16, v8
    v_lshlrev_b32 v36, 16, v8
    v_lshlrev_b32 v37, 16, v8
    v_lshlrev_b32 v38, 16, v8
    v_lshlrev_b32 v39, 16, v8
    v_lshlrev_b32 v40, 16, v8
    v_lshlrev_b32 v41, 16, v8
    v_lshlrev_b32 v42, 16, v8
    v_lshlrev_b32 v43, 16, v8
    v_lshlrev_b32 v44, 16, v8
    v_lshlrev_b32 v45, 16, v8
    v_lshlrev_b32 v46, 16, v8
    v_lshlrev_b32 v47, 16, v8
    v_lshlrev_b32 v48, 16, v8
    v_lshlrev_b32 v49, 16, v8
    v_lshlrev_b32 v50, 16, v8
    v_lshlrev_b32 v51, 16, v8
    v_lshlrev_b32 v52, 16, v8
    v_lshlrev_b32 v53, 16, v8
    v_lshlrev_b32 v54, 16, v8
    v_lshlrev_b32 v55, 16, v8
    v_lshlrev_b32 v56, 16, v8
    v_lshlrev_b32 v57, 16, v8
    v_lshlrev_b32 v58, 16, v8
    v_lshlrev_b32 v59, 16, v8
    v_mov_b32 v7, v5
    v_mov_b32 v5, v4
    v_lshlrev_b32 v60, 16, v9
    v_lshlrev_b32 v61, 16, v9
    v_lshlrev_b32 v62, 16, v9
    v_lshlrev_b32 v63, 16, v9
    v_lshlrev_b32 v64, 16, v9
    v_lshlrev_b32 v65, 16, v9
    v_lshlrev_b32 v66, 16, v9
    v_lshlrev_b32 v67, 16, v9
    v_lshlrev_b32 v68, 16, v9
    v_lshlrev_b32 v69, 16, v9
    v_lshlrev_b32 v70, 16, v9
    v_lshlrev_b32 v71, 16, v9
    v_lshlrev_b32 v72, 16, v9
    v_lshlrev_b32 v73, 16, v9
    v_lshlrev_b32 v74, 16, v9
    v_lshlrev_b32 v75, 16, v9
    v_lshlrev_b32 v76, 16, v9
    v_lshlrev_b32 v77, 16, v9
    v_lshlrev_b32 v78, 16, v9
    v_lshlrev_b32 v79, 16, v9
    v_lshlrev_b32 v80, 16, v9
    v_lshlrev_b32 v81, 16, v9
    v_lshlrev_b32 v82, 16, v9
    v_lshlrev_b32 v83, 16, v9
    v_lshlrev_b32 v84, 16, v9
    v_lshlrev_b32 v85, 16, v9
    v_lshlrev_b32 v86, 16, v9
    v_lshlrev_b32 v87, 16, v9
    v_lshlrev_b32 v88, 16, v9
    v_lshlrev_b32 v89, 16, v9
    v_lshlrev_b32 v90, 16, v9
    v_lshlrev_b32 v91, 16, v9
    v_lshlrev_b32 v92, 16, v9
    v_lshlrev_b32 v93, 16, v9
    v_lshlrev_b32 v94, 16, v9
    v_lshlrev_b32 v95, 16, v9
    s_barrier
    ds_read_b64_tr_b16 v[96:97], v18 offset:17408
    ds_read_b64_tr_b16 v[98:99], v18 offset:21504
    ds_read_b128 v[112:115], v14 offset:17408
    ds_read_b64_tr_b16 v[100:101], v19 offset:17408
    ds_read_b64_tr_b16 v[102:103], v19 offset:21504
    ds_read_b128 v[116:119], v14 offset:18432
    ds_read_b128 v[120:123], v14 offset:19456
    ds_read_b128 v[124:127], v14 offset:20480
    ds_read_b128 v[128:131], v14 offset:21504
    ds_read_b128 v[132:135], v14 offset:22528
    ds_read_b128 v[136:139], v14 offset:23552
    ds_read_b128 v[140:143], v14 offset:24576
    ds_read_b128 v[144:147], v14 offset:25600
    s_waitcnt lgkmcnt(4)
    v_mfma_f32_16x16x32_bf16 v[184:187], v[112:115], v[96:99], 0
    ds_read_b64_tr_b16 v[104:105], v18 offset:34816
    v_mfma_f32_16x16x32_bf16 v[220:223], v[112:115], v[100:103], 0
    ds_read_b64_tr_b16 v[106:107], v18 offset:38912
    v_mfma_f32_16x16x32_bf16 v[188:191], v[116:119], v[96:99], 0
    ds_read_b128 v[148:151], v14 offset:34816
    v_mfma_f32_16x16x32_bf16 v[224:227], v[116:119], v[100:103], 0
    ds_read_b64_tr_b16 v[108:109], v19 offset:34816
    v_mfma_f32_16x16x32_bf16 v[192:195], v[120:123], v[96:99], 0
    ds_read_b64_tr_b16 v[110:111], v19 offset:38912
    v_mfma_f32_16x16x32_bf16 v[228:231], v[120:123], v[100:103], 0
    ds_read_b128 v[152:155], v14 offset:35840
    v_mfma_f32_16x16x32_bf16 v[196:199], v[124:127], v[96:99], 0
    ds_read_b128 v[156:159], v14 offset:36864
    v_mfma_f32_16x16x32_bf16 v[232:235], v[124:127], v[100:103], 0
    ds_read_b128 v[160:163], v14 offset:37888
    v_mfma_f32_16x16x32_bf16 v[200:203], v[128:131], v[96:99], 0
    ds_read_b128 v[164:167], v14 offset:38912
    s_waitcnt lgkmcnt(9)
    v_mfma_f32_16x16x32_bf16 v[236:239], v[128:131], v[100:103], 0
    ds_read_b128 v[168:171], v14 offset:39936
    v_mfma_f32_16x16x32_bf16 v[204:207], v[132:135], v[96:99], 0
    ds_read_b128 v[172:175], v14 offset:40960
    v_mfma_f32_16x16x32_bf16 v[240:243], v[132:135], v[100:103], 0
    ds_read_b128 v[176:179], v14 offset:41984
    v_mfma_f32_16x16x32_bf16 v[208:211], v[136:139], v[96:99], 0
    ds_read_b128 v[180:183], v14 offset:43008
    v_mfma_f32_16x16x32_bf16 v[244:247], v[136:139], v[100:103], 0
    v_mfma_f32_16x16x32_bf16 v[212:215], v[140:143], v[96:99], 0
    v_mfma_f32_16x16x32_bf16 v[248:251], v[140:143], v[100:103], 0
    v_mfma_f32_16x16x32_bf16 v[216:219], v[144:147], v[96:99], 0
    v_mfma_f32_16x16x32_bf16 v[252:255], v[144:147], v[100:103], 0
    s_waitcnt lgkmcnt(4)
    v_mfma_f32_16x16x32_bf16 v[184:187], v[148:151], v[104:107], v[184:187]
    ds_read_b64_tr_b16 v[96:97], v20 offset:0
    v_mfma_f32_16x16x32_bf16 v[220:223], v[148:151], v[108:111], v[220:223]
    ds_read_b64_tr_b16 v[98:99], v20 offset:4096
    v_mfma_f32_16x16x32_bf16 v[188:191], v[152:155], v[104:107], v[188:191]
    ds_read_b128 v[112:115], v15 offset:0
    v_mfma_f32_16x16x32_bf16 v[224:227], v[152:155], v[108:111], v[224:227]
    ds_read_b64_tr_b16 v[100:101], v21 offset:0
    v_mfma_f32_16x16x32_bf16 v[192:195], v[156:159], v[104:107], v[192:195]
    ds_read_b64_tr_b16 v[102:103], v21 offset:4096
    v_mfma_f32_16x16x32_bf16 v[228:231], v[156:159], v[108:111], v[228:231]
    ds_read_b128 v[116:119], v15 offset:1024
    v_mfma_f32_16x16x32_bf16 v[196:199], v[160:163], v[104:107], v[196:199]
    ds_read_b128 v[120:123], v15 offset:2048
    v_mfma_f32_16x16x32_bf16 v[232:235], v[160:163], v[108:111], v[232:235]
    ds_read_b128 v[124:127], v15 offset:3072
    v_mfma_f32_16x16x32_bf16 v[200:203], v[164:167], v[104:107], v[200:203]
    ds_read_b128 v[128:131], v15 offset:4096
    s_waitcnt lgkmcnt(9)
    v_mfma_f32_16x16x32_bf16 v[236:239], v[164:167], v[108:111], v[236:239]
    ds_read_b128 v[132:135], v15 offset:5120
    v_mfma_f32_16x16x32_bf16 v[204:207], v[168:171], v[104:107], v[204:207]
    ds_read_b128 v[136:139], v15 offset:6144
    v_mfma_f32_16x16x32_bf16 v[240:243], v[168:171], v[108:111], v[240:243]
    ds_read_b128 v[140:143], v15 offset:7168
    v_mfma_f32_16x16x32_bf16 v[208:211], v[172:175], v[104:107], v[208:211]
    ds_read_b128 v[144:147], v15 offset:8192
    v_mfma_f32_16x16x32_bf16 v[244:247], v[172:175], v[108:111], v[244:247]
    v_mfma_f32_16x16x32_bf16 v[212:215], v[176:179], v[104:107], v[212:215]
    v_mfma_f32_16x16x32_bf16 v[248:251], v[176:179], v[108:111], v[248:251]
    v_mfma_f32_16x16x32_bf16 v[216:219], v[180:183], v[104:107], v[216:219]
    v_mfma_f32_16x16x32_bf16 v[252:255], v[180:183], v[108:111], v[252:255]
    s_waitcnt lgkmcnt(4)
    v_mfma_f32_16x16x32_bf16 v[184:187], v[112:115], v[96:99], v[184:187]
    ds_read_b64_tr_b16 v[104:105], v20 offset:17408
    v_mfma_f32_16x16x32_bf16 v[220:223], v[112:115], v[100:103], v[220:223]
    ds_read_b64_tr_b16 v[106:107], v20 offset:21504
    v_mfma_f32_16x16x32_bf16 v[188:191], v[116:119], v[96:99], v[188:191]
    ds_read_b128 v[148:151], v15 offset:17408
    v_mfma_f32_16x16x32_bf16 v[224:227], v[116:119], v[100:103], v[224:227]
    ds_read_b64_tr_b16 v[108:109], v21 offset:17408
    v_mfma_f32_16x16x32_bf16 v[192:195], v[120:123], v[96:99], v[192:195]
    ds_read_b64_tr_b16 v[110:111], v21 offset:21504
    v_mfma_f32_16x16x32_bf16 v[228:231], v[120:123], v[100:103], v[228:231]
    ds_read_b128 v[152:155], v15 offset:18432
    v_mfma_f32_16x16x32_bf16 v[196:199], v[124:127], v[96:99], v[196:199]
    ds_read_b128 v[156:159], v15 offset:19456
    v_mfma_f32_16x16x32_bf16 v[232:235], v[124:127], v[100:103], v[232:235]
    ds_read_b128 v[160:163], v15 offset:20480
    v_mfma_f32_16x16x32_bf16 v[200:203], v[128:131], v[96:99], v[200:203]
    ds_read_b128 v[164:167], v15 offset:21504
    s_waitcnt lgkmcnt(9)
    v_mfma_f32_16x16x32_bf16 v[236:239], v[128:131], v[100:103], v[236:239]
    ds_read_b128 v[168:171], v15 offset:22528
    v_mfma_f32_16x16x32_bf16 v[204:207], v[132:135], v[96:99], v[204:207]
    ds_read_b128 v[172:175], v15 offset:23552
    v_mfma_f32_16x16x32_bf16 v[240:243], v[132:135], v[100:103], v[240:243]
    ds_read_b128 v[176:179], v15 offset:24576
    v_mfma_f32_16x16x32_bf16 v[208:211], v[136:139], v[96:99], v[208:211]
    ds_read_b128 v[180:183], v15 offset:25600
    v_mfma_f32_16x16x32_bf16 v[244:247], v[136:139], v[100:103], v[244:247]
    v_mfma_f32_16x16x32_bf16 v[212:215], v[140:143], v[96:99], v[212:215]
    v_mfma_f32_16x16x32_bf16 v[248:251], v[140:143], v[100:103], v[248:251]
    v_mfma_f32_16x16x32_bf16 v[216:219], v[144:147], v[96:99], v[216:219]
    v_mfma_f32_16x16x32_bf16 v[252:255], v[144:147], v[100:103], v[252:255]
    s_waitcnt lgkmcnt(4)
    v_mfma_f32_16x16x32_bf16 v[184:187], v[148:151], v[104:107], v[184:187]
    ds_read_b64_tr_b16 v[96:97], v20 offset:34816
    v_mfma_f32_16x16x32_bf16 v[220:223], v[148:151], v[108:111], v[220:223]
    ds_read_b64_tr_b16 v[98:99], v20 offset:38912
    v_mfma_f32_16x16x32_bf16 v[188:191], v[152:155], v[104:107], v[188:191]
    ds_read_b128 v[112:115], v15 offset:34816
    v_mfma_f32_16x16x32_bf16 v[224:227], v[152:155], v[108:111], v[224:227]
    ds_read_b64_tr_b16 v[100:101], v21 offset:34816
    v_mfma_f32_16x16x32_bf16 v[192:195], v[156:159], v[104:107], v[192:195]
    ds_read_b64_tr_b16 v[102:103], v21 offset:38912
    v_mfma_f32_16x16x32_bf16 v[228:231], v[156:159], v[108:111], v[228:231]
    ds_read_b128 v[116:119], v15 offset:35840
    v_mfma_f32_16x16x32_bf16 v[196:199], v[160:163], v[104:107], v[196:199]
    ds_read_b128 v[120:123], v15 offset:36864
    v_mfma_f32_16x16x32_bf16 v[232:235], v[160:163], v[108:111], v[232:235]
    ds_read_b128 v[124:127], v15 offset:37888
    v_mfma_f32_16x16x32_bf16 v[200:203], v[164:167], v[104:107], v[200:203]
    ds_read_b128 v[128:131], v15 offset:38912
    s_waitcnt lgkmcnt(9)
    v_mfma_f32_16x16x32_bf16 v[236:239], v[164:167], v[108:111], v[236:239]
    ds_read_b128 v[132:135], v15 offset:39936
    v_mfma_f32_16x16x32_bf16 v[204:207], v[168:171], v[104:107], v[204:207]
    ds_read_b128 v[136:139], v15 offset:40960
    v_mfma_f32_16x16x32_bf16 v[240:243], v[168:171], v[108:111], v[240:243]
    ds_read_b128 v[140:143], v15 offset:41984
    v_mfma_f32_16x16x32_bf16 v[208:211], v[172:175], v[104:107], v[208:211]
    ds_read_b128 v[144:147], v15 offset:43008
    v_mfma_f32_16x16x32_bf16 v[244:247], v[172:175], v[108:111], v[244:247]
    v_mfma_f32_16x16x32_bf16 v[212:215], v[176:179], v[104:107], v[212:215]
    v_mfma_f32_16x16x32_bf16 v[248:251], v[176:179], v[108:111], v[248:251]
    v_mfma_f32_16x16x32_bf16 v[216:219], v[180:183], v[104:107], v[216:219]
    s_cmp_lt_u32 s33, 2
    v_mfma_f32_16x16x32_bf16 v[252:255], v[180:183], v[108:111], v[252:255]
    s_cbranch_scc1 m_B_zc
    s_waitcnt lgkmcnt(4)
    v_mfma_f32_16x16x32_bf16 v[184:187], v[112:115], v[96:99], v[184:187]
    v_mfma_f32_16x16x32_bf16 v[220:223], v[112:115], v[100:103], v[220:223]
    v_mfma_f32_16x16x32_bf16 v[188:191], v[116:119], v[96:99], v[188:191]
    v_mfma_f32_16x16x32_bf16 v[224:227], v[116:119], v[100:103], v[224:227]
    v_mfma_f32_16x16x32_bf16 v[192:195], v[120:123], v[96:99], v[192:195]
    v_mfma_f32_16x16x32_bf16 v[228:231], v[120:123], v[100:103], v[228:231]
    v_mfma_f32_16x16x32_bf16 v[196:199], v[124:127], v[96:99], v[196:199]
    v_mfma_f32_16x16x32_bf16 v[232:235], v[124:127], v[100:103], v[232:235]
    v_mfma_f32_16x16x32_bf16 v[200:203], v[128:131], v[96:99], v[200:203]
    s_waitcnt lgkmcnt(0)
    v_mfma_f32_16x16x32_bf16 v[236:239], v[128:131], v[100:103], v[236:239]
    v_mfma_f32_16x16x32_bf16 v[204:207], v[132:135], v[96:99], v[204:207]
    v_mfma_f32_16x16x32_bf16 v[240:243], v[132:135], v[100:103], v[240:243]
    v_mfma_f32_16x16x32_bf16 v[208:211], v[136:139], v[96:99], v[208:211]
    v_mfma_f32_16x16x32_bf16 v[244:247], v[136:139], v[100:103], v[244:247]
    v_mfma_f32_16x16x32_bf16 v[212:215], v[140:143], v[96:99], v[212:215]
    v_mfma_f32_16x16x32_bf16 v[248:251], v[140:143], v[100:103], v[248:251]
    v_mfma_f32_16x16x32_bf16 v[216:219], v[144:147], v[96:99], v[216:219]
    v_mfma_f32_16x16x32_bf16 v[252:255], v[144:147], v[100:103], v[252:255]
m_B_zc:
    s_nop 7
    v_pk_mul_f32 v[184:185], v[184:185], v[6:7] op_sel:[0,0] op_sel_hi:[1,0]
    v_pk_mul_f32 v[186:187], v[186:187], v[6:7] op_sel:[0,0] op_sel_hi:[1,0]
    v_pk_mul_f32 v[220:221], v[220:221], v[6:7] op_sel:[0,1] op_sel_hi:[1,1]
    v_pk_mul_f32 v[222:223], v[222:223], v[6:7] op_sel:[0,1] op_sel_hi:[1,1]
    v_pk_mul_f32 v[188:189], v[188:189], v[6:7] op_sel:[0,0] op_sel_hi:[1,0]
    v_pk_mul_f32 v[190:191], v[190:191], v[6:7] op_sel:[0,0] op_sel_hi:[1,0]
    v_pk_mul_f32 v[224:225], v[224:225], v[6:7] op_sel:[0,1] op_sel_hi:[1,1]
    v_pk_mul_f32 v[226:227], v[226:227], v[6:7] op_sel:[0,1] op_sel_hi:[1,1]
    v_pk_mul_f32 v[192:193], v[192:193], v[6:7] op_sel:[0,0] op_sel_hi:[1,0]
    v_pk_mul_f32 v[194:195], v[194:195], v[6:7] op_sel:[0,0] op_sel_hi:[1,0]
    v_pk_mul_f32 v[228:229], v[228:229], v[6:7] op_sel:[0,1] op_sel_hi:[1,1]
    v_pk_mul_f32 v[230:231], v[230:231], v[6:7] op_sel:[0,1] op_sel_hi:[1,1]
    v_pk_mul_f32 v[196:197], v[196:197], v[6:7] op_sel:[0,0] op_sel_hi:[1,0]
    v_pk_mul_f32 v[198:199], v[198:199], v[6:7] op_sel:[0,0] op_sel_hi:[1,0]
    v_pk_mul_f32 v[232:233], v[232:233], v[6:7] op_sel:[0,1] op_sel_hi:[1,1]
    v_pk_mul_f32 v[234:235], v[234:235], v[6:7] op_sel:[0,1] op_sel_hi:[1,1]
    v_pk_mul_f32 v[200:201], v[200:201], v[6:7] op_sel:[0,0] op_sel_hi:[1,0]
    v_pk_mul_f32 v[202:203], v[202:203], v[6:7] op_sel:[0,0] op_sel_hi:[1,0]
    v_pk_mul_f32 v[236:237], v[236:237], v[6:7] op_sel:[0,1] op_sel_hi:[1,1]
    v_pk_mul_f32 v[238:239], v[238:239], v[6:7] op_sel:[0,1] op_sel_hi:[1,1]
    v_pk_mul_f32 v[204:205], v[204:205], v[6:7] op_sel:[0,0] op_sel_hi:[1,0]
    v_pk_mul_f32 v[206:207], v[206:207], v[6:7] op_sel:[0,0] op_sel_hi:[1,0]
    v_pk_mul_f32 v[240:241], v[240:241], v[6:7] op_sel:[0,1] op_sel_hi:[1,1]
    v_pk_mul_f32 v[242:243], v[242:243], v[6:7] op_sel:[0,1] op_sel_hi:[1,1]
    v_pk_mul_f32 v[208:209], v[208:209], v[6:7] op_sel:[0,0] op_sel_hi:[1,0]
    v_pk_mul_f32 v[210:211], v[210:211], v[6:7] op_sel:[0,0] op_sel_hi:[1,0]
    v_pk_mul_f32 v[244:245], v[244:245], v[6:7] op_sel:[0,1] op_sel_hi:[1,1]
    v_pk_mul_f32 v[246:247], v[246:247], v[6:7] op_sel:[0,1] op_sel_hi:[1,1]
    v_pk_mul_f32 v[212:213], v[212:213], v[6:7] op_sel:[0,0] op_sel_hi:[1,0]
    v_pk_mul_f32 v[214:215], v[214:215], v[6:7] op_sel:[0,0] op_sel_hi:[1,0]
    v_pk_mul_f32 v[248:249], v[248:249], v[6:7] op_sel:[0,1] op_sel_hi:[1,1]
    v_pk_mul_f32 v[250:251], v[250:251], v[6:7] op_sel:[0,1] op_sel_hi:[1,1]
    v_pk_mul_f32 v[216:217], v[216:217], v[6:7] op_sel:[0,0] op_sel_hi:[1,0]
    v_pk_mul_f32 v[218:219], v[218:219], v[6:7] op_sel:[0,0] op_sel_hi:[1,0]
    v_pk_mul_f32 v[252:253], v[252:253], v[6:7] op_sel:[0,1] op_sel_hi:[1,1]
    v_pk_mul_f32 v[254:255], v[254:255], v[6:7] op_sel:[0,1] op_sel_hi:[1,1]
    s_barrier
    ds_read_b64_tr_b16 v[96:97], v16 offset:0
    ds_read_b64_tr_b16 v[98:99], v16 offset:4096
    ds_read_b128 v[112:115], v13 offset:0
    ds_read_b64_tr_b16 v[100:101], v17 offset:0
    ds_read_b64_tr_b16 v[102:103], v17 offset:4096
    ds_read_b128 v[116:119], v13 offset:1024
    ds_read_b128 v[120:123], v13 offset:2048
    ds_read_b128 v[124:127], v13 offset:3072
    ds_read_b128 v[128:131], v13 offset:4096
    ds_read_b128 v[132:135], v13 offset:5120
    ds_read_b128 v[136:139], v13 offset:6144
    ds_read_b128 v[140:143], v13 offset:7168
    ds_read_b128 v[144:147], v13 offset:8192
    s_mov_b32 s21, s18
    s_waitcnt lgkmcnt(4)
    v_mfma_f32_16x16x32_bf16 v[24:27], v[112:115], v[96:99], v[24:27]
    ds_read_b64_tr_b16 v[104:105], v16 offset:17408
    v_mfma_f32_16x16x32_bf16 v[60:63], v[112:115], v[100:103], v[60:63]
    ds_read_b64_tr_b16 v[106:107], v16 offset:21504
    v_mfma_f32_16x16x32_bf16 v[28:31], v[116:119], v[96:99], v[28:31]
    ds_read_b128 v[148:151], v13 offset:17408
    v_mfma_f32_16x16x32_bf16 v[64:67], v[116:119], v[100:103], v[64:67]
    ds_read_b64_tr_b16 v[108:109], v17 offset:17408
    v_mfma_f32_16x16x32_bf16 v[32:35], v[120:123], v[96:99], v[32:35]
    ds_read_b64_tr_b16 v[110:111], v17 offset:21504
    v_mfma_f32_16x16x32_bf16 v[68:71], v[120:123], v[100:103], v[68:71]
    ds_read_b128 v[152:155], v13 offset:18432
    v_mfma_f32_16x16x32_bf16 v[36:39], v[124:127], v[96:99], v[36:39]
    ds_read_b128 v[156:159], v13 offset:19456
    v_mfma_f32_16x16x32_bf16 v[72:75], v[124:127], v[100:103], v[72:75]
    ds_read_b128 v[160:163], v13 offset:20480
    v_mfma_f32_16x16x32_bf16 v[40:43], v[128:131], v[96:99], v[40:43]
    ds_read_b128 v[164:167], v13 offset:21504
    s_waitcnt lgkmcnt(9)
    v_mfma_f32_16x16x32_bf16 v[76:79], v[128:131], v[100:103], v[76:79]
    ds_read_b128 v[168:171], v13 offset:22528
    v_mfma_f32_16x16x32_bf16 v[44:47], v[132:135], v[96:99], v[44:47]
    ds_read_b128 v[172:175], v13 offset:23552
    v_mfma_f32_16x16x32_bf16 v[80:83], v[132:135], v[100:103], v[80:83]
    ds_read_b128 v[176:179], v13 offset:24576
    v_mfma_f32_16x16x32_bf16 v[48:51], v[136:139], v[96:99], v[48:51]
    ds_read_b128 v[180:183], v13 offset:25600
    v_mfma_f32_16x16x32_bf16 v[84:87], v[136:139], v[100:103], v[84:87]
    v_mfma_f32_16x16x32_bf16 v[52:55], v[140:143], v[96:99], v[52:55]
    v_mfma_f32_16x16x32_bf16 v[88:91], v[140:143], v[100:103], v[88:91]
    v_mfma_f32_16x16x32_bf16 v[56:59], v[144:147], v[96:99], v[56:59]
    v_mfma_f32_16x16x32_bf16 v[92:95], v[144:147], v[100:103], v[92:95]
    s_branch m_B_c1_67
m_B_cl_65:
    s_waitcnt lgkmcnt(4)
    v_mfma_f32_16x16x32_bf16 v[24:27], v[112:115], v[96:99], v[24:27]
    s_barrier
    ds_read_b64_tr_b16 v[104:105], v16 offset:17408
    v_mfma_f32_16x16x32_bf16 v[60:63], v[112:115], v[100:103], v[60:63]
    ds_read_b64_tr_b16 v[106:107], v16 offset:21504
    v_mfma_f32_16x16x32_bf16 v[28:31], v[116:119], v[96:99], v[28:31]
    ds_read_b128 v[148:151], v13 offset:17408
    v_mfma_f32_16x16x32_bf16 v[64:67], v[116:119], v[100:103], v[64:67]
    ds_read_b64_tr_b16 v[108:109], v17 offset:17408
    v_mfma_f32_16x16x32_bf16 v[32:35], v[120:123], v[96:99], v[32:35]
    ds_read_b64_tr_b16 v[110:111], v17 offset:21504
    v_mfma_f32_16x16x32_bf16 v[68:71], v[120:123], v[100:103], v[68:71]
    ds_read_b128 v[152:155], v13 offset:18432
    v_mfma_f32_16x16x32_bf16 v[36:39], v[124:127], v[96:99], v[36:39]
    ds_read_b128 v[156:159], v13 offset:19456
    v_mfma_f32_16x16x32_bf16 v[72:75], v[124:127], v[100:103], v[72:75]
    ds_read_b128 v[160:163], v13 offset:20480
    v_mfma_f32_16x16x32_bf16 v[40:43], v[128:131], v[96:99], v[40:43]
    ds_read_b128 v[164:167], v13 offset:21504
    s_waitcnt lgkmcnt(9)
    v_mfma_f32_16x16x32_bf16 v[76:79], v[128:131], v[100:103], v[76:79]
    ds_read_b128 v[168:171], v13 offset:22528
    v_mfma_f32_16x16x32_bf16 v[44:47], v[132:135], v[96:99], v[44:47]
    ds_read_b128 v[172:175], v13 offset:23552
    v_mfma_f32_16x16x32_bf16 v[80:83], v[132:135], v[100:103], v[80:83]
    ds_read_b128 v[176:179], v13 offset:24576
    v_mfma_f32_16x16x32_bf16 v[48:51], v[136:139], v[96:99], v[48:51]
    ds_read_b128 v[180:183], v13 offset:25600
    v_mfma_f32_16x16x32_bf16 v[84:87], v[136:139], v[100:103], v[84:87]
    v_mfma_f32_16x16x32_bf16 v[52:55], v[140:143], v[96:99], v[52:55]
    v_mfma_f32_16x16x32_bf16 v[88:91], v[140:143], v[100:103], v[88:91]
    v_mfma_f32_16x16x32_bf16 v[56:59], v[144:147], v[96:99], v[56:59]
    v_mfma_f32_16x16x32_bf16 v[92:95], v[144:147], v[100:103], v[92:95]
m_B_c1_67:
    s_waitcnt lgkmcnt(4)
    v_mfma_f32_16x16x32_bf16 v[24:27], v[148:151], v[104:107], v[24:27]
    s_barrier
    ds_read_b64_tr_b16 v[96:97], v16 offset:34816
    v_mfma_f32_16x16x32_bf16 v[60:63], v[148:151], v[108:111], v[60:63]
    ds_read_b64_tr_b16 v[98:99], v16 offset:38912
    v_mfma_f32_16x16x32_bf16 v[28:31], v[152:155], v[104:107], v[28:31]
    ds_read_b128 v[112:115], v13 offset:34816
    v_mfma_f32_16x16x32_bf16 v[64:67], v[152:155], v[108:111], v[64:67]
    ds_read_b64_tr_b16 v[100:101], v17 offset:34816
    v_mfma_f32_16x16x32_bf16 v[32:35], v[156:159], v[104:107], v[32:35]
    ds_read_b64_tr_b16 v[102:103], v17 offset:38912
    v_mfma_f32_16x16x32_bf16 v[68:71], v[156:159], v[108:111], v[68:71]
    ds_read_b128 v[116:119], v13 offset:35840
    v_mfma_f32_16x16x32_bf16 v[36:39], v[160:163], v[104:107], v[36:39]
    ds_read_b128 v[120:123], v13 offset:36864
    v_mfma_f32_16x16x32_bf16 v[72:75], v[160:163], v[108:111], v[72:75]
    ds_read_b128 v[124:127], v13 offset:37888
    v_mfma_f32_16x16x32_bf16 v[40:43], v[164:167], v[104:107], v[40:43]
    ds_read_b128 v[128:131], v13 offset:38912
    s_waitcnt lgkmcnt(9)
    v_mfma_f32_16x16x32_bf16 v[76:79], v[164:167], v[108:111], v[76:79]
    ds_read_b128 v[132:135], v13 offset:39936
    v_mfma_f32_16x16x32_bf16 v[44:47], v[168:171], v[104:107], v[44:47]
    ds_read_b128 v[136:139], v13 offset:40960
    v_mfma_f32_16x16x32_bf16 v[80:83], v[168:171], v[108:111], v[80:83]
    ds_read_b128 v[140:143], v13 offset:41984
    v_mfma_f32_16x16x32_bf16 v[48:51], v[172:175], v[104:107], v[48:51]
    ds_read_b128 v[144:147], v13 offset:43008
    v_mfma_f32_16x16x32_bf16 v[84:87], v[172:175], v[108:111], v[84:87]
    v_mfma_f32_16x16x32_bf16 v[52:55], v[176:179], v[104:107], v[52:55]
    v_mfma_f32_16x16x32_bf16 v[88:91], v[176:179], v[108:111], v[88:91]
    v_mfma_f32_16x16x32_bf16 v[56:59], v[180:183], v[104:107], v[56:59]
    v_mfma_f32_16x16x32_bf16 v[92:95], v[180:183], v[108:111], v[92:95]
    s_waitcnt lgkmcnt(4)
    v_mfma_f32_16x16x32_bf16 v[24:27], v[112:115], v[96:99], v[24:27]
    s_barrier
    ds_read_b64_tr_b16 v[104:105], v18 offset:0
    v_mfma_f32_16x16x32_bf16 v[60:63], v[112:115], v[100:103], v[60:63]
    ds_read_b64_tr_b16 v[106:107], v18 offset:4096
    v_mfma_f32_16x16x32_bf16 v[28:31], v[116:119], v[96:99], v[28:31]
    ds_read_b128 v[148:151], v14 offset:0
    v_mfma_f32_16x16x32_bf16 v[64:67], v[116:119], v[100:103], v[64:67]
    ds_read_b64_tr_b16 v[108:109], v19 offset:0
    v_mfma_f32_16x16x32_bf16 v[32:35], v[120:123], v[96:99], v[32:35]
    ds_read_b64_tr_b16 v[110:111], v19 offset:4096
    v_mfma_f32_16x16x32_bf16 v[68:71], v[120:123], v[100:103], v[68:71]
    ds_read_b128 v[152:155], v14 offset:1024
    v_mfma_f32_16x16x32_bf16 v[36:39], v[124:127], v[96:99], v[36:39]
    ds_read_b128 v[156:159], v14 offset:2048
    v_mfma_f32_16x16x32_bf16 v[72:75], v[124:127], v[100:103], v[72:75]
    ds_read_b128 v[160:163], v14 offset:3072
    v_mfma_f32_16x16x32_bf16 v[40:43], v[128:131], v[96:99], v[40:43]
    ds_read_b128 v[164:167], v14 offset:4096
    s_waitcnt lgkmcnt(9)
    v_mfma_f32_16x16x32_bf16 v[76:79], v[128:131], v[100:103], v[76:79]
    ds_read_b128 v[168:171], v14 offset:5120
    v_mfma_f32_16x16x32_bf16 v[44:47], v[132:135], v[96:99], v[44:47]
    ds_read_b128 v[172:175], v14 offset:6144
    v_mfma_f32_16x16x32_bf16 v[80:83], v[132:135], v[100:103], v[80:83]
    ds_read_b128 v[176:179], v14 offset:7168
    v_mfma_f32_16x16x32_bf16 v[48:51], v[136:139], v[96:99], v[48:51]
    ds_read_b128 v[180:183], v14 offset:8192
    v_mfma_f32_16x16x32_bf16 v[84:87], v[136:139], v[100:103], v[84:87]
    v_mfma_f32_16x16x32_bf16 v[52:55], v[140:143], v[96:99], v[52:55]
    v_mfma_f32_16x16x32_bf16 v[88:91], v[140:143], v[100:103], v[88:91]
    v_mfma_f32_16x16x32_bf16 v[56:59], v[144:147], v[96:99], v[56:59]
    v_mfma_f32_16x16x32_bf16 v[92:95], v[144:147], v[100:103], v[92:95]
    s_waitcnt lgkmcnt(4)
    v_mfma_f32_16x16x32_bf16 v[24:27], v[148:151], v[104:107], v[24:27]
    s_barrier
    ds_read_b64_tr_b16 v[96:97], v18 offset:17408
    v_mfma_f32_16x16x32_bf16 v[60:63], v[148:151], v[108:111], v[60:63]
    ds_read_b64_tr_b16 v[98:99], v18 offset:21504
    v_mfma_f32_16x16x32_bf16 v[28:31], v[152:155], v[104:107], v[28:31]
    ds_read_b128 v[112:115], v14 offset:17408
    v_mfma_f32_16x16x32_bf16 v[64:67], v[152:155], v[108:111], v[64:67]
    ds_read_b64_tr_b16 v[100:101], v19 offset:17408
    v_mfma_f32_16x16x32_bf16 v[32:35], v[156:159], v[104:107], v[32:35]
    ds_read_b64_tr_b16 v[102:103], v19 offset:21504
    v_mfma_f32_16x16x32_bf16 v[68:71], v[156:159], v[108:111], v[68:71]
    ds_read_b128 v[116:119], v14 offset:18432
    v_mfma_f32_16x16x32_bf16 v[36:39], v[160:163], v[104:107], v[36:39]
    ds_read_b128 v[120:123], v14 offset:19456
    v_mfma_f32_16x16x32_bf16 v[72:75], v[160:163], v[108:111], v[72:75]
    ds_read_b128 v[124:127], v14 offset:20480
    v_mfma_f32_16x16x32_bf16 v[40:43], v[164:167], v[104:107], v[40:43]
    ds_read_b128 v[128:131], v14 offset:21504
    s_waitcnt lgkmcnt(9)
    v_mfma_f32_16x16x32_bf16 v[76:79], v[164:167], v[108:111], v[76:79]
    ds_read_b128 v[132:135], v14 offset:22528
    v_mfma_f32_16x16x32_bf16 v[44:47], v[168:171], v[104:107], v[44:47]
    ds_read_b128 v[136:139], v14 offset:23552
    v_mfma_f32_16x16x32_bf16 v[80:83], v[168:171], v[108:111], v[80:83]
    ds_read_b128 v[140:143], v14 offset:24576
    v_mfma_f32_16x16x32_bf16 v[48:51], v[172:175], v[104:107], v[48:51]
    ds_read_b128 v[144:147], v14 offset:25600
    v_mfma_f32_16x16x32_bf16 v[84:87], v[172:175], v[108:111], v[84:87]
    v_mfma_f32_16x16x32_bf16 v[52:55], v[176:179], v[104:107], v[52:55]
    v_mfma_f32_16x16x32_bf16 v[88:91], v[176:179], v[108:111], v[88:91]
    v_mfma_f32_16x16x32_bf16 v[56:59], v[180:183], v[104:107], v[56:59]
    s_cmp_eq_u32 s21, 4
    v_mfma_f32_16x16x32_bf16 v[92:95], v[180:183], v[108:111], v[92:95]
    s_cbranch_scc1 m_B_cd_66
    s_waitcnt lgkmcnt(4)
    v_mfma_f32_16x16x32_bf16 v[24:27], v[112:115], v[96:99], v[24:27]
    s_barrier
    ds_read_b64_tr_b16 v[104:105], v18 offset:34816
    v_mfma_f32_16x16x32_bf16 v[60:63], v[112:115], v[100:103], v[60:63]
    ds_read_b64_tr_b16 v[106:107], v18 offset:38912
    v_mfma_f32_16x16x32_bf16 v[28:31], v[116:119], v[96:99], v[28:31]
    ds_read_b128 v[148:151], v14 offset:34816
    v_mfma_f32_16x16x32_bf16 v[64:67], v[116:119], v[100:103], v[64:67]
    ds_read_b64_tr_b16 v[108:109], v19 offset:34816
    v_mfma_f32_16x16x32_bf16 v[32:35], v[120:123], v[96:99], v[32:35]
    ds_read_b64_tr_b16 v[110:111], v19 offset:38912
    v_mfma_f32_16x16x32_bf16 v[68:71], v[120:123], v[100:103], v[68:71]
    ds_read_b128 v[152:155], v14 offset:35840
    v_mfma_f32_16x16x32_bf16 v[36:39], v[124:127], v[96:99], v[36:39]
    ds_read_b128 v[156:159], v14 offset:36864
    v_mfma_f32_16x16x32_bf16 v[72:75], v[124:127], v[100:103], v[72:75]
    ds_read_b128 v[160:163], v14 offset:37888
    v_mfma_f32_16x16x32_bf16 v[40:43], v[128:131], v[96:99], v[40:43]
    ds_read_b128 v[164:167], v14 offset:38912
    s_waitcnt lgkmcnt(9)
    v_mfma_f32_16x16x32_bf16 v[76:79], v[128:131], v[100:103], v[76:79]
    ds_read_b128 v[168:171], v14 offset:39936
    v_mfma_f32_16x16x32_bf16 v[44:47], v[132:135], v[96:99], v[44:47]
    ds_read_b128 v[172:175], v14 offset:40960
    v_mfma_f32_16x16x32_bf16 v[80:83], v[132:135], v[100:103], v[80:83]
    ds_read_b128 v[176:179], v14 offset:41984
    v_mfma_f32_16x16x32_bf16 v[48:51], v[136:139], v[96:99], v[48:51]
    ds_read_b128 v[180:183], v14 offset:43008
    v_mfma_f32_16x16x32_bf16 v[84:87], v[136:139], v[100:103], v[84:87]
    v_mfma_f32_16x16x32_bf16 v[52:55], v[140:143], v[96:99], v[52:55]
    v_mfma_f32_16x16x32_bf16 v[88:91], v[140:143], v[100:103], v[88:91]
    v_mfma_f32_16x16x32_bf16 v[56:59], v[144:147], v[96:99], v[56:59]
    v_mfma_f32_16x16x32_bf16 v[92:95], v[144:147], v[100:103], v[92:95]
    s_waitcnt lgkmcnt(4)
    v_mfma_f32_16x16x32_bf16 v[24:27], v[148:151], v[104:107], v[24:27]
    s_barrier
    ds_read_b64_tr_b16 v[96:97], v20 offset:0
    v_mfma_f32_16x16x32_bf16 v[60:63], v[148:151], v[108:111], v[60:63]
    ds_read_b64_tr_b16 v[98:99], v20 offset:4096
    v_mfma_f32_16x16x32_bf16 v[28:31], v[152:155], v[104:107], v[28:31]
    ds_read_b128 v[112:115], v15 offset:0
    v_mfma_f32_16x16x32_bf16 v[64:67], v[152:155], v[108:111], v[64:67]
    ds_read_b64_tr_b16 v[100:101], v21 offset:0
    v_mfma_f32_16x16x32_bf16 v[32:35], v[156:159], v[104:107], v[32:35]
    ds_read_b64_tr_b16 v[102:103], v21 offset:4096
    v_mfma_f32_16x16x32_bf16 v[68:71], v[156:159], v[108:111], v[68:71]
    ds_read_b128 v[116:119], v15 offset:1024
    v_mfma_f32_16x16x32_bf16 v[36:39], v[160:163], v[104:107], v[36:39]
    ds_read_b128 v[120:123], v15 offset:2048
    v_mfma_f32_16x16x32_bf16 v[72:75], v[160:163], v[108:111], v[72:75]
    ds_read_b128 v[124:127], v15 offset:3072
    v_mfma_f32_16x16x32_bf16 v[40:43], v[164:167], v[104:107], v[40:43]
    ds_read_b128 v[128:131], v15 offset:4096
    s_waitcnt lgkmcnt(9)
    v_mfma_f32_16x16x32_bf16 v[76:79], v[164:167], v[108:111], v[76:79]
    ds_read_b128 v[132:135], v15 offset:5120
    v_mfma_f32_16x16x32_bf16 v[44:47], v[168:171], v[104:107], v[44:47]
    ds_read_b128 v[136:139], v15 offset:6144
    v_mfma_f32_16x16x32_bf16 v[80:83], v[168:171], v[108:111], v[80:83]
    ds_read_b128 v[140:143], v15 offset:7168
    v_mfma_f32_16x16x32_bf16 v[48:51], v[172:175], v[104:107], v[48:51]
    ds_read_b128 v[144:147], v15 offset:8192
    v_mfma_f32_16x16x32_bf16 v[84:87], v[172:175], v[108:111], v[84:87]
    v_mfma_f32_16x16x32_bf16 v[52:55], v[176:179], v[104:107], v[52:55]
    v_mfma_f32_16x16x32_bf16 v[88:91], v[176:179], v[108:111], v[88:91]
    v_mfma_f32_16x16x32_bf16 v[56:59], v[180:183], v[104:107], v[56:59]
    v_mfma_f32_16x16x32_bf16 v[92:95], v[180:183], v[108:111], v[92:95]
    s_waitcnt lgkmcnt(4)
    v_mfma_f32_16x16x32_bf16 v[24:27], v[112:115], v[96:99], v[24:27]
    s_barrier
    ds_read_b64_tr_b16 v[104:105], v20 offset:17408
    v_mfma_f32_16x16x32_bf16 v[60:63], v[112:115], v[100:103], v[60:63]
    ds_read_b64_tr_b16 v[106:107], v20 offset:21504
    v_mfma_f32_16x16x32_bf16 v[28:31], v[116:119], v[96:99], v[28:31]
    ds_read_b128 v[148:151], v15 offset:17408
    v_mfma_f32_16x16x32_bf16 v[64:67], v[116:119], v[100:103], v[64:67]
    ds_read_b64_tr_b16 v[108:109], v21 offset:17408
    v_mfma_f32_16x16x32_bf16 v[32:35], v[120:123], v[96:99], v[32:35]
    ds_read_b64_tr_b16 v[110:111], v21 offset:21504
    v_mfma_f32_16x16x32_bf16 v[68:71], v[120:123], v[100:103], v[68:71]
    ds_read_b128 v[152:155], v15 offset:18432
    v_mfma_f32_16x16x32_bf16 v[36:39], v[124:127], v[96:99], v[36:39]
    ds_read_b128 v[156:159], v15 offset:19456
    v_mfma_f32_16x16x32_bf16 v[72:75], v[124:127], v[100:103], v[72:75]
    ds_read_b128 v[160:163], v15 offset:20480
    v_mfma_f32_16x16x32_bf16 v[40:43], v[128:131], v[96:99], v[40:43]
    ds_read_b128 v[164:167], v15 offset:21504
    s_waitcnt lgkmcnt(9)
    v_mfma_f32_16x16x32_bf16 v[76:79], v[128:131], v[100:103], v[76:79]
    ds_read_b128 v[168:171], v15 offset:22528
    v_mfma_f32_16x16x32_bf16 v[44:47], v[132:135], v[96:99], v[44:47]
    ds_read_b128 v[172:175], v15 offset:23552
    v_mfma_f32_16x16x32_bf16 v[80:83], v[132:135], v[100:103], v[80:83]
    ds_read_b128 v[176:179], v15 offset:24576
    v_mfma_f32_16x16x32_bf16 v[48:51], v[136:139], v[96:99], v[48:51]
    ds_read_b128 v[180:183], v15 offset:25600
    v_mfma_f32_16x16x32_bf16 v[84:87], v[136:139], v[100:103], v[84:87]
    v_mfma_f32_16x16x32_bf16 v[52:55], v[140:143], v[96:99], v[52:55]
    v_mfma_f32_16x16x32_bf16 v[88:91], v[140:143], v[100:103], v[88:91]
    v_mfma_f32_16x16x32_bf16 v[56:59], v[144:147], v[96:99], v[56:59]
    v_mfma_f32_16x16x32_bf16 v[92:95], v[144:147], v[100:103], v[92:95]
    s_waitcnt lgkmcnt(4)
    v_mfma_f32_16x16x32_bf16 v[24:27], v[148:151], v[104:107], v[24:27]
    s_barrier
    ds_read_b64_tr_b16 v[96:97], v16 offset:0
    v_mfma_f32_16x16x32_bf16 v[60:63], v[148:151], v[108:111], v[60:63]
    ds_read_b64_tr_b16 v[98:99], v16 offset:4096
    v_mfma_f32_16x16x32_bf16 v[28:31], v[152:155], v[104:107], v[28:31]
    ds_read_b128 v[112:115], v13 offset:0
    v_mfma_f32_16x16x32_bf16 v[64:67], v[152:155], v[108:111], v[64:67]
    ds_read_b64_tr_b16 v[100:101], v17 offset:0
    v_mfma_f32_16x16x32_bf16 v[32:35], v[156:159], v[104:107], v[32:35]
    ds_read_b64_tr_b16 v[102:103], v17 offset:4096
    v_mfma_f32_16x16x32_bf16 v[68:71], v[156:159], v[108:111], v[68:71]
    ds_read_b128 v[116:119], v13 offset:1024
    v_mfma_f32_16x16x32_bf16 v[36:39], v[160:163], v[104:107], v[36:39]
    ds_read_b128 v[120:123], v13 offset:2048
    v_mfma_f32_16x16x32_bf16 v[72:75], v[160:163], v[108:111], v[72:75]
    ds_read_b128 v[124:127], v13 offset:3072
    v_mfma_f32_16x16x32_bf16 v[40:43], v[164:167], v[104:107], v[40:43]
    ds_read_b128 v[128:131], v13 offset:4096
    s_waitcnt lgkmcnt(9)
    v_mfma_f32_16x16x32_bf16 v[76:79], v[164:167], v[108:111], v[76:79]
    ds_read_b128 v[132:135], v13 offset:5120
    v_mfma_f32_16x16x32_bf16 v[44:47], v[168:171], v[104:107], v[44:47]
    ds_read_b128 v[136:139], v13 offset:6144
    v_mfma_f32_16x16x32_bf16 v[80:83], v[168:171], v[108:111], v[80:83]
    ds_read_b128 v[140:143], v13 offset:7168
    v_mfma_f32_16x16x32_bf16 v[48:51], v[172:175], v[104:107], v[48:51]
    ds_read_b128 v[144:147], v13 offset:8192
    v_mfma_f32_16x16x32_bf16 v[84:87], v[172:175], v[108:111], v[84:87]
    v_mfma_f32_16x16x32_bf16 v[52:55], v[176:179], v[104:107], v[52:55]
    v_mfma_f32_16x16x32_bf16 v[88:91], v[176:179], v[108:111], v[88:91]
    s_sub_u32 s21, s21, 8
    v_mfma_f32_16x16x32_bf16 v[56:59], v[180:183], v[104:107], v[56:59]
    s_cmp_lg_u32 s21, 0
    v_mfma_f32_16x16x32_bf16 v[92:95], v[180:183], v[108:111], v[92:95]
    s_cbranch_scc1 m_B_cl_65
m_B_cd_66:
    s_nop 6
    s_waitcnt lgkmcnt(0)
    v_lshlrev_b32 v11, 4, v10
    v_pk_fma_f32 v[32:33], v[32:33], v[2:3], v[192:193]
    v_pk_fma_f32 v[34:35], v[34:35], v[2:3], v[194:195]
    v_pk_fma_f32 v[68:69], v[68:69], v[4:5], v[228:229]
    v_pk_fma_f32 v[70:71], v[70:71], v[4:5], v[230:231]
    v_cvt_pk_bf16_f32 v120, v32, v33
    v_cvt_pk_bf16_f32 v121, v34, v35
    v_cvt_pk_bf16_f32 v122, v68, v69
    v_cvt_pk_bf16_f32 v123, v70, v71
    buffer_store_dwordx4 v[120:123], v11, s[48:51], s4 offen offset:0 sc1
    v_pk_fma_f32 v[36:37], v[36:37], v[2:3], v[196:197]
    v_pk_fma_f32 v[38:39], v[38:39], v[2:3], v[198:199]
    v_pk_fma_f32 v[72:73], v[72:73], v[4:5], v[232:233]
    v_pk_fma_f32 v[74:75], v[74:75], v[4:5], v[234:235]
    v_cvt_pk_bf16_f32 v124, v36, v37
    v_cvt_pk_bf16_f32 v125, v38, v39
    v_cvt_pk_bf16_f32 v126, v72, v73
    v_cvt_pk_bf16_f32 v127, v74, v75
    buffer_store_dwordx4 v[124:127], v11, s[48:51], s4 offen offset:1024 sc1
    v_pk_fma_f32 v[40:41], v[40:41], v[2:3], v[200:201]
    v_pk_fma_f32 v[42:43], v[42:43], v[2:3], v[202:203]
    v_pk_fma_f32 v[76:77], v[76:77], v[4:5], v[236:237]
    v_pk_fma_f32 v[78:79], v[78:79], v[4:5], v[238:239]
    v_cvt_pk_bf16_f32 v128, v40, v41
    v_cvt_pk_bf16_f32 v129, v42, v43
    v_cvt_pk_bf16_f32 v130, v76, v77
    v_cvt_pk_bf16_f32 v131, v78, v79
    buffer_store_dwordx4 v[128:131], v11, s[48:51], s5 offen offset:0 sc1
    v_pk_fma_f32 v[44:45], v[44:45], v[2:3], v[204:205]
    v_pk_fma_f32 v[46:47], v[46:47], v[2:3], v[206:207]
    v_pk_fma_f32 v[80:81], v[80:81], v[4:5], v[240:241]
    v_pk_fma_f32 v[82:83], v[82:83], v[4:5], v[242:243]
    v_cvt_pk_bf16_f32 v132, v44, v45
    v_cvt_pk_bf16_f32 v133, v46, v47
    v_cvt_pk_bf16_f32 v134, v80, v81
    v_cvt_pk_bf16_f32 v135, v82, v83
    buffer_store_dwordx4 v[132:135], v11, s[48:51], s5 offen offset:1024 sc1
    v_pk_fma_f32 v[48:49], v[48:49], v[2:3], v[208:209]
    v_pk_fma_f32 v[50:51], v[50:51], v[2:3], v[210:211]
    v_pk_fma_f32 v[84:85], v[84:85], v[4:5], v[244:245]
    v_pk_fma_f32 v[86:87], v[86:87], v[4:5], v[246:247]
    v_cvt_pk_bf16_f32 v136, v48, v49
    v_cvt_pk_bf16_f32 v137, v50, v51
    v_cvt_pk_bf16_f32 v138, v84, v85
    v_cvt_pk_bf16_f32 v139, v86, v87
    buffer_store_dwordx4 v[136:139], v11, s[48:51], s6 offen offset:0 sc1
    v_pk_fma_f32 v[52:53], v[52:53], v[2:3], v[212:213]
    v_pk_fma_f32 v[54:55], v[54:55], v[2:3], v[214:215]
    v_pk_fma_f32 v[88:89], v[88:89], v[4:5], v[248:249]
    v_pk_fma_f32 v[90:91], v[90:91], v[4:5], v[250:251]
    v_cvt_pk_bf16_f32 v140, v52, v53
    v_cvt_pk_bf16_f32 v141, v54, v55
    v_cvt_pk_bf16_f32 v142, v88, v89
    v_cvt_pk_bf16_f32 v143, v90, v91
    buffer_store_dwordx4 v[140:143], v11, s[48:51], s6 offen offset:1024 sc1
    v_pk_fma_f32 v[56:57], v[56:57], v[2:3], v[216:217]
    v_pk_fma_f32 v[58:59], v[58:59], v[2:3], v[218:219]
    v_pk_fma_f32 v[92:93], v[92:93], v[4:5], v[252:253]
    v_pk_fma_f32 v[94:95], v[94:95], v[4:5], v[254:255]
    s_cmp_eq_u32 s33, s19
    s_cbranch_scc1 m_B_keep
    v_cvt_pk_bf16_f32 v144, v56, v57
    v_cvt_pk_bf16_f32 v145, v58, v59
    v_cvt_pk_bf16_f32 v146, v92, v93
    v_cvt_pk_bf16_f32 v147, v94, v95
    s_sub_u32 s7, s7, 1024
    buffer_store_dwordx4 v[144:147], v11, s[48:51], s7 offen sc1
m_B_keep:
    v_pk_fma_f32 v[24:25], v[24:25], v[2:3], v[184:185]
    v_pk_fma_f32 v[26:27], v[26:27], v[2:3], v[186:187]
    v_pk_fma_f32 v[60:61], v[60:61], v[4:5], v[220:221]
    v_pk_fma_f32 v[62:63], v[62:63], v[4:5], v[222:223]
    v_pk_fma_f32 v[28:29], v[28:29], v[2:3], v[188:189]
    v_pk_fma_f32 v[30:31], v[30:31], v[2:3], v[190:191]
    v_pk_fma_f32 v[64:65], v[64:65], v[4:5], v[224:225]
    v_pk_fma_f32 v[66:67], v[66:67], v[4:5], v[226:227]
    v_and_b32 v98, 15, v10
    v_mul_u32_u24 v98, 1152, v98
    v_and_b32 v12, 48, v10
    v_add_u32 v98, v98, v12
    v_lshlrev_b32 v12, 7, v10
    v_mov_b32 v99, s96
    s_mov_b64 exec, 1
    s_waitcnt vmcnt(0)
    buffer_store_dword v99, off, s[12:15], s17 sc1
    s_mov_b32 exec_lo, s11
    s_mov_b32 s98, 0x80000
m_B_poll:
    v_mov_b32 v96, 0
    buffer_atomic_or v96, v12, s[12:15], s16 offen sc0 sc1
    s_sub_u32 s98, s98, 1
    s_cbranch_scc1 m_B_poll_x
    s_waitcnt vmcnt(0)
    v_cmp_ne_u32 vcc, s96, v96
    s_nop 0
    s_and_b64 exec, exec, vcc
    s_cbranch_scc1 m_B_poll
m_B_poll_x:
    s_mov_b64 exec, -1
    buffer_load_dwordx4 v[148:151], v11, s[48:51], s8 offen offset:0 sc1
    buffer_load_dwordx4 v[152:155], v11, s[48:51], s8 offen offset:1024 sc1
    buffer_load_dwordx4 v[156:159], v11, s[48:51], s9 offen offset:0 sc1
    buffer_load_dwordx4 v[160:163], v11, s[48:51], s9 offen offset:1024 sc1
    buffer_load_dwordx4 v[164:167], v11, s[48:51], s10 offen offset:0 sc1
    buffer_load_dwordx4 v[168:171], v11, s[48:51], s10 offen offset:1024 sc1
    s_cmp_eq_u32 s33, s19
    s_cbranch_scc0 m_B_pair
    buffer_load_dwordx4 v[172:175], v11, s[48:51], s8 offen offset:2048 sc1
    buffer_load_dwordx4 v[176:179], v11, s[48:51], s9 offen offset:2048 sc1
    buffer_load_dwordx4 v[180:183], v11, s[48:51], s10 offen offset:2048 sc1
    s_waitcnt vmcnt(0)
    v_lshlrev_b32 v96, 16, v172
    v_and_b32 v97, 0xffff0000, v172
    v_pk_add_f32 v[56:57], v[56:57], v[96:97]
    v_lshlrev_b32 v96, 16, v173
    v_and_b32 v97, 0xffff0000, v173
    v_pk_add_f32 v[58:59], v[58:59], v[96:97]
    v_lshlrev_b32 v96, 16, v174
    v_and_b32 v97, 0xffff0000, v174
    v_pk_add_f32 v[92:93], v[92:93], v[96:97]
    v_lshlrev_b32 v96, 16, v175
    v_and_b32 v97, 0xffff0000, v175
    v_pk_add_f32 v[94:95], v[94:95], v[96:97]
    v_lshlrev_b32 v96, 16, v176
    v_and_b32 v97, 0xffff0000, v176
    v_pk_add_f32 v[56:57], v[56:57], v[96:97]
    v_lshlrev_b32 v96, 16, v177
    v_and_b32 v97, 0xffff0000, v177
    v_pk_add_f32 v[58:59], v[58:59], v[96:97]
    v_lshlrev_b32 v96, 16, v178
    v_and_b32 v97, 0xffff0000, v178
    v_pk_add_f32 v[92:93], v[92:93], v[96:97]
    v_lshlrev_b32 v96, 16, v179
    v_and_b32 v97, 0xffff0000, v179
    v_pk_add_f32 v[94:95], v[94:95], v[96:97]
    v_lshlrev_b32 v96, 16, v180
    v_and_b32 v97, 0xffff0000, v180
    v_pk_add_f32 v[56:57], v[56:57], v[96:97]
    v_lshlrev_b32 v96, 16, v181
    v_and_b32 v97, 0xffff0000, v181
    v_pk_add_f32 v[58:59], v[58:59], v[96:97]
    v_lshlrev_b32 v96, 16, v182
    v_and_b32 v97, 0xffff0000, v182
    v_pk_add_f32 v[92:93], v[92:93], v[96:97]
    v_lshlrev_b32 v96, 16, v183
    v_and_b32 v97, 0xffff0000, v183
    v_pk_add_f32 v[94:95], v[94:95], v[96:97]
    v_cvt_pk_bf16_f32 v144, v56, v57
    v_cvt_pk_bf16_f32 v145, v58, v59
    v_cvt_pk_bf16_f32 v146, v92, v93
    v_cvt_pk_bf16_f32 v147, v94, v95
    buffer_store_dwordx2 v[144:145], v98, s[56:59], s30 offen
    buffer_store_dwordx2 v[146:147], v98, s[56:59], s31 offen
    s_branch m_B_sum
m_B_pair:
    s_waitcnt vmcnt(0)
m_B_sum:
    v_lshlrev_b32 v96, 16, v148
    v_and_b32 v97, 0xffff0000, v148
    v_pk_add_f32 v[24:25], v[24:25], v[96:97]
    v_lshlrev_b32 v96, 16, v149
    v_and_b32 v97, 0xffff0000, v149
    v_pk_add_f32 v[26:27], v[26:27], v[96:97]
    v_lshlrev_b32 v96, 16, v150
    v_and_b32 v97, 0xffff0000, v150
    v_pk_add_f32 v[60:61], v[60:61], v[96:97]
    v_lshlrev_b32 v96, 16, v151
    v_and_b32 v97, 0xffff0000, v151
    v_pk_add_f32 v[62:63], v[62:63], v[96:97]
    v_lshlrev_b32 v96, 16, v152
    v_and_b32 v97, 0xffff0000, v152
    v_pk_add_f32 v[28:29], v[28:29], v[96:97]
    v_lshlrev_b32 v96, 16, v153
    v_and_b32 v97, 0xffff0000, v153
    v_pk_add_f32 v[30:31], v[30:31], v[96:97]
    v_lshlrev_b32 v96, 16, v154
    v_and_b32 v97, 0xffff0000, v154
    v_pk_add_f32 v[64:65], v[64:65], v[96:97]
    v_lshlrev_b32 v96, 16, v155
    v_and_b32 v97, 0xffff0000, v155
    v_pk_add_f32 v[66:67], v[66:67], v[96:97]
    v_lshlrev_b32 v96, 16, v156
    v_and_b32 v97, 0xffff0000, v156
    v_pk_add_f32 v[24:25], v[24:25], v[96:97]
    v_lshlrev_b32 v96, 16, v157
    v_and_b32 v97, 0xffff0000, v157
    v_pk_add_f32 v[26:27], v[26:27], v[96:97]
    v_lshlrev_b32 v96, 16, v158
    v_and_b32 v97, 0xffff0000, v158
    v_pk_add_f32 v[60:61], v[60:61], v[96:97]
    v_lshlrev_b32 v96, 16, v159
    v_and_b32 v97, 0xffff0000, v159
    v_pk_add_f32 v[62:63], v[62:63], v[96:97]
    v_lshlrev_b32 v96, 16, v160
    v_and_b32 v97, 0xffff0000, v160
    v_pk_add_f32 v[28:29], v[28:29], v[96:97]
    v_lshlrev_b32 v96, 16, v161
    v_and_b32 v97, 0xffff0000, v161
    v_pk_add_f32 v[30:31], v[30:31], v[96:97]
    v_lshlrev_b32 v96, 16, v162
    v_and_b32 v97, 0xffff0000, v162
    v_pk_add_f32 v[64:65], v[64:65], v[96:97]
    v_lshlrev_b32 v96, 16, v163
    v_and_b32 v97, 0xffff0000, v163
    v_pk_add_f32 v[66:67], v[66:67], v[96:97]
    v_lshlrev_b32 v96, 16, v164
    v_and_b32 v97, 0xffff0000, v164
    v_pk_add_f32 v[24:25], v[24:25], v[96:97]
    v_lshlrev_b32 v96, 16, v165
    v_and_b32 v97, 0xffff0000, v165
    v_pk_add_f32 v[26:27], v[26:27], v[96:97]
    v_lshlrev_b32 v96, 16, v166
    v_and_b32 v97, 0xffff0000, v166
    v_pk_add_f32 v[60:61], v[60:61], v[96:97]
    v_lshlrev_b32 v96, 16, v167
    v_and_b32 v97, 0xffff0000, v167
    v_pk_add_f32 v[62:63], v[62:63], v[96:97]
    v_lshlrev_b32 v96, 16, v168
    v_and_b32 v97, 0xffff0000, v168
    v_pk_add_f32 v[28:29], v[28:29], v[96:97]
    v_lshlrev_b32 v96, 16, v169
    v_and_b32 v97, 0xffff0000, v169
    v_pk_add_f32 v[30:31], v[30:31], v[96:97]
    v_lshlrev_b32 v96, 16, v170
    v_and_b32 v97, 0xffff0000, v170
    v_pk_add_f32 v[64:65], v[64:65], v[96:97]
    v_lshlrev_b32 v96, 16, v171
    v_and_b32 v97, 0xffff0000, v171
    v_pk_add_f32 v[66:67], v[66:67], v[96:97]
    v_cvt_pk_bf16_f32 v112, v24, v25
    v_cvt_pk_bf16_f32 v113, v26, v27
    v_cvt_pk_bf16_f32 v114, v28, v29
    v_cvt_pk_bf16_f32 v115, v30, v31
    buffer_store_dwordx4 v[112:115], v98, s[56:59], s28 offen
    v_cvt_pk_bf16_f32 v116, v60, v61
    v_cvt_pk_bf16_f32 v117, v62, v63
    v_cvt_pk_bf16_f32 v118, v64, v65
    v_cvt_pk_bf16_f32 v119, v66, v67
    buffer_store_dwordx4 v[116:119], v98, s[56:59], s29 offen
    s_or_b32 s16, s2, s19
    s_cbranch_scc1 m_B_ne
    s_mov_b32 s16, 261888
    s_mov_b64 exec, 1
    buffer_store_dword v99, off, s[12:15], s16 sc1
    s_mov_b64 exec, -1
m_B_ne:
m_end:
    s_endpgm
.section .rodata,"a"
.p2align 6
.amdhsa_kernel gated_mix__spectral_gfnet__mixer_token_mlp__prompt_kernel
  .amdhsa_next_free_vgpr 256
  .amdhsa_next_free_sgpr 100
  .amdhsa_accum_offset 256
  .amdhsa_group_segment_fixed_size 0
  .amdhsa_kernarg_size 96
  .amdhsa_user_sgpr_count 2
  .amdhsa_user_sgpr_kernarg_segment_ptr 1
  .amdhsa_system_sgpr_workgroup_id_x 1
.end_amdhsa_kernel
```
